```python
import torch

def _softmax(x, axis=-1):
    return torch.softmax(x, dim=axis)
def _gelu(x):
    return torch.nn.functional.gelu(x, approximate="tanh")
def _silu(x):
    return torch.nn.functional.silu(x)
def _sigmoid(x):
    return torch.sigmoid(x)
def _layernorm(x, axis=-1, eps=1e-5):
    m = x.mean(dim=axis, keepdim=True)
    v = x.var(dim=axis, keepdim=True, unbiased=False)
    return (x - m) / torch.sqrt(v + eps)
def _scatter_add(tgt, idx, src, axis=0):
    return tgt.clone().index_add_(axis, idx, src)
def _segment_sum(src, seg, n):
    out = torch.zeros((n,) + src.shape[1:], dtype=src.dtype)
    return out.index_add_(0, seg, src)
def _pad(x, pw):
    flat = tuple(v for pair in reversed(pw) for v in pair)
    return torch.nn.functional.pad(x, flat)

kernel_name = 'parallel_sum__sliding_local_dilated__glu_gated_bilinear__prompt'

def setup_inputs():

    _w = (lambda a: (lambda t: t.to(torch.bfloat16) if t.is_floating_point() else t)(torch.as_tensor(a)))
    def _A_setup():
        B, S, D = 1, 2048, 1024
        return {
            "x": _w((lambda *s: torch.randn(*s, dtype=torch.bfloat16) * 0.05)(B, S, D)),
            "wqkv": _w((lambda *s: torch.randn(*s, dtype=torch.bfloat16) * 0.05)(D, 3 * D)),
            "wo": _w((lambda *s: torch.randn(*s, dtype=torch.bfloat16) * 0.05)(D, D)),
        }
    _A_in = _A_setup()

    def _B_setup():
        B, S, D, F = 1, 2048, 1024, 3584
        return {
            "x": _w((lambda *s: torch.randn(*s, dtype=torch.bfloat16) * 0.05)(B, S, D)),
            "w_gate": _w((lambda *s: torch.randn(*s, dtype=torch.bfloat16) * 0.8)(D, F) * (D ** -0.5)),
            "w_up": _w((lambda *s: torch.randn(*s, dtype=torch.bfloat16) * 0.8)(D, F) * (D ** -0.5)),
            "w_down": _w((lambda *s: torch.randn(*s, dtype=torch.bfloat16) * 0.8)(F, D) * (F ** -0.5)),
        }
    _B_in = _B_setup()

    return {
        "A_x": _A_in["x"],
        "A_wqkv": _A_in["wqkv"],
        "A_wo": _A_in["wo"],
        "B_x": _B_in["x"],
        "B_w_gate": _B_in["w_gate"],
        "B_w_up": _B_in["w_up"],
        "B_w_down": _B_in["w_down"],
    }

def reference(A_x, A_wqkv, A_wo, B_x, B_w_gate, B_w_up, B_w_down):
    def _A_ref(x, wqkv, wo):
        B, S, D = x.shape
        H = 32; Dh = D // H
        W, dil = 8, 2
        qkv = (lambda x, *d: x.permute(*d))((x @ wqkv).reshape(B, S, 3, H, Dh), 2, 0, 3, 1, 4)
        q, k, v = qkv[0], qkv[1], qkv[2]
        scale = Dh ** -0.5
        pos = torch.arange(S)
        off = torch.arange(W) * dil
        idx = pos[:, None] - off[None, :]
        mask = idx >= 0
        idx_c = torch.where(mask, idx, 0).reshape(-1)
        kg = k[:, :, idx_c, :].reshape(B, H, S, W, Dh)
        vg = v[:, :, idx_c, :].reshape(B, H, S, W, Dh)
        logits = torch.einsum("bhsd,bhswd->bhsw", q, kg) * scale
        logits = torch.where(mask[None, None, :, :], logits, -1e9)
        attn = _softmax(logits, axis=-1)
        o = torch.einsum("bhsw,bhswd->bhsd", attn, vg)
        return (lambda x, *d: x.permute(*d))(o, 0, 2, 1, 3).reshape(B, S, D) @ wo

    def _B_ref(x, w_gate, w_up, w_down):
        g = torch.einsum("bsd,df->bsf", x, w_gate)
        u = torch.einsum("bsd,df->bsf", x, w_up)
        h = g * u
        return torch.einsum("bsf,fd->bsd", h, w_down)

    x = A_x
    xn = _layernorm(x, axis=-1)
    return x + _A_ref(xn, A_wqkv, A_wo) + _B_ref(xn, B_w_gate, B_w_up, B_w_down)
```

```asm
; @launch grid=(256,1,1) block=(256,1,1) lds=163840
.amdgcn_target "amdgcn-amd-amdhsa--gfx950"
.text
.globl parallel_sum__sliding_local_dilated__glu_gated_bilinear__prompt_kernel
.p2align 8
.type parallel_sum__sliding_local_dilated__glu_gated_bilinear__prompt_kernel,@function
parallel_sum__sliding_local_dilated__glu_gated_bilinear__prompt_kernel:
    s_cmp_ge_u32 s2, 256
    s_cbranch_scc1 L_end
    s_load_dwordx16 s[64:79], s[0:1], 0
    s_load_dwordx4 s[80:83], s[0:1], 64
    s_getpc_b64 s[4:5]
    v_and_b32 v1, 63, v0
    v_lshrrev_b32 v2, 6, v0
    s_lshr_b32 s48, s2, 3
    s_mul_i32 s48, s48, 12
    s_add_u32 s48, s48, 48
    v_lshl_add_u32 v13, v2, 4, v1
    v_mad_u32_u24 v14, v2, 3, v1
    v_add_u32 v14, s48, v14
    v_cmp_gt_u32 vcc, 16, v1
    s_and_b32 s5, s5, 0xffff
    s_and_b32 s4, s4, 0xffffff00
    s_mov_b32 s6, L_end_code-parallel_sum__sliding_local_dilated__glu_gated_bilinear__prompt_kernel
    s_mov_b32 s7, 0x00020000
    v_cndmask_b32 v13, v14, v13, vcc
    v_lshlrev_b32 v13, 7, v13
    s_mov_b64 exec, 0x7ffff
    buffer_load_dword v196, v13, s[4:7], 0 offen
    s_mov_b64 exec, -1
    v_and_b32 v1, 63, v0
    v_lshrrev_b32 v2, 6, v0
    v_and_b32 v4, 7, v1
    v_lshrrev_b32 v5, 3, v1
    v_readfirstlane_b32 s32, v2
    s_lshl_b32 s3, s2, 3
    v_add_u32 v6, s3, v4
    v_lshlrev_b32 v7, 11, v6
    s_lshl_b32 s47, s32, 9
    v_lshl_add_u32 v8, v5, 4, v7
    v_add_u32 v8, s47, v8
    v_mov_b32 v9, 0
    s_waitcnt lgkmcnt(0)
    s_mov_b32 s24, s64
    s_and_b32 s25, s65, 0xffff
    s_mov_b32 s26, 4194304
    s_mov_b32 s27, 0x00020000
    buffer_load_dwordx4 v[76:79], v8, s[24:27], 0 offen offset:0 nt
    buffer_load_dwordx4 v[80:83], v8, s[24:27], 0 offen offset:128 nt
    buffer_load_dwordx4 v[84:87], v8, s[24:27], 0 offen offset:256 nt
    buffer_load_dwordx4 v[88:91], v8, s[24:27], 0 offen offset:384 nt
    buffer_load_dword v10, v7, s[24:27], 0 offen nt
    s_add_u32 s84, s82, 41943040
    s_addc_u32 s85, s83, 0
    s_and_b32 s85, s85, 0xffff
    s_mov_b32 s86, 196736
    s_mov_b32 s87, 0x00020000
    s_mov_b32 s47, 196608
    buffer_load_dword v11, v9, s[84:87], s47 offen sc1
    s_and_b32 s33, s2, 7
    s_lshl_b32 s33, s33, 2
    s_bfe_u32 s34, s2, 0x20003
    s_add_u32 s33, s33, s34
    s_lshr_b32 s34, s2, 5
    s_movk_i32 s54, 6144
    s_movk_i32 s55, 7168
    v_lshlrev_b32 v3, 4, v1
    s_movk_i32 s57, 9363
    s_movk_i32 s49, 896
    s_cmp_eq_u32 s32, 1
    s_cselect_b32 s92, s66, s72
    s_cselect_b32 s93, s67, s73
    s_cselect_b32 s56, 6, 7
    s_cselect_b32 s57, 10923, s57
    s_cselect_b32 s58, s54, s55
    s_cselect_b32 s49, 256, s49
    s_cselect_b32 s50, 1792, 0
    s_cmp_eq_u32 s32, 3
    s_cselect_b32 s92, s74, s92
    s_cselect_b32 s93, s75, s93
    s_and_b32 s93, s93, 0xffff
    s_lshl_b32 s94, s58, 10
    s_mov_b32 s95, 0x00020000
    v_mul_u32_u24 v188, s57, v1
    v_lshrrev_b32 v188, 16, v188
    v_mul_u32_u24 v189, s56, v188
    v_sub_u32 v189, v1, v189
    s_lshr_b32 s47, s2, 3
    v_lshl_add_u32 v190, v188, 5, s47
    v_mul_u32_u24 v190, s58, v190
    v_lshl_add_u32 v190, v189, 7, v190
    v_lshrrev_b32 v191, 1, v189
    v_mul_u32_u24 v191, s50, v191
    s_and_b32 s47, s2, 7
    s_mul_i32 s47, s47, s49
    v_add3_u32 v190, v190, v191, s47
    s_cmp_eq_u32 s32, 0
    s_cselect_b32 s49, 0, 7
    s_cselect_b32 s50, 0, 4
    v_mov_b32 v191, 0x7fffff00
    v_cmp_gt_u32 vcc, s49, v188
    s_nop 1
    v_cndmask_b32 v192, v191, v190, vcc
    v_cmp_gt_u32 vcc, s50, v188
    buffer_load_dword v196, v192, s[92:95], 0 offen
    s_mul_i32 s59, s58, 224
    v_cndmask_b32 v199, v191, v190, vcc
    s_lshl_b32 s97, s58, 7
    v_lshrrev_b32 v12, 2, v5
    v_lshlrev_b32 v12, 17, v12
    v_and_b32 v13, 3, v5
    v_lshl_add_u32 v12, v13, 8, v12
    v_lshrrev_b32 v13, 4, v6
    v_lshl_add_u32 v12, v13, 10, v12
    v_and_b32 v13, 15, v6
    v_lshl_add_u32 v12, v13, 4, v12
    s_lshl_b32 s47, s32, 20
    v_add_u32 v12, s47, v12
    s_mov_b32 s8, s82
    s_and_b32 s9, s83, 0xffff
    s_mov_b32 s10, 4194304
    s_mov_b32 s11, 0x00020000
    s_mov_b32 s60, 0x40000
    s_mov_b32 s61, 0x80000
    s_mov_b32 s62, 0xc0000
    v_lshlrev_b32 v13, 5, v4
    v_add_u32 v13, 151552, v13
    s_lshl_b32 s47, s32, 3
    v_add_u32 v14, s47, v13
    s_waitcnt vmcnt(1)
    v_readfirstlane_b32 s96, v11
    v_lshlrev_b32 v10, 16, v10
    v_lshlrev_b32 v92, 16, v76
    v_and_b32 v93, 0xffff0000, v76
    v_lshlrev_b32 v94, 16, v77
    v_and_b32 v95, 0xffff0000, v77
    v_lshlrev_b32 v96, 16, v78
    v_and_b32 v97, 0xffff0000, v78
    v_lshlrev_b32 v98, 16, v79
    v_and_b32 v99, 0xffff0000, v79
    v_lshlrev_b32 v100, 16, v80
    v_and_b32 v101, 0xffff0000, v80
    v_lshlrev_b32 v102, 16, v81
    v_and_b32 v103, 0xffff0000, v81
    v_lshlrev_b32 v104, 16, v82
    v_and_b32 v105, 0xffff0000, v82
    v_lshlrev_b32 v106, 16, v83
    v_and_b32 v107, 0xffff0000, v83
    v_lshlrev_b32 v108, 16, v84
    v_and_b32 v109, 0xffff0000, v84
    v_lshlrev_b32 v110, 16, v85
    v_and_b32 v111, 0xffff0000, v85
    v_lshlrev_b32 v112, 16, v86
    v_and_b32 v113, 0xffff0000, v86
    v_lshlrev_b32 v114, 16, v87
    v_and_b32 v115, 0xffff0000, v87
    v_lshlrev_b32 v116, 16, v88
    v_and_b32 v117, 0xffff0000, v88
    v_lshlrev_b32 v118, 16, v89
    v_and_b32 v119, 0xffff0000, v89
    v_lshlrev_b32 v120, 16, v90
    v_and_b32 v121, 0xffff0000, v90
    v_lshlrev_b32 v122, 16, v91
    v_and_b32 v123, 0xffff0000, v91
    s_add_u32 s96, s96, 1
    v_mov_b32 v11, v10
    v_pk_add_f32 v[16:17], v[92:93], v[10:11] neg_lo:[0,1] neg_hi:[0,1]
    v_pk_mul_f32 v[18:19], v[16:17], v[16:17]
    v_pk_add_f32 v[20:21], v[94:95], v[10:11] neg_lo:[0,1] neg_hi:[0,1]
    v_pk_add_f32 v[16:17], v[16:17], v[20:21]
    v_pk_fma_f32 v[18:19], v[20:21], v[20:21], v[18:19]
    v_pk_add_f32 v[20:21], v[96:97], v[10:11] neg_lo:[0,1] neg_hi:[0,1]
    v_pk_add_f32 v[16:17], v[16:17], v[20:21]
    v_pk_fma_f32 v[18:19], v[20:21], v[20:21], v[18:19]
    v_pk_add_f32 v[20:21], v[98:99], v[10:11] neg_lo:[0,1] neg_hi:[0,1]
    v_pk_add_f32 v[16:17], v[16:17], v[20:21]
    v_pk_fma_f32 v[18:19], v[20:21], v[20:21], v[18:19]
    v_pk_add_f32 v[20:21], v[100:101], v[10:11] neg_lo:[0,1] neg_hi:[0,1]
    v_pk_add_f32 v[16:17], v[16:17], v[20:21]
    v_pk_fma_f32 v[18:19], v[20:21], v[20:21], v[18:19]
    v_pk_add_f32 v[20:21], v[102:103], v[10:11] neg_lo:[0,1] neg_hi:[0,1]
    v_pk_add_f32 v[16:17], v[16:17], v[20:21]
    v_pk_fma_f32 v[18:19], v[20:21], v[20:21], v[18:19]
    v_pk_add_f32 v[20:21], v[104:105], v[10:11] neg_lo:[0,1] neg_hi:[0,1]
    v_pk_add_f32 v[16:17], v[16:17], v[20:21]
    v_pk_fma_f32 v[18:19], v[20:21], v[20:21], v[18:19]
    v_pk_add_f32 v[20:21], v[106:107], v[10:11] neg_lo:[0,1] neg_hi:[0,1]
    v_pk_add_f32 v[16:17], v[16:17], v[20:21]
    v_pk_fma_f32 v[18:19], v[20:21], v[20:21], v[18:19]
    v_pk_add_f32 v[20:21], v[108:109], v[10:11] neg_lo:[0,1] neg_hi:[0,1]
    v_pk_add_f32 v[16:17], v[16:17], v[20:21]
    v_pk_fma_f32 v[18:19], v[20:21], v[20:21], v[18:19]
    v_pk_add_f32 v[20:21], v[110:111], v[10:11] neg_lo:[0,1] neg_hi:[0,1]
    v_pk_add_f32 v[16:17], v[16:17], v[20:21]
    v_pk_fma_f32 v[18:19], v[20:21], v[20:21], v[18:19]
    v_pk_add_f32 v[20:21], v[112:113], v[10:11] neg_lo:[0,1] neg_hi:[0,1]
    v_pk_add_f32 v[16:17], v[16:17], v[20:21]
    v_pk_fma_f32 v[18:19], v[20:21], v[20:21], v[18:19]
    v_pk_add_f32 v[20:21], v[114:115], v[10:11] neg_lo:[0,1] neg_hi:[0,1]
    v_pk_add_f32 v[16:17], v[16:17], v[20:21]
    v_pk_fma_f32 v[18:19], v[20:21], v[20:21], v[18:19]
    v_pk_add_f32 v[20:21], v[116:117], v[10:11] neg_lo:[0,1] neg_hi:[0,1]
    v_pk_add_f32 v[16:17], v[16:17], v[20:21]
    v_pk_fma_f32 v[18:19], v[20:21], v[20:21], v[18:19]
    v_pk_add_f32 v[20:21], v[118:119], v[10:11] neg_lo:[0,1] neg_hi:[0,1]
    v_pk_add_f32 v[16:17], v[16:17], v[20:21]
    v_pk_fma_f32 v[18:19], v[20:21], v[20:21], v[18:19]
    v_pk_add_f32 v[20:21], v[120:121], v[10:11] neg_lo:[0,1] neg_hi:[0,1]
    v_pk_add_f32 v[16:17], v[16:17], v[20:21]
    v_pk_fma_f32 v[18:19], v[20:21], v[20:21], v[18:19]
    v_pk_add_f32 v[20:21], v[122:123], v[10:11] neg_lo:[0,1] neg_hi:[0,1]
    v_pk_add_f32 v[16:17], v[16:17], v[20:21]
    v_pk_fma_f32 v[18:19], v[20:21], v[20:21], v[18:19]
    v_add_f32 v16, v16, v17
    v_add_f32 v17, v18, v19
    s_nop 0
    v_add_f32_dpp v16, v16, v16 row_ror:8 row_mask:0xf bank_mask:0xf
    v_add_f32_dpp v17, v17, v17 row_ror:8 row_mask:0xf bank_mask:0xf
    v_mov_b32 v18, v16
    v_mov_b32 v19, v17
    s_nop 1
    v_permlane16_swap_b32 v16, v18
    v_permlane16_swap_b32 v17, v19
    s_nop 1
    v_pk_add_f32 v[16:17], v[16:17], v[18:19]
    v_mov_b32 v18, v16
    v_mov_b32 v19, v17
    s_nop 1
    v_permlane32_swap_b32 v16, v18
    v_permlane32_swap_b32 v17, v19
    s_nop 1
    v_pk_add_f32 v[16:17], v[16:17], v[18:19]
    ds_write_b64 v14, v[16:17]
    s_waitcnt lgkmcnt(0)
    s_barrier
    ds_read_b128 v[20:23], v13
    ds_read_b128 v[24:27], v13 offset:16
    s_waitcnt lgkmcnt(0)
    v_pk_add_f32 v[16:17], v[20:21], v[22:23]
    v_pk_add_f32 v[18:19], v[24:25], v[26:27]
    v_pk_add_f32 v[16:17], v[16:17], v[18:19]
    v_mul_f32 v16, 0.0009765625, v16
    v_mul_f32 v17, 0.0009765625, v17
    v_fma_f32 v17, -v16, v16, v17
    v_max_f32 v17, 0, v17
    v_add_f32 v16, v16, v10
    v_cvt_pk_bf16_f32 v17, v17, v17
    v_lshlrev_b32 v17, 16, v17
    v_add_f32 v17, 1e-05, v17
    v_cvt_pk_bf16_f32 v17, v17, v17
    v_lshlrev_b32 v17, 16, v17
    v_sqrt_f32 v17, v17
    v_cvt_pk_bf16_f32 v16, v16, v16
    v_lshlrev_b32 v16, 16, v16
    v_cvt_pk_bf16_f32 v17, v17, v17
    v_lshlrev_b32 v17, 16, v17
    v_rcp_f32 v20, v17
    v_mov_b32 v17, v16
    v_mov_b32 v21, v20
    v_pk_add_f32 v[92:93], v[92:93], v[16:17] neg_lo:[0,1] neg_hi:[0,1]
    v_cvt_pk_bf16_f32 v18, v92, v93
    v_lshlrev_b32 v92, 16, v18
    v_and_b32 v93, 0xffff0000, v18
    v_pk_mul_f32 v[92:93], v[92:93], v[20:21]
    v_cvt_pk_bf16_f32 v76, v92, v93
    v_pk_add_f32 v[94:95], v[94:95], v[16:17] neg_lo:[0,1] neg_hi:[0,1]
    v_cvt_pk_bf16_f32 v18, v94, v95
    v_lshlrev_b32 v94, 16, v18
    v_and_b32 v95, 0xffff0000, v18
    v_pk_mul_f32 v[94:95], v[94:95], v[20:21]
    v_cvt_pk_bf16_f32 v77, v94, v95
    v_pk_add_f32 v[96:97], v[96:97], v[16:17] neg_lo:[0,1] neg_hi:[0,1]
    v_cvt_pk_bf16_f32 v18, v96, v97
    v_lshlrev_b32 v96, 16, v18
    v_and_b32 v97, 0xffff0000, v18
    v_pk_mul_f32 v[96:97], v[96:97], v[20:21]
    v_cvt_pk_bf16_f32 v78, v96, v97
    v_pk_add_f32 v[98:99], v[98:99], v[16:17] neg_lo:[0,1] neg_hi:[0,1]
    v_cvt_pk_bf16_f32 v18, v98, v99
    v_lshlrev_b32 v98, 16, v18
    v_and_b32 v99, 0xffff0000, v18
    v_pk_mul_f32 v[98:99], v[98:99], v[20:21]
    v_cvt_pk_bf16_f32 v79, v98, v99
    buffer_store_dwordx4 v[76:79], v12, s[8:11], 0 offen sc1
    v_pk_add_f32 v[100:101], v[100:101], v[16:17] neg_lo:[0,1] neg_hi:[0,1]
    v_cvt_pk_bf16_f32 v18, v100, v101
    v_lshlrev_b32 v100, 16, v18
    v_and_b32 v101, 0xffff0000, v18
    v_pk_mul_f32 v[100:101], v[100:101], v[20:21]
    v_cvt_pk_bf16_f32 v80, v100, v101
    v_pk_add_f32 v[102:103], v[102:103], v[16:17] neg_lo:[0,1] neg_hi:[0,1]
    v_cvt_pk_bf16_f32 v18, v102, v103
    v_lshlrev_b32 v102, 16, v18
    v_and_b32 v103, 0xffff0000, v18
    v_pk_mul_f32 v[102:103], v[102:103], v[20:21]
    v_cvt_pk_bf16_f32 v81, v102, v103
    v_pk_add_f32 v[104:105], v[104:105], v[16:17] neg_lo:[0,1] neg_hi:[0,1]
    v_cvt_pk_bf16_f32 v18, v104, v105
    v_lshlrev_b32 v104, 16, v18
    v_and_b32 v105, 0xffff0000, v18
    v_pk_mul_f32 v[104:105], v[104:105], v[20:21]
    v_cvt_pk_bf16_f32 v82, v104, v105
    v_pk_add_f32 v[106:107], v[106:107], v[16:17] neg_lo:[0,1] neg_hi:[0,1]
    v_cvt_pk_bf16_f32 v18, v106, v107
    v_lshlrev_b32 v106, 16, v18
    v_and_b32 v107, 0xffff0000, v18
    v_pk_mul_f32 v[106:107], v[106:107], v[20:21]
    v_cvt_pk_bf16_f32 v83, v106, v107
    buffer_store_dwordx4 v[80:83], v12, s[8:11], s60 offen sc1
    v_pk_add_f32 v[108:109], v[108:109], v[16:17] neg_lo:[0,1] neg_hi:[0,1]
    v_cvt_pk_bf16_f32 v18, v108, v109
    v_lshlrev_b32 v108, 16, v18
    v_and_b32 v109, 0xffff0000, v18
    v_pk_mul_f32 v[108:109], v[108:109], v[20:21]
    v_cvt_pk_bf16_f32 v84, v108, v109
    v_pk_add_f32 v[110:111], v[110:111], v[16:17] neg_lo:[0,1] neg_hi:[0,1]
    v_cvt_pk_bf16_f32 v18, v110, v111
    v_lshlrev_b32 v110, 16, v18
    v_and_b32 v111, 0xffff0000, v18
    v_pk_mul_f32 v[110:111], v[110:111], v[20:21]
    v_cvt_pk_bf16_f32 v85, v110, v111
    v_pk_add_f32 v[112:113], v[112:113], v[16:17] neg_lo:[0,1] neg_hi:[0,1]
    v_cvt_pk_bf16_f32 v18, v112, v113
    v_lshlrev_b32 v112, 16, v18
    v_and_b32 v113, 0xffff0000, v18
    v_pk_mul_f32 v[112:113], v[112:113], v[20:21]
    v_cvt_pk_bf16_f32 v86, v112, v113
    v_pk_add_f32 v[114:115], v[114:115], v[16:17] neg_lo:[0,1] neg_hi:[0,1]
    v_cvt_pk_bf16_f32 v18, v114, v115
    v_lshlrev_b32 v114, 16, v18
    v_and_b32 v115, 0xffff0000, v18
    v_pk_mul_f32 v[114:115], v[114:115], v[20:21]
    v_cvt_pk_bf16_f32 v87, v114, v115
    buffer_store_dwordx4 v[84:87], v12, s[8:11], s61 offen sc1
    v_pk_add_f32 v[116:117], v[116:117], v[16:17] neg_lo:[0,1] neg_hi:[0,1]
    v_cvt_pk_bf16_f32 v18, v116, v117
    v_lshlrev_b32 v116, 16, v18
    v_and_b32 v117, 0xffff0000, v18
    v_pk_mul_f32 v[116:117], v[116:117], v[20:21]
    v_cvt_pk_bf16_f32 v88, v116, v117
    v_pk_add_f32 v[118:119], v[118:119], v[16:17] neg_lo:[0,1] neg_hi:[0,1]
    v_cvt_pk_bf16_f32 v18, v118, v119
    v_lshlrev_b32 v118, 16, v18
    v_and_b32 v119, 0xffff0000, v18
    v_pk_mul_f32 v[118:119], v[118:119], v[20:21]
    v_cvt_pk_bf16_f32 v89, v118, v119
    v_pk_add_f32 v[120:121], v[120:121], v[16:17] neg_lo:[0,1] neg_hi:[0,1]
    v_cvt_pk_bf16_f32 v18, v120, v121
    v_lshlrev_b32 v120, 16, v18
    v_and_b32 v121, 0xffff0000, v18
    v_pk_mul_f32 v[120:121], v[120:121], v[20:21]
    v_cvt_pk_bf16_f32 v90, v120, v121
    v_pk_add_f32 v[122:123], v[122:123], v[16:17] neg_lo:[0,1] neg_hi:[0,1]
    v_cvt_pk_bf16_f32 v18, v122, v123
    v_lshlrev_b32 v122, 16, v18
    v_and_b32 v123, 0xffff0000, v18
    v_pk_mul_f32 v[122:123], v[122:123], v[20:21]
    v_cvt_pk_bf16_f32 v91, v122, v123
    buffer_store_dwordx4 v[88:91], v12, s[8:11], s62 offen sc1
    s_cmp_eq_u32 s34, 0
    s_cselect_b32 s35, 0, 1024
    s_lshl_b32 s42, s34, 14
    s_sub_u32 s42, s42, s35
    s_lshl_b32 s43, s33, 6
    s_mul_i32 s44, s33, 224
    s_mov_b32 s28, 0
    s_mov_b32 s29, 0
    s_mov_b32 s30, 0
    s_and_b32 s45, s33, 1
    s_lshl_b32 s46, s45, 1
    s_movk_i32 s52, 5462
    s_movk_i32 s53, 4682
    s_add_u32 s12, s66, s43
    s_addc_u32 s13, s67, 0
    s_and_b32 s13, s13, 0xffff
    s_mov_b32 s14, 0
    s_mov_b32 s15, 0x00020000
    s_sub_u32 s14, 6291456, s43
    s_add_u32 s16, s72, s44
    s_addc_u32 s17, s73, 0
    s_and_b32 s17, s17, 0xffff
    s_mov_b32 s18, 0
    s_mov_b32 s19, 0x00020000
    s_sub_u32 s18, 7340032, s44
    s_add_u32 s20, s74, s44
    s_addc_u32 s21, s75, 0
    s_and_b32 s21, s21, 0xffff
    s_mov_b32 s22, 0
    s_mov_b32 s23, 0x00020000
    s_sub_u32 s22, 7340032, s44
    s_add_u32 s24, s82, 4194304
    s_addc_u32 s25, s83, 0
    s_and_b32 s25, s25, 0xffff
    s_mov_b32 s26, 18874368
    s_mov_b32 s27, 0x00020000
    s_lshl_b32 s47, s34, 5
    s_sub_u32 s47, s47, 2
    v_add_u32 v200, s47, v1
    v_max_i32 v200, 0, v200
    v_lshlrev_b32 v200, 2, v200
    s_and_b32 s47, s2, 7
    s_lshl_b32 s47, s47, 10
    s_add_u32 s47, s47, 32768
    v_add_u32 v200, s47, v200
    s_mov_b32 s31, 8
    v_mov_b32 v176, 0x7fffff00
    v_mov_b32 v177, 0x7fffff00
    s_cmp_eq_u32 s32, 1
    s_cbranch_scc1 L_g1_w1
    s_cmp_eq_u32 s32, 2
    s_cbranch_scc1 L_g1_w2
    s_cmp_eq_u32 s32, 3
    s_cbranch_scc1 L_g1_w3
L_g1_w0:
    v_mov_b32 v168, v3
    s_add_u32 s47, s35, 0
    v_add_u32 v169, s47, v3
    s_add_u32 s47, s35, 0
    v_add_u32 v170, s47, v3
    s_add_u32 s47, s35, 0
    v_add_u32 v171, s47, v3
    s_add_u32 s47, s35, 0
    v_add_u32 v172, s47, v3
    s_add_u32 s47, s35, 4096
    v_add_u32 v173, s47, v3
    s_add_u32 s47, s35, 4096
    v_add_u32 v174, s47, v3
    s_add_u32 s47, s35, 4096
    v_add_u32 v175, s47, v3
    s_add_u32 s47, s35, 4096
    v_add_u32 v176, s47, v3
    v_add_u32 v178, 1024, v3
    v_add_u32 v179, 76800, v3
    s_waitcnt vmcnt(0)
    s_barrier
    s_lshl_b32 s47, s2, 2
    s_add_u32 s47, s47, 32768
    v_lshlrev_b32 v188, 10, v1
    v_mov_b32 v189, s96
    s_mov_b64 exec, 0xff
    buffer_store_dword v189, v188, s[84:87], s47 offen sc1
    s_mov_b64 exec, -1
    s_add_u32 s8, s82, s42
    s_addc_u32 s9, s83, 0
    s_and_b32 s9, s9, 0xffff
    s_mov_b32 s10, 0
    s_mov_b32 s11, 0x00020000
    s_sub_u32 s10, 4194304, s42
    s_call_b64 s[62:63], L_common
    s_and_b32 s60, s2, 1
    s_bfe_u32 s61, s2, 0x20001
    s_lshl_b32 s61, s61, 2
    s_bfe_u32 s47, s2, 0x20003
    s_add_u32 s61, s61, s47
    s_lshr_b32 s62, s2, 5
    s_lshl_b32 s63, s62, 8
    v_mov_b32 v220, v3
    v_add_u32 v221, 4096, v220
    v_mov_b32 v222, 0x7fffff00
    v_mov_b32 v223, 0x7fffff00
    v_mov_b32 v224, 0x7fffff00
    v_mov_b32 v225, 0x7fffff00
    v_mov_b32 v226, 0x7fffff00
    v_mov_b32 v227, 0x7fffff00
    v_add_u32 v228, 0, v3
    v_add_u32 v229, 65536, v228
    v_add_u32 v230, 2048, v228
    v_add_u32 v231, 65536, v230
    v_lshrrev_b32 v240, 2, v1
    v_and_b32 v241, 7, v240
    v_and_b32 v242, 3, v1
    v_lshlrev_b32 v242, 3, v242
    v_lshl_add_u32 v242, v240, 8, v242
    v_add_u32 v242, 16384, v242
    v_xor_b32 v243, 0, v241
    v_lshl_add_u32 v232, v243, 5, v242
    v_add_u32 v233, 65536, v232
    v_xor_b32 v243, 1, v241
    v_lshl_add_u32 v234, v243, 5, v242
    v_add_u32 v235, 65536, v234
    v_xor_b32 v243, 2, v241
    v_lshl_add_u32 v236, v243, 5, v242
    v_add_u32 v237, 65536, v236
    v_xor_b32 v243, 3, v241
    v_lshl_add_u32 v238, v243, 5, v242
    v_add_u32 v239, 65536, v238
    s_lshl_b32 s47, s61, 8
    s_add_u32 s47, s47, 4096
    v_lshl_add_u32 v245, v1, 2, s47
    v_and_b32 v240, 1, v1
    v_lshlrev_b32 v240, 7, v240
    v_and_b32 v241, 2, v1
    v_lshl_add_u32 v240, v241, 9, v240
    v_and_b32 v241, 4, v1
    v_lshl_add_u32 v240, v241, 7, v240
    s_lshr_b32 s47, s2, 3
    s_lshl_b32 s47, s47, 11
    s_add_u32 s47, s47, 256
    v_add_u32 v240, s47, v240
    v_lshrrev_b32 v241, 4, v1
    v_mul_u32_u24 v241, 7, v241
    v_bfe_u32 v242, v1, 3, 1
    v_lshl_add_u32 v241, v242, 2, v241
    v_lshl_add_u32 v247, v241, 16, v240
    s_cmp_eq_u32 s60, 1
    s_cselect_b32 s47, 7, 1
    v_lshrrev_b32 v241, 3, v1
    v_mul_u32_u24 v241, s47, v241
    v_lshl_add_u32 v246, v241, 16, v240
    s_lshl_b32 s4, s61, 7
    s_add_u32 s4, s4, 0
    s_lshl_b32 s4, s4, 11
    s_add_u32 s5, s63, 0
    s_add_u32 s4, s4, s5
    v_and_b32 v249, 15, v1
    v_lshlrev_b32 v249, 11, v249
    v_and_b32 v241, 16, v1
    v_lshl_add_u32 v249, v241, 1, v249
    v_and_b32 v241, 32, v1
    v_lshrrev_b32 v241, 1, v241
    v_add3_u32 v249, v249, v241, s4
    v_lshlrev_b32 v188, 7, v1
    v_mov_b32 v189, 0x7fffff00
    v_cmp_gt_u32 vcc, 28, v1
    s_nop 1
    v_cndmask_b32 v197, v189, v188, vcc
    s_mov_b32 s48, s76
    s_and_b32 s49, s77, 0xffff
    s_mov_b32 s50, 7340032
    s_mov_b32 s51, 0x00020000
    s_mul_i32 s60, s2, 28672
    v_lshrrev_b32 v188, 1, v1
    v_lshlrev_b32 v188, 10, v188
    v_and_b32 v190, 1, v1
    v_lshl_add_u32 v188, v190, 7, v188
    s_and_b32 s47, s33, 3
    s_lshl_b32 s47, s47, 17
    s_add_u32 s47, s47, s35
    s_add_u32 s47, s47, 256
    v_add_u32 v188, s47, v188
    v_cmp_gt_u32 vcc, 32, v1
    s_nop 1
    v_cndmask_b32 v198, v189, v188, vcc
    s_mov_b32 s61, 786432
    s_lshl_b32 s47, s34, 14
    s_add_u32 s47, s47, 0
    v_add_u32 v194, s47, v3
    s_lshl_b32 s47, s45, 3
    v_add_u32 v195, s47, v194
    s_mov_b32 exec_lo, -1
    s_mov_b32 exec_hi, 0x3
    s_mov_b32 s47, 0x20000
    buffer_load_dword v250, v200, s[84:87], 0 offen sc1
L_poll0:
    s_waitcnt vmcnt(0)
    v_cmp_ne_u32 vcc, s96, v250
    s_nop 4
    s_cbranch_vccz L_pollok0
    buffer_load_dword v250, v200, s[84:87], 0 offen sc1
    s_sub_u32 s47, s47, 1
    s_cmp_lg_u32 s47, 0
    s_cbranch_scc1 L_poll0
    s_branch L_end
L_pollok0:
    s_mov_b64 exec, -1
    s_mov_b32 m0, 0
    s_nop 0
    buffer_load_dwordx4 v168, s[8:11], s28 offen offset:0 sc1 lds
    s_mov_b32 m0, 1024
    s_nop 0
    buffer_load_dwordx4 v169, s[8:11], s28 offen offset:0 sc1 lds
    buffer_load_dwordx4 v170, s[8:11], s28 offen offset:1024 sc1 lds
    buffer_load_dwordx4 v171, s[8:11], s28 offen offset:2048 sc1 lds
    buffer_load_dwordx4 v172, s[8:11], s28 offen offset:3072 sc1 lds
    s_mov_b32 m0, 5120
    s_nop 0
    buffer_load_dwordx4 v173, s[8:11], s28 offen offset:0 sc1 lds
    buffer_load_dwordx4 v174, s[8:11], s28 offen offset:1024 sc1 lds
    buffer_load_dwordx4 v175, s[8:11], s28 offen offset:2048 sc1 lds
    buffer_load_dwordx4 v176, s[8:11], s28 offen offset:3072 sc1 lds
    s_add_u32 s28, s28, 131072
    s_mov_b32 m0, 37888
    s_nop 0
    buffer_load_dwordx4 v168, s[8:11], s28 offen offset:0 sc1 lds
    s_mov_b32 m0, 38912
    s_nop 0
    buffer_load_dwordx4 v169, s[8:11], s28 offen offset:0 sc1 lds
    buffer_load_dwordx4 v170, s[8:11], s28 offen offset:1024 sc1 lds
    buffer_load_dwordx4 v171, s[8:11], s28 offen offset:2048 sc1 lds
    buffer_load_dwordx4 v172, s[8:11], s28 offen offset:3072 sc1 lds
    s_mov_b32 m0, 43008
    s_nop 0
    buffer_load_dwordx4 v173, s[8:11], s28 offen offset:0 sc1 lds
    buffer_load_dwordx4 v174, s[8:11], s28 offen offset:1024 sc1 lds
    buffer_load_dwordx4 v175, s[8:11], s28 offen offset:2048 sc1 lds
    buffer_load_dwordx4 v176, s[8:11], s28 offen offset:3072 sc1 lds
    s_add_u32 s28, s28, 131072
    s_mov_b32 m0, 75776
    s_nop 0
    buffer_load_dwordx4 v168, s[8:11], s28 offen offset:0 sc1 lds
    s_mov_b32 m0, 76800
    s_nop 0
    buffer_load_dwordx4 v169, s[8:11], s28 offen offset:0 sc1 lds
    buffer_load_dwordx4 v170, s[8:11], s28 offen offset:1024 sc1 lds
    buffer_load_dwordx4 v171, s[8:11], s28 offen offset:2048 sc1 lds
    buffer_load_dwordx4 v172, s[8:11], s28 offen offset:3072 sc1 lds
    s_mov_b32 m0, 80896
    s_nop 0
    buffer_load_dwordx4 v173, s[8:11], s28 offen offset:0 sc1 lds
    buffer_load_dwordx4 v174, s[8:11], s28 offen offset:1024 sc1 lds
    buffer_load_dwordx4 v175, s[8:11], s28 offen offset:2048 sc1 lds
    buffer_load_dwordx4 v176, s[8:11], s28 offen offset:3072 sc1 lds
    s_add_u32 s28, s28, 131072
    s_waitcnt vmcnt(18)
    s_barrier
    .p2align 6
L_g1_loop0:
    ds_read_b128 a[112:115], v178 offset:0
    v_mfma_f32_16x16x32_bf16 v[68:71], a[132:135], a[168:171], v[68:71]
    ds_read_b64_tr_b16 a[152:153], v186 offset:0
    s_mov_b32 m0, 113664
    v_mfma_f32_16x16x32_bf16 v[76:79], a[136:139], a[168:171], v[76:79]
    ds_read_b64_tr_b16 a[154:155], v186 offset:3584
    buffer_load_dwordx4 v168, s[8:11], s28 offen offset:0 sc1 lds
    v_mfma_f32_16x16x32_bf16 v[84:87], a[140:143], a[168:171], v[84:87]
    ds_read_b128 a[116:119], v178 offset:1024
    v_mfma_f32_16x16x32_bf16 v[92:95], a[144:147], a[168:171], v[92:95]
    ds_read_b128 a[120:123], v178 offset:2048
    v_mfma_f32_16x16x32_bf16 v[72:75], a[132:135], a[172:175], v[72:75]
    ds_read_b128 a[124:127], v178 offset:3072
    v_mfma_f32_16x16x32_bf16 v[80:83], a[136:139], a[172:175], v[80:83]
    ds_read_b64_tr_b16 a[156:157], v186 offset:7168
    v_mfma_f32_16x16x32_bf16 v[88:91], a[140:143], a[172:175], v[88:91]
    ds_read_b64_tr_b16 a[158:159], v186 offset:10752
    v_mfma_f32_16x16x32_bf16 v[96:99], a[144:147], a[172:175], v[96:99]
    ds_read_b128 a[128:131], v180 offset:0
    s_mov_b32 m0, 114688
    v_mfma_f32_16x16x32_bf16 v[4:7], a[176:179], a[132:135], v[4:7]
    ds_read_b64_tr_b16 a[160:161], v186 offset:32
    buffer_load_dwordx4 v169, s[8:11], s28 offen offset:0 sc1 lds
    v_mfma_f32_16x16x32_bf16 v[12:15], a[176:179], a[136:139], v[12:15]
    ds_read_b64_tr_b16 a[162:163], v186 offset:3616
    v_mfma_f32_16x16x32_bf16 v[20:23], a[176:179], a[140:143], v[20:23]
    ds_read_b64_tr_b16 a[164:165], v186 offset:7200
    v_mfma_f32_16x16x32_bf16 v[28:31], a[176:179], a[144:147], v[28:31]
    ds_read_b64_tr_b16 a[166:167], v186 offset:10784
    v_mfma_f32_16x16x32_bf16 v[8:11], a[180:183], a[132:135], v[8:11]
    v_mfma_f32_16x16x32_bf16 v[16:19], a[180:183], a[136:139], v[16:19]
    v_mfma_f32_16x16x32_bf16 v[24:27], a[180:183], a[140:143], v[24:27]
    buffer_load_dwordx4 v170, s[8:11], s28 offen offset:1024 sc1 lds
    v_mfma_f32_16x16x32_bf16 v[32:35], a[180:183], a[144:147], v[32:35]
    ds_read_b64_tr_b16 a[172:173], v186 offset:7232
    s_waitcnt lgkmcnt(11)
    v_mfma_f32_16x16x32_bf16 a[0:3], a[152:155], a[112:115], a[0:3]
    ds_read_b64_tr_b16 a[168:169], v186 offset:64
    s_waitcnt lgkmcnt(11)
    v_mfma_f32_16x16x32_bf16 a[4:7], a[152:155], a[116:119], a[4:7]
    ds_read_b64_tr_b16 a[174:175], v186 offset:10816
    s_waitcnt lgkmcnt(11)
    v_mfma_f32_16x16x32_bf16 a[8:11], a[152:155], a[120:123], a[8:11]
    ds_read_b64_tr_b16 a[170:171], v186 offset:3648
    s_waitcnt lgkmcnt(11)
    v_mfma_f32_16x16x32_bf16 a[12:15], a[152:155], a[124:127], a[12:15]
    s_waitcnt lgkmcnt(9)
    v_mfma_f32_16x16x32_bf16 v[104:107], a[156:159], a[112:115], v[104:107]
    ds_read_b64_tr_b16 a[176:177], v186 offset:96
    v_mfma_f32_16x16x32_bf16 v[108:111], a[156:159], a[116:119], v[108:111]
    v_mfma_f32_16x16x32_bf16 v[112:115], a[156:159], a[120:123], v[112:115]
    ds_read_b64_tr_b16 a[178:179], v186 offset:3680
    v_mfma_f32_16x16x32_bf16 v[116:119], a[156:159], a[124:127], v[116:119]
    s_waitcnt lgkmcnt(8)
    v_mfma_f32_16x16x32_bf16 a[16:19], a[160:163], a[112:115], a[16:19]
    ds_read_b64_tr_b16 a[180:181], v186 offset:7264
    v_mfma_f32_16x16x32_bf16 a[20:23], a[160:163], a[116:119], a[20:23]
    buffer_load_dwordx4 v171, s[8:11], s28 offen offset:2048 sc1 lds
    v_mfma_f32_16x16x32_bf16 a[24:27], a[160:163], a[120:123], a[24:27]
    ds_read_b64_tr_b16 a[182:183], v186 offset:10848
    v_mfma_f32_16x16x32_bf16 a[28:31], a[160:163], a[124:127], a[28:31]
    s_waitcnt lgkmcnt(8)
    v_mfma_f32_16x16x32_bf16 v[120:123], a[164:167], a[112:115], v[120:123]
    ds_read_b64_tr_b16 a[152:153], v186 offset:128
    v_mfma_f32_16x16x32_bf16 v[124:127], a[164:167], a[116:119], v[124:127]
    v_mfma_f32_16x16x32_bf16 v[128:131], a[164:167], a[120:123], v[128:131]
    ds_read_b64_tr_b16 a[154:155], v186 offset:3712
    v_mfma_f32_16x16x32_bf16 v[132:135], a[164:167], a[124:127], v[132:135]
    s_waitcnt lgkmcnt(6)
    v_mfma_f32_16x16x32_bf16 a[32:35], a[168:171], a[112:115], a[32:35]
    ds_read_b64_tr_b16 a[156:157], v186 offset:7296
    v_mfma_f32_16x16x32_bf16 a[36:39], a[168:171], a[116:119], a[36:39]
    buffer_load_dwordx4 v172, s[8:11], s28 offen offset:3072 sc1 lds
    v_mfma_f32_16x16x32_bf16 a[40:43], a[168:171], a[120:123], a[40:43]
    ds_read_b64_tr_b16 a[158:159], v186 offset:10880
    v_mfma_f32_16x16x32_bf16 a[44:47], a[168:171], a[124:127], a[44:47]
    v_mfma_f32_16x16x32_bf16 v[136:139], a[172:175], a[112:115], v[136:139]
    ds_read_b64_tr_b16 a[160:161], v186 offset:160
    v_mfma_f32_16x16x32_bf16 v[140:143], a[172:175], a[116:119], v[140:143]
    s_mov_b32 m0, 118784
    v_mfma_f32_16x16x32_bf16 v[144:147], a[172:175], a[120:123], v[144:147]
    ds_read_b64_tr_b16 a[162:163], v186 offset:3744
    v_mfma_f32_16x16x32_bf16 v[148:151], a[172:175], a[124:127], v[148:151]
    s_waitcnt lgkmcnt(8)
    v_mfma_f32_16x16x32_bf16 a[48:51], a[176:179], a[112:115], a[48:51]
    ds_read_b64_tr_b16 a[164:165], v186 offset:7328
    v_mfma_f32_16x16x32_bf16 a[52:55], a[176:179], a[116:119], a[52:55]
    buffer_load_dwordx4 v173, s[8:11], s28 offen offset:0 sc1 lds
    v_mfma_f32_16x16x32_bf16 a[56:59], a[176:179], a[120:123], a[56:59]
    ds_read_b64_tr_b16 a[166:167], v186 offset:10912
    v_mfma_f32_16x16x32_bf16 a[60:63], a[176:179], a[124:127], a[60:63]
    ds_read_b64_tr_b16 a[172:173], v186 offset:7360
    s_waitcnt lgkmcnt(9)
    v_mfma_f32_16x16x32_bf16 v[152:155], a[180:183], a[112:115], v[152:155]
    ds_read_b64_tr_b16 a[168:169], v186 offset:192
    v_mfma_f32_16x16x32_bf16 v[156:159], a[180:183], a[116:119], v[156:159]
    ds_read_b64_tr_b16 a[174:175], v186 offset:10944
    v_mfma_f32_16x16x32_bf16 v[160:163], a[180:183], a[120:123], v[160:163]
    ds_read_b64_tr_b16 a[170:171], v186 offset:3776
    v_mfma_f32_16x16x32_bf16 v[164:167], a[180:183], a[124:127], v[164:167]
    s_waitcnt lgkmcnt(10)
    v_mfma_f32_16x16x32_bf16 a[64:67], a[152:155], a[112:115], a[64:67]
    ds_read_b64_tr_b16 a[176:177], v182 offset:17472
    v_mfma_f32_16x16x32_bf16 a[68:71], a[152:155], a[116:119], a[68:71]
    buffer_load_dwordx4 v174, s[8:11], s28 offen offset:1024 sc1 lds
    v_mfma_f32_16x16x32_bf16 a[72:75], a[152:155], a[120:123], a[72:75]
    ds_read_b64_tr_b16 a[178:179], v182 offset:20544
    v_mfma_f32_16x16x32_bf16 a[76:79], a[152:155], a[124:127], a[76:79]
    s_waitcnt lgkmcnt(10)
    v_mfma_f32_16x16x32_bf16 a[184:187], a[156:159], a[112:115], a[184:187]
    ds_read_b64_tr_b16 a[180:181], v184 offset:17472
    v_mfma_f32_16x16x32_bf16 a[188:191], a[156:159], a[116:119], a[188:191]
    v_mfma_f32_16x16x32_bf16 a[192:195], a[156:159], a[120:123], a[192:195]
    ds_read_b64_tr_b16 a[182:183], v184 offset:20544
    v_mfma_f32_16x16x32_bf16 a[196:199], a[156:159], a[124:127], a[196:199]
    s_waitcnt lgkmcnt(10)
    v_mfma_f32_16x16x32_bf16 a[80:83], a[160:163], a[112:115], a[80:83]
    ds_read_b64_tr_b16 a[152:153], v182 offset:17536
    v_mfma_f32_16x16x32_bf16 a[84:87], a[160:163], a[116:119], a[84:87]
    buffer_load_dwordx4 v175, s[8:11], s28 offen offset:2048 sc1 lds
    v_mfma_f32_16x16x32_bf16 a[88:91], a[160:163], a[120:123], a[88:91]
    ds_read_b64_tr_b16 a[154:155], v182 offset:20608
    v_mfma_f32_16x16x32_bf16 a[92:95], a[160:163], a[124:127], a[92:95]
    s_waitcnt lgkmcnt(10)
    v_mfma_f32_16x16x32_bf16 a[200:203], a[164:167], a[112:115], a[200:203]
    ds_read_b64_tr_b16 a[156:157], v184 offset:17536
    v_mfma_f32_16x16x32_bf16 a[204:207], a[164:167], a[116:119], a[204:207]
    v_mfma_f32_16x16x32_bf16 a[208:211], a[164:167], a[120:123], a[208:211]
    ds_read_b64_tr_b16 a[158:159], v184 offset:20608
    v_mfma_f32_16x16x32_bf16 a[212:215], a[164:167], a[124:127], a[212:215]
    s_waitcnt lgkmcnt(8)
    v_mfma_f32_16x16x32_bf16 a[96:99], a[168:171], a[112:115], a[96:99]
    ds_read_b64_tr_b16 a[160:161], v182 offset:17408
    v_mfma_f32_16x16x32_bf16 a[100:103], a[168:171], a[116:119], a[100:103]
    buffer_load_dwordx4 v176, s[8:11], s28 offen offset:3072 sc1 lds
    v_mfma_f32_16x16x32_bf16 a[104:107], a[168:171], a[120:123], a[104:107]
    ds_read_b64_tr_b16 a[162:163], v182 offset:20480
    v_mfma_f32_16x16x32_bf16 a[108:111], a[168:171], a[124:127], a[108:111]
    v_mfma_f32_16x16x32_bf16 a[216:219], a[172:175], a[112:115], a[216:219]
    ds_read_b64_tr_b16 a[164:165], v184 offset:17408
    v_mfma_f32_16x16x32_bf16 a[220:223], a[172:175], a[116:119], a[220:223]
    v_mfma_f32_16x16x32_bf16 a[224:227], a[172:175], a[120:123], a[224:227]
    ds_read_b64_tr_b16 a[166:167], v184 offset:20480
    v_mfma_f32_16x16x32_bf16 a[228:231], a[172:175], a[124:127], a[228:231]
    s_waitcnt lgkmcnt(10)
    v_mfma_f32_16x16x32_bf16 v[36:39], a[176:179], a[112:115], v[36:39]
    v_mfma_f32_16x16x32_bf16 v[44:47], a[176:179], a[116:119], v[44:47]
    v_mfma_f32_16x16x32_bf16 v[52:55], a[176:179], a[120:123], v[52:55]
    v_mfma_f32_16x16x32_bf16 v[60:63], a[176:179], a[124:127], v[60:63]
    v_mfma_f32_16x16x32_bf16 v[100:103], a[176:179], a[128:131], v[100:103]
    s_waitcnt lgkmcnt(8)
    v_mfma_f32_16x16x32_bf16 v[40:43], a[180:183], a[112:115], v[40:43]
    buffer_load_dword v196, v197, s[48:51], s60 offen
    v_mfma_f32_16x16x32_bf16 v[48:51], a[180:183], a[116:119], v[48:51]
    s_add_u32 s28, s28, 131072
    s_add_u32 s60, s60, 3584
    v_mfma_f32_16x16x32_bf16 v[56:59], a[180:183], a[120:123], v[56:59]
    v_mfma_f32_16x16x32_bf16 v[64:67], a[180:183], a[124:127], v[64:67]
    s_waitcnt vmcnt(19) lgkmcnt(0)
    s_barrier
    ds_read_b128 a[132:135], v178 offset:37888
    v_mfma_f32_16x16x32_bf16 v[68:71], a[112:115], a[152:155], v[68:71]
    ds_read_b64_tr_b16 a[168:169], v186 offset:37888
    s_mov_b32 m0, 0
    v_mfma_f32_16x16x32_bf16 v[76:79], a[116:119], a[152:155], v[76:79]
    ds_read_b64_tr_b16 a[170:171], v186 offset:41472
    buffer_load_dwordx4 v168, s[8:11], s28 offen offset:0 sc1 lds
    v_mfma_f32_16x16x32_bf16 v[84:87], a[120:123], a[152:155], v[84:87]
    ds_read_b128 a[136:139], v178 offset:38912
    v_mfma_f32_16x16x32_bf16 v[92:95], a[124:127], a[152:155], v[92:95]
    ds_read_b128 a[140:143], v178 offset:39936
    v_mfma_f32_16x16x32_bf16 v[72:75], a[112:115], a[156:159], v[72:75]
    ds_read_b128 a[144:147], v178 offset:40960
    v_mfma_f32_16x16x32_bf16 v[80:83], a[116:119], a[156:159], v[80:83]
    ds_read_b64_tr_b16 a[172:173], v186 offset:45056
    v_mfma_f32_16x16x32_bf16 v[88:91], a[120:123], a[156:159], v[88:91]
    ds_read_b64_tr_b16 a[174:175], v186 offset:48640
    v_mfma_f32_16x16x32_bf16 v[96:99], a[124:127], a[156:159], v[96:99]
    ds_read_b128 a[148:151], v180 offset:37888
    s_mov_b32 m0, 1024
    v_mfma_f32_16x16x32_bf16 v[4:7], a[160:163], a[112:115], v[4:7]
    ds_read_b64_tr_b16 a[176:177], v186 offset:37920
    buffer_load_dwordx4 v169, s[8:11], s28 offen offset:0 sc1 lds
    v_mfma_f32_16x16x32_bf16 v[12:15], a[160:163], a[116:119], v[12:15]
    ds_read_b64_tr_b16 a[178:179], v186 offset:41504
    v_mfma_f32_16x16x32_bf16 v[20:23], a[160:163], a[120:123], v[20:23]
    ds_read_b64_tr_b16 a[180:181], v186 offset:45088
    v_mfma_f32_16x16x32_bf16 v[28:31], a[160:163], a[124:127], v[28:31]
    ds_read_b64_tr_b16 a[182:183], v186 offset:48672
    v_mfma_f32_16x16x32_bf16 v[8:11], a[164:167], a[112:115], v[8:11]
    v_mfma_f32_16x16x32_bf16 v[16:19], a[164:167], a[116:119], v[16:19]
    v_mfma_f32_16x16x32_bf16 v[24:27], a[164:167], a[120:123], v[24:27]
    buffer_load_dwordx4 v170, s[8:11], s28 offen offset:1024 sc1 lds
    v_mfma_f32_16x16x32_bf16 v[32:35], a[164:167], a[124:127], v[32:35]
    ds_read_b64_tr_b16 a[156:157], v186 offset:45120
    s_waitcnt lgkmcnt(11)
    v_mfma_f32_16x16x32_bf16 a[0:3], a[168:171], a[132:135], a[0:3]
    ds_read_b64_tr_b16 a[152:153], v186 offset:37952
    s_waitcnt lgkmcnt(11)
    v_mfma_f32_16x16x32_bf16 a[4:7], a[168:171], a[136:139], a[4:7]
    ds_read_b64_tr_b16 a[158:159], v186 offset:48704
    s_waitcnt lgkmcnt(11)
    v_mfma_f32_16x16x32_bf16 a[8:11], a[168:171], a[140:143], a[8:11]
    ds_read_b64_tr_b16 a[154:155], v186 offset:41536
    s_waitcnt lgkmcnt(11)
    v_mfma_f32_16x16x32_bf16 a[12:15], a[168:171], a[144:147], a[12:15]
    s_waitcnt lgkmcnt(9)
    v_mfma_f32_16x16x32_bf16 v[104:107], a[172:175], a[132:135], v[104:107]
    ds_read_b64_tr_b16 a[160:161], v186 offset:37984
    v_mfma_f32_16x16x32_bf16 v[108:111], a[172:175], a[136:139], v[108:111]
    v_mfma_f32_16x16x32_bf16 v[112:115], a[172:175], a[140:143], v[112:115]
    ds_read_b64_tr_b16 a[162:163], v186 offset:41568
    v_mfma_f32_16x16x32_bf16 v[116:119], a[172:175], a[144:147], v[116:119]
    s_waitcnt lgkmcnt(8)
    v_mfma_f32_16x16x32_bf16 a[16:19], a[176:179], a[132:135], a[16:19]
    ds_read_b64_tr_b16 a[164:165], v186 offset:45152
    v_mfma_f32_16x16x32_bf16 a[20:23], a[176:179], a[136:139], a[20:23]
    buffer_load_dwordx4 v171, s[8:11], s28 offen offset:2048 sc1 lds
    v_mfma_f32_16x16x32_bf16 a[24:27], a[176:179], a[140:143], a[24:27]
    ds_read_b64_tr_b16 a[166:167], v186 offset:48736
    v_mfma_f32_16x16x32_bf16 a[28:31], a[176:179], a[144:147], a[28:31]
    s_waitcnt lgkmcnt(8)
    v_mfma_f32_16x16x32_bf16 v[120:123], a[180:183], a[132:135], v[120:123]
    ds_read_b64_tr_b16 a[168:169], v186 offset:38016
    v_mfma_f32_16x16x32_bf16 v[124:127], a[180:183], a[136:139], v[124:127]
    v_mfma_f32_16x16x32_bf16 v[128:131], a[180:183], a[140:143], v[128:131]
    ds_read_b64_tr_b16 a[170:171], v186 offset:41600
    v_mfma_f32_16x16x32_bf16 v[132:135], a[180:183], a[144:147], v[132:135]
    s_waitcnt lgkmcnt(6)
    v_mfma_f32_16x16x32_bf16 a[32:35], a[152:155], a[132:135], a[32:35]
    ds_read_b64_tr_b16 a[172:173], v186 offset:45184
    v_mfma_f32_16x16x32_bf16 a[36:39], a[152:155], a[136:139], a[36:39]
    buffer_load_dwordx4 v172, s[8:11], s28 offen offset:3072 sc1 lds
    v_mfma_f32_16x16x32_bf16 a[40:43], a[152:155], a[140:143], a[40:43]
    ds_read_b64_tr_b16 a[174:175], v186 offset:48768
    v_mfma_f32_16x16x32_bf16 a[44:47], a[152:155], a[144:147], a[44:47]
    v_mfma_f32_16x16x32_bf16 v[136:139], a[156:159], a[132:135], v[136:139]
    ds_read_b64_tr_b16 a[176:177], v186 offset:38048
    v_mfma_f32_16x16x32_bf16 v[140:143], a[156:159], a[136:139], v[140:143]
    s_mov_b32 m0, 5120
    v_mfma_f32_16x16x32_bf16 v[144:147], a[156:159], a[140:143], v[144:147]
    ds_read_b64_tr_b16 a[178:179], v186 offset:41632
    v_mfma_f32_16x16x32_bf16 v[148:151], a[156:159], a[144:147], v[148:151]
    s_waitcnt lgkmcnt(8)
    v_mfma_f32_16x16x32_bf16 a[48:51], a[160:163], a[132:135], a[48:51]
    ds_read_b64_tr_b16 a[180:181], v186 offset:45216
    v_mfma_f32_16x16x32_bf16 a[52:55], a[160:163], a[136:139], a[52:55]
    buffer_load_dwordx4 v173, s[8:11], s28 offen offset:0 sc1 lds
    v_mfma_f32_16x16x32_bf16 a[56:59], a[160:163], a[140:143], a[56:59]
    ds_read_b64_tr_b16 a[182:183], v186 offset:48800
    v_mfma_f32_16x16x32_bf16 a[60:63], a[160:163], a[144:147], a[60:63]
    ds_read_b64_tr_b16 a[156:157], v186 offset:45248
    s_waitcnt lgkmcnt(9)
    v_mfma_f32_16x16x32_bf16 v[152:155], a[164:167], a[132:135], v[152:155]
    ds_read_b64_tr_b16 a[152:153], v186 offset:38080
    v_mfma_f32_16x16x32_bf16 v[156:159], a[164:167], a[136:139], v[156:159]
    ds_read_b64_tr_b16 a[158:159], v186 offset:48832
    v_mfma_f32_16x16x32_bf16 v[160:163], a[164:167], a[140:143], v[160:163]
    ds_read_b64_tr_b16 a[154:155], v186 offset:41664
    v_mfma_f32_16x16x32_bf16 v[164:167], a[164:167], a[144:147], v[164:167]
    s_waitcnt lgkmcnt(10)
    v_mfma_f32_16x16x32_bf16 a[64:67], a[168:171], a[132:135], a[64:67]
    ds_read_b64_tr_b16 a[160:161], v182 offset:55360
    v_mfma_f32_16x16x32_bf16 a[68:71], a[168:171], a[136:139], a[68:71]
    buffer_load_dwordx4 v174, s[8:11], s28 offen offset:1024 sc1 lds
    v_mfma_f32_16x16x32_bf16 a[72:75], a[168:171], a[140:143], a[72:75]
    ds_read_b64_tr_b16 a[162:163], v182 offset:58432
    v_mfma_f32_16x16x32_bf16 a[76:79], a[168:171], a[144:147], a[76:79]
    s_waitcnt lgkmcnt(10)
    v_mfma_f32_16x16x32_bf16 a[184:187], a[172:175], a[132:135], a[184:187]
    ds_read_b64_tr_b16 a[164:165], v184 offset:55360
    v_mfma_f32_16x16x32_bf16 a[188:191], a[172:175], a[136:139], a[188:191]
    v_mfma_f32_16x16x32_bf16 a[192:195], a[172:175], a[140:143], a[192:195]
    ds_read_b64_tr_b16 a[166:167], v184 offset:58432
    v_mfma_f32_16x16x32_bf16 a[196:199], a[172:175], a[144:147], a[196:199]
    s_waitcnt lgkmcnt(10)
    v_mfma_f32_16x16x32_bf16 a[80:83], a[176:179], a[132:135], a[80:83]
    ds_read_b64_tr_b16 a[168:169], v182 offset:55424
    v_mfma_f32_16x16x32_bf16 a[84:87], a[176:179], a[136:139], a[84:87]
    buffer_load_dwordx4 v175, s[8:11], s28 offen offset:2048 sc1 lds
    v_mfma_f32_16x16x32_bf16 a[88:91], a[176:179], a[140:143], a[88:91]
    ds_read_b64_tr_b16 a[170:171], v182 offset:58496
    v_mfma_f32_16x16x32_bf16 a[92:95], a[176:179], a[144:147], a[92:95]
    s_waitcnt lgkmcnt(10)
    v_mfma_f32_16x16x32_bf16 a[200:203], a[180:183], a[132:135], a[200:203]
    ds_read_b64_tr_b16 a[172:173], v184 offset:55424
    v_mfma_f32_16x16x32_bf16 a[204:207], a[180:183], a[136:139], a[204:207]
    v_mfma_f32_16x16x32_bf16 a[208:211], a[180:183], a[140:143], a[208:211]
    ds_read_b64_tr_b16 a[174:175], v184 offset:58496
    v_mfma_f32_16x16x32_bf16 a[212:215], a[180:183], a[144:147], a[212:215]
    s_waitcnt lgkmcnt(8)
    v_mfma_f32_16x16x32_bf16 a[96:99], a[152:155], a[132:135], a[96:99]
    ds_read_b64_tr_b16 a[176:177], v182 offset:55296
    v_mfma_f32_16x16x32_bf16 a[100:103], a[152:155], a[136:139], a[100:103]
    buffer_load_dwordx4 v176, s[8:11], s28 offen offset:3072 sc1 lds
    v_mfma_f32_16x16x32_bf16 a[104:107], a[152:155], a[140:143], a[104:107]
    ds_read_b64_tr_b16 a[178:179], v182 offset:58368
    v_mfma_f32_16x16x32_bf16 a[108:111], a[152:155], a[144:147], a[108:111]
    v_mfma_f32_16x16x32_bf16 a[216:219], a[156:159], a[132:135], a[216:219]
    ds_read_b64_tr_b16 a[180:181], v184 offset:55296
    v_mfma_f32_16x16x32_bf16 a[220:223], a[156:159], a[136:139], a[220:223]
    v_mfma_f32_16x16x32_bf16 a[224:227], a[156:159], a[140:143], a[224:227]
    ds_read_b64_tr_b16 a[182:183], v184 offset:58368
    v_mfma_f32_16x16x32_bf16 a[228:231], a[156:159], a[144:147], a[228:231]
    s_waitcnt lgkmcnt(10)
    v_mfma_f32_16x16x32_bf16 v[36:39], a[160:163], a[132:135], v[36:39]
    v_mfma_f32_16x16x32_bf16 v[44:47], a[160:163], a[136:139], v[44:47]
    v_mfma_f32_16x16x32_bf16 v[52:55], a[160:163], a[140:143], v[52:55]
    v_mfma_f32_16x16x32_bf16 v[60:63], a[160:163], a[144:147], v[60:63]
    v_mfma_f32_16x16x32_bf16 v[100:103], a[160:163], a[148:151], v[100:103]
    s_waitcnt lgkmcnt(8)
    v_mfma_f32_16x16x32_bf16 v[40:43], a[164:167], a[132:135], v[40:43]
    v_mfma_f32_16x16x32_bf16 v[48:51], a[164:167], a[136:139], v[48:51]
    s_add_u32 s28, s28, 131072
    v_mfma_f32_16x16x32_bf16 v[56:59], a[164:167], a[140:143], v[56:59]
    v_mfma_f32_16x16x32_bf16 v[64:67], a[164:167], a[144:147], v[64:67]
    s_waitcnt vmcnt(19) lgkmcnt(0)
    s_barrier
    s_cmp_eq_u32 s31, 1
    s_cbranch_scc1 L_g1_fin
    ds_read_b128 a[112:115], v179 offset:0
    v_mfma_f32_16x16x32_bf16 v[68:71], a[132:135], a[168:171], v[68:71]
    ds_read_b64_tr_b16 a[152:153], v187 offset:0
    s_mov_b32 m0, 37888
    v_mfma_f32_16x16x32_bf16 v[76:79], a[136:139], a[168:171], v[76:79]
    ds_read_b64_tr_b16 a[154:155], v187 offset:3584
    buffer_load_dwordx4 v168, s[8:11], s28 offen offset:0 sc1 lds
    v_mfma_f32_16x16x32_bf16 v[84:87], a[140:143], a[168:171], v[84:87]
    ds_read_b128 a[116:119], v179 offset:1024
    v_mfma_f32_16x16x32_bf16 v[92:95], a[144:147], a[168:171], v[92:95]
    ds_read_b128 a[120:123], v179 offset:2048
    v_mfma_f32_16x16x32_bf16 v[72:75], a[132:135], a[172:175], v[72:75]
    ds_read_b128 a[124:127], v179 offset:3072
    v_mfma_f32_16x16x32_bf16 v[80:83], a[136:139], a[172:175], v[80:83]
    ds_read_b64_tr_b16 a[156:157], v187 offset:7168
    v_mfma_f32_16x16x32_bf16 v[88:91], a[140:143], a[172:175], v[88:91]
    ds_read_b64_tr_b16 a[158:159], v187 offset:10752
    v_mfma_f32_16x16x32_bf16 v[96:99], a[144:147], a[172:175], v[96:99]
    ds_read_b128 a[128:131], v181 offset:0
    s_mov_b32 m0, 38912
    v_mfma_f32_16x16x32_bf16 v[4:7], a[176:179], a[132:135], v[4:7]
    ds_read_b64_tr_b16 a[160:161], v187 offset:32
    buffer_load_dwordx4 v169, s[8:11], s28 offen offset:0 sc1 lds
    v_mfma_f32_16x16x32_bf16 v[12:15], a[176:179], a[136:139], v[12:15]
    ds_read_b64_tr_b16 a[162:163], v187 offset:3616
    v_mfma_f32_16x16x32_bf16 v[20:23], a[176:179], a[140:143], v[20:23]
    ds_read_b64_tr_b16 a[164:165], v187 offset:7200
    v_mfma_f32_16x16x32_bf16 v[28:31], a[176:179], a[144:147], v[28:31]
    ds_read_b64_tr_b16 a[166:167], v187 offset:10784
    v_mfma_f32_16x16x32_bf16 v[8:11], a[180:183], a[132:135], v[8:11]
    v_mfma_f32_16x16x32_bf16 v[16:19], a[180:183], a[136:139], v[16:19]
    v_mfma_f32_16x16x32_bf16 v[24:27], a[180:183], a[140:143], v[24:27]
    buffer_load_dwordx4 v170, s[8:11], s28 offen offset:1024 sc1 lds
    v_mfma_f32_16x16x32_bf16 v[32:35], a[180:183], a[144:147], v[32:35]
    ds_read_b64_tr_b16 a[172:173], v187 offset:7232
    s_waitcnt lgkmcnt(11)
    v_mfma_f32_16x16x32_bf16 a[0:3], a[152:155], a[112:115], a[0:3]
    ds_read_b64_tr_b16 a[168:169], v187 offset:64
    s_waitcnt lgkmcnt(11)
    v_mfma_f32_16x16x32_bf16 a[4:7], a[152:155], a[116:119], a[4:7]
    ds_read_b64_tr_b16 a[174:175], v187 offset:10816
    s_waitcnt lgkmcnt(11)
    v_mfma_f32_16x16x32_bf16 a[8:11], a[152:155], a[120:123], a[8:11]
    ds_read_b64_tr_b16 a[170:171], v187 offset:3648
    s_waitcnt lgkmcnt(11)
    v_mfma_f32_16x16x32_bf16 a[12:15], a[152:155], a[124:127], a[12:15]
    s_waitcnt lgkmcnt(9)
    v_mfma_f32_16x16x32_bf16 v[104:107], a[156:159], a[112:115], v[104:107]
    ds_read_b64_tr_b16 a[176:177], v187 offset:96
    v_mfma_f32_16x16x32_bf16 v[108:111], a[156:159], a[116:119], v[108:111]
    v_mfma_f32_16x16x32_bf16 v[112:115], a[156:159], a[120:123], v[112:115]
    ds_read_b64_tr_b16 a[178:179], v187 offset:3680
    v_mfma_f32_16x16x32_bf16 v[116:119], a[156:159], a[124:127], v[116:119]
    s_waitcnt lgkmcnt(8)
    v_mfma_f32_16x16x32_bf16 a[16:19], a[160:163], a[112:115], a[16:19]
    ds_read_b64_tr_b16 a[180:181], v187 offset:7264
    v_mfma_f32_16x16x32_bf16 a[20:23], a[160:163], a[116:119], a[20:23]
    buffer_load_dwordx4 v171, s[8:11], s28 offen offset:2048 sc1 lds
    v_mfma_f32_16x16x32_bf16 a[24:27], a[160:163], a[120:123], a[24:27]
    ds_read_b64_tr_b16 a[182:183], v187 offset:10848
    v_mfma_f32_16x16x32_bf16 a[28:31], a[160:163], a[124:127], a[28:31]
    s_waitcnt lgkmcnt(8)
    v_mfma_f32_16x16x32_bf16 v[120:123], a[164:167], a[112:115], v[120:123]
    ds_read_b64_tr_b16 a[152:153], v187 offset:128
    v_mfma_f32_16x16x32_bf16 v[124:127], a[164:167], a[116:119], v[124:127]
    v_mfma_f32_16x16x32_bf16 v[128:131], a[164:167], a[120:123], v[128:131]
    ds_read_b64_tr_b16 a[154:155], v187 offset:3712
    v_mfma_f32_16x16x32_bf16 v[132:135], a[164:167], a[124:127], v[132:135]
    s_waitcnt lgkmcnt(6)
    v_mfma_f32_16x16x32_bf16 a[32:35], a[168:171], a[112:115], a[32:35]
    ds_read_b64_tr_b16 a[156:157], v187 offset:7296
    v_mfma_f32_16x16x32_bf16 a[36:39], a[168:171], a[116:119], a[36:39]
    buffer_load_dwordx4 v172, s[8:11], s28 offen offset:3072 sc1 lds
    v_mfma_f32_16x16x32_bf16 a[40:43], a[168:171], a[120:123], a[40:43]
    ds_read_b64_tr_b16 a[158:159], v187 offset:10880
    v_mfma_f32_16x16x32_bf16 a[44:47], a[168:171], a[124:127], a[44:47]
    v_mfma_f32_16x16x32_bf16 v[136:139], a[172:175], a[112:115], v[136:139]
    ds_read_b64_tr_b16 a[160:161], v187 offset:160
    v_mfma_f32_16x16x32_bf16 v[140:143], a[172:175], a[116:119], v[140:143]
    s_mov_b32 m0, 43008
    v_mfma_f32_16x16x32_bf16 v[144:147], a[172:175], a[120:123], v[144:147]
    ds_read_b64_tr_b16 a[162:163], v187 offset:3744
    v_mfma_f32_16x16x32_bf16 v[148:151], a[172:175], a[124:127], v[148:151]
    s_waitcnt lgkmcnt(8)
    v_mfma_f32_16x16x32_bf16 a[48:51], a[176:179], a[112:115], a[48:51]
    ds_read_b64_tr_b16 a[164:165], v187 offset:7328
    v_mfma_f32_16x16x32_bf16 a[52:55], a[176:179], a[116:119], a[52:55]
    buffer_load_dwordx4 v173, s[8:11], s28 offen offset:0 sc1 lds
    v_mfma_f32_16x16x32_bf16 a[56:59], a[176:179], a[120:123], a[56:59]
    ds_read_b64_tr_b16 a[166:167], v187 offset:10912
    v_mfma_f32_16x16x32_bf16 a[60:63], a[176:179], a[124:127], a[60:63]
    ds_read_b64_tr_b16 a[172:173], v187 offset:7360
    s_waitcnt lgkmcnt(9)
    v_mfma_f32_16x16x32_bf16 v[152:155], a[180:183], a[112:115], v[152:155]
    ds_read_b64_tr_b16 a[168:169], v187 offset:192
    v_mfma_f32_16x16x32_bf16 v[156:159], a[180:183], a[116:119], v[156:159]
    ds_read_b64_tr_b16 a[174:175], v187 offset:10944
    v_mfma_f32_16x16x32_bf16 v[160:163], a[180:183], a[120:123], v[160:163]
    ds_read_b64_tr_b16 a[170:171], v187 offset:3776
    v_mfma_f32_16x16x32_bf16 v[164:167], a[180:183], a[124:127], v[164:167]
    s_waitcnt lgkmcnt(10)
    v_mfma_f32_16x16x32_bf16 a[64:67], a[152:155], a[112:115], a[64:67]
    ds_read_b64_tr_b16 a[176:177], v183 offset:17472
    v_mfma_f32_16x16x32_bf16 a[68:71], a[152:155], a[116:119], a[68:71]
    buffer_load_dwordx4 v174, s[8:11], s28 offen offset:1024 sc1 lds
    v_mfma_f32_16x16x32_bf16 a[72:75], a[152:155], a[120:123], a[72:75]
    ds_read_b64_tr_b16 a[178:179], v183 offset:20544
    v_mfma_f32_16x16x32_bf16 a[76:79], a[152:155], a[124:127], a[76:79]
    s_waitcnt lgkmcnt(10)
    v_mfma_f32_16x16x32_bf16 a[184:187], a[156:159], a[112:115], a[184:187]
    ds_read_b64_tr_b16 a[180:181], v185 offset:17472
    v_mfma_f32_16x16x32_bf16 a[188:191], a[156:159], a[116:119], a[188:191]
    v_mfma_f32_16x16x32_bf16 a[192:195], a[156:159], a[120:123], a[192:195]
    ds_read_b64_tr_b16 a[182:183], v185 offset:20544
    v_mfma_f32_16x16x32_bf16 a[196:199], a[156:159], a[124:127], a[196:199]
    s_waitcnt lgkmcnt(10)
    v_mfma_f32_16x16x32_bf16 a[80:83], a[160:163], a[112:115], a[80:83]
    ds_read_b64_tr_b16 a[152:153], v183 offset:17536
    v_mfma_f32_16x16x32_bf16 a[84:87], a[160:163], a[116:119], a[84:87]
    buffer_load_dwordx4 v175, s[8:11], s28 offen offset:2048 sc1 lds
    v_mfma_f32_16x16x32_bf16 a[88:91], a[160:163], a[120:123], a[88:91]
    ds_read_b64_tr_b16 a[154:155], v183 offset:20608
    v_mfma_f32_16x16x32_bf16 a[92:95], a[160:163], a[124:127], a[92:95]
    s_waitcnt lgkmcnt(10)
    v_mfma_f32_16x16x32_bf16 a[200:203], a[164:167], a[112:115], a[200:203]
    ds_read_b64_tr_b16 a[156:157], v185 offset:17536
    v_mfma_f32_16x16x32_bf16 a[204:207], a[164:167], a[116:119], a[204:207]
    v_mfma_f32_16x16x32_bf16 a[208:211], a[164:167], a[120:123], a[208:211]
    ds_read_b64_tr_b16 a[158:159], v185 offset:20608
    v_mfma_f32_16x16x32_bf16 a[212:215], a[164:167], a[124:127], a[212:215]
    s_waitcnt lgkmcnt(8)
    v_mfma_f32_16x16x32_bf16 a[96:99], a[168:171], a[112:115], a[96:99]
    ds_read_b64_tr_b16 a[160:161], v183 offset:17408
    v_mfma_f32_16x16x32_bf16 a[100:103], a[168:171], a[116:119], a[100:103]
    buffer_load_dwordx4 v176, s[8:11], s28 offen offset:3072 sc1 lds
    v_mfma_f32_16x16x32_bf16 a[104:107], a[168:171], a[120:123], a[104:107]
    ds_read_b64_tr_b16 a[162:163], v183 offset:20480
    v_mfma_f32_16x16x32_bf16 a[108:111], a[168:171], a[124:127], a[108:111]
    v_mfma_f32_16x16x32_bf16 a[216:219], a[172:175], a[112:115], a[216:219]
    ds_read_b64_tr_b16 a[164:165], v185 offset:17408
    v_mfma_f32_16x16x32_bf16 a[220:223], a[172:175], a[116:119], a[220:223]
    v_mfma_f32_16x16x32_bf16 a[224:227], a[172:175], a[120:123], a[224:227]
    ds_read_b64_tr_b16 a[166:167], v185 offset:20480
    v_mfma_f32_16x16x32_bf16 a[228:231], a[172:175], a[124:127], a[228:231]
    s_waitcnt lgkmcnt(10)
    v_mfma_f32_16x16x32_bf16 v[36:39], a[176:179], a[112:115], v[36:39]
    v_mfma_f32_16x16x32_bf16 v[44:47], a[176:179], a[116:119], v[44:47]
    v_mfma_f32_16x16x32_bf16 v[52:55], a[176:179], a[120:123], v[52:55]
    v_mfma_f32_16x16x32_bf16 v[60:63], a[176:179], a[124:127], v[60:63]
    v_mfma_f32_16x16x32_bf16 v[100:103], a[176:179], a[128:131], v[100:103]
    s_waitcnt lgkmcnt(8)
    v_mfma_f32_16x16x32_bf16 v[40:43], a[180:183], a[112:115], v[40:43]
    v_mfma_f32_16x16x32_bf16 v[48:51], a[180:183], a[116:119], v[48:51]
    s_add_u32 s28, s28, 131072
    v_mfma_f32_16x16x32_bf16 v[56:59], a[180:183], a[120:123], v[56:59]
    v_mfma_f32_16x16x32_bf16 v[64:67], a[180:183], a[124:127], v[64:67]
    s_waitcnt vmcnt(19) lgkmcnt(0)
    s_barrier
    ds_read_b128 a[132:135], v179 offset:37888
    v_mfma_f32_16x16x32_bf16 v[68:71], a[112:115], a[152:155], v[68:71]
    ds_read_b64_tr_b16 a[168:169], v187 offset:37888
    s_mov_b32 m0, 75776
    v_mfma_f32_16x16x32_bf16 v[76:79], a[116:119], a[152:155], v[76:79]
    ds_read_b64_tr_b16 a[170:171], v187 offset:41472
    buffer_load_dwordx4 v168, s[8:11], s28 offen offset:0 sc1 lds
    v_mfma_f32_16x16x32_bf16 v[84:87], a[120:123], a[152:155], v[84:87]
    ds_read_b128 a[136:139], v179 offset:38912
    v_mfma_f32_16x16x32_bf16 v[92:95], a[124:127], a[152:155], v[92:95]
    ds_read_b128 a[140:143], v179 offset:39936
    v_mfma_f32_16x16x32_bf16 v[72:75], a[112:115], a[156:159], v[72:75]
    ds_read_b128 a[144:147], v179 offset:40960
    v_mfma_f32_16x16x32_bf16 v[80:83], a[116:119], a[156:159], v[80:83]
    ds_read_b64_tr_b16 a[172:173], v187 offset:45056
    v_mfma_f32_16x16x32_bf16 v[88:91], a[120:123], a[156:159], v[88:91]
    ds_read_b64_tr_b16 a[174:175], v187 offset:48640
    v_mfma_f32_16x16x32_bf16 v[96:99], a[124:127], a[156:159], v[96:99]
    ds_read_b128 a[148:151], v181 offset:37888
    s_mov_b32 m0, 76800
    v_mfma_f32_16x16x32_bf16 v[4:7], a[160:163], a[112:115], v[4:7]
    ds_read_b64_tr_b16 a[176:177], v187 offset:37920
    buffer_load_dwordx4 v169, s[8:11], s28 offen offset:0 sc1 lds
    v_mfma_f32_16x16x32_bf16 v[12:15], a[160:163], a[116:119], v[12:15]
    ds_read_b64_tr_b16 a[178:179], v187 offset:41504
    v_mfma_f32_16x16x32_bf16 v[20:23], a[160:163], a[120:123], v[20:23]
    ds_read_b64_tr_b16 a[180:181], v187 offset:45088
    v_mfma_f32_16x16x32_bf16 v[28:31], a[160:163], a[124:127], v[28:31]
    ds_read_b64_tr_b16 a[182:183], v187 offset:48672
    v_mfma_f32_16x16x32_bf16 v[8:11], a[164:167], a[112:115], v[8:11]
    v_mfma_f32_16x16x32_bf16 v[16:19], a[164:167], a[116:119], v[16:19]
    v_mfma_f32_16x16x32_bf16 v[24:27], a[164:167], a[120:123], v[24:27]
    buffer_load_dwordx4 v170, s[8:11], s28 offen offset:1024 sc1 lds
    v_mfma_f32_16x16x32_bf16 v[32:35], a[164:167], a[124:127], v[32:35]
    ds_read_b64_tr_b16 a[156:157], v187 offset:45120
    s_waitcnt lgkmcnt(11)
    v_mfma_f32_16x16x32_bf16 a[0:3], a[168:171], a[132:135], a[0:3]
    ds_read_b64_tr_b16 a[152:153], v187 offset:37952
    s_waitcnt lgkmcnt(11)
    v_mfma_f32_16x16x32_bf16 a[4:7], a[168:171], a[136:139], a[4:7]
    ds_read_b64_tr_b16 a[158:159], v187 offset:48704
    s_waitcnt lgkmcnt(11)
    v_mfma_f32_16x16x32_bf16 a[8:11], a[168:171], a[140:143], a[8:11]
    ds_read_b64_tr_b16 a[154:155], v187 offset:41536
    s_waitcnt lgkmcnt(11)
    v_mfma_f32_16x16x32_bf16 a[12:15], a[168:171], a[144:147], a[12:15]
    s_waitcnt lgkmcnt(9)
    v_mfma_f32_16x16x32_bf16 v[104:107], a[172:175], a[132:135], v[104:107]
    ds_read_b64_tr_b16 a[160:161], v187 offset:37984
    v_mfma_f32_16x16x32_bf16 v[108:111], a[172:175], a[136:139], v[108:111]
    v_mfma_f32_16x16x32_bf16 v[112:115], a[172:175], a[140:143], v[112:115]
    ds_read_b64_tr_b16 a[162:163], v187 offset:41568
    v_mfma_f32_16x16x32_bf16 v[116:119], a[172:175], a[144:147], v[116:119]
    s_waitcnt lgkmcnt(8)
    v_mfma_f32_16x16x32_bf16 a[16:19], a[176:179], a[132:135], a[16:19]
    ds_read_b64_tr_b16 a[164:165], v187 offset:45152
    v_mfma_f32_16x16x32_bf16 a[20:23], a[176:179], a[136:139], a[20:23]
    buffer_load_dwordx4 v171, s[8:11], s28 offen offset:2048 sc1 lds
    v_mfma_f32_16x16x32_bf16 a[24:27], a[176:179], a[140:143], a[24:27]
    ds_read_b64_tr_b16 a[166:167], v187 offset:48736
    v_mfma_f32_16x16x32_bf16 a[28:31], a[176:179], a[144:147], a[28:31]
    s_waitcnt lgkmcnt(8)
    v_mfma_f32_16x16x32_bf16 v[120:123], a[180:183], a[132:135], v[120:123]
    ds_read_b64_tr_b16 a[168:169], v187 offset:38016
    v_mfma_f32_16x16x32_bf16 v[124:127], a[180:183], a[136:139], v[124:127]
    v_mfma_f32_16x16x32_bf16 v[128:131], a[180:183], a[140:143], v[128:131]
    ds_read_b64_tr_b16 a[170:171], v187 offset:41600
    v_mfma_f32_16x16x32_bf16 v[132:135], a[180:183], a[144:147], v[132:135]
    s_waitcnt lgkmcnt(6)
    v_mfma_f32_16x16x32_bf16 a[32:35], a[152:155], a[132:135], a[32:35]
    ds_read_b64_tr_b16 a[172:173], v187 offset:45184
    v_mfma_f32_16x16x32_bf16 a[36:39], a[152:155], a[136:139], a[36:39]
    buffer_load_dwordx4 v172, s[8:11], s28 offen offset:3072 sc1 lds
    v_mfma_f32_16x16x32_bf16 a[40:43], a[152:155], a[140:143], a[40:43]
    ds_read_b64_tr_b16 a[174:175], v187 offset:48768
    v_mfma_f32_16x16x32_bf16 a[44:47], a[152:155], a[144:147], a[44:47]
    v_mfma_f32_16x16x32_bf16 v[136:139], a[156:159], a[132:135], v[136:139]
    ds_read_b64_tr_b16 a[176:177], v187 offset:38048
    v_mfma_f32_16x16x32_bf16 v[140:143], a[156:159], a[136:139], v[140:143]
    s_mov_b32 m0, 80896
    v_mfma_f32_16x16x32_bf16 v[144:147], a[156:159], a[140:143], v[144:147]
    ds_read_b64_tr_b16 a[178:179], v187 offset:41632
    v_mfma_f32_16x16x32_bf16 v[148:151], a[156:159], a[144:147], v[148:151]
    s_waitcnt lgkmcnt(8)
    v_mfma_f32_16x16x32_bf16 a[48:51], a[160:163], a[132:135], a[48:51]
    ds_read_b64_tr_b16 a[180:181], v187 offset:45216
    v_mfma_f32_16x16x32_bf16 a[52:55], a[160:163], a[136:139], a[52:55]
    buffer_load_dwordx4 v173, s[8:11], s28 offen offset:0 sc1 lds
    v_mfma_f32_16x16x32_bf16 a[56:59], a[160:163], a[140:143], a[56:59]
    ds_read_b64_tr_b16 a[182:183], v187 offset:48800
    v_mfma_f32_16x16x32_bf16 a[60:63], a[160:163], a[144:147], a[60:63]
    ds_read_b64_tr_b16 a[156:157], v187 offset:45248
    s_waitcnt lgkmcnt(9)
    v_mfma_f32_16x16x32_bf16 v[152:155], a[164:167], a[132:135], v[152:155]
    ds_read_b64_tr_b16 a[152:153], v187 offset:38080
    v_mfma_f32_16x16x32_bf16 v[156:159], a[164:167], a[136:139], v[156:159]
    ds_read_b64_tr_b16 a[158:159], v187 offset:48832
    v_mfma_f32_16x16x32_bf16 v[160:163], a[164:167], a[140:143], v[160:163]
    ds_read_b64_tr_b16 a[154:155], v187 offset:41664
    v_mfma_f32_16x16x32_bf16 v[164:167], a[164:167], a[144:147], v[164:167]
    s_waitcnt lgkmcnt(10)
    v_mfma_f32_16x16x32_bf16 a[64:67], a[168:171], a[132:135], a[64:67]
    ds_read_b64_tr_b16 a[160:161], v183 offset:55360
    v_mfma_f32_16x16x32_bf16 a[68:71], a[168:171], a[136:139], a[68:71]
    buffer_load_dwordx4 v174, s[8:11], s28 offen offset:1024 sc1 lds
    v_mfma_f32_16x16x32_bf16 a[72:75], a[168:171], a[140:143], a[72:75]
    ds_read_b64_tr_b16 a[162:163], v183 offset:58432
    v_mfma_f32_16x16x32_bf16 a[76:79], a[168:171], a[144:147], a[76:79]
    s_waitcnt lgkmcnt(10)
    v_mfma_f32_16x16x32_bf16 a[184:187], a[172:175], a[132:135], a[184:187]
    ds_read_b64_tr_b16 a[164:165], v185 offset:55360
    v_mfma_f32_16x16x32_bf16 a[188:191], a[172:175], a[136:139], a[188:191]
    v_mfma_f32_16x16x32_bf16 a[192:195], a[172:175], a[140:143], a[192:195]
    ds_read_b64_tr_b16 a[166:167], v185 offset:58432
    v_mfma_f32_16x16x32_bf16 a[196:199], a[172:175], a[144:147], a[196:199]
    s_waitcnt lgkmcnt(10)
    v_mfma_f32_16x16x32_bf16 a[80:83], a[176:179], a[132:135], a[80:83]
    ds_read_b64_tr_b16 a[168:169], v183 offset:55424
    v_mfma_f32_16x16x32_bf16 a[84:87], a[176:179], a[136:139], a[84:87]
    buffer_load_dwordx4 v175, s[8:11], s28 offen offset:2048 sc1 lds
    v_mfma_f32_16x16x32_bf16 a[88:91], a[176:179], a[140:143], a[88:91]
    ds_read_b64_tr_b16 a[170:171], v183 offset:58496
    v_mfma_f32_16x16x32_bf16 a[92:95], a[176:179], a[144:147], a[92:95]
    s_waitcnt lgkmcnt(10)
    v_mfma_f32_16x16x32_bf16 a[200:203], a[180:183], a[132:135], a[200:203]
    ds_read_b64_tr_b16 a[172:173], v185 offset:55424
    v_mfma_f32_16x16x32_bf16 a[204:207], a[180:183], a[136:139], a[204:207]
    v_mfma_f32_16x16x32_bf16 a[208:211], a[180:183], a[140:143], a[208:211]
    ds_read_b64_tr_b16 a[174:175], v185 offset:58496
    v_mfma_f32_16x16x32_bf16 a[212:215], a[180:183], a[144:147], a[212:215]
    s_waitcnt lgkmcnt(8)
    v_mfma_f32_16x16x32_bf16 a[96:99], a[152:155], a[132:135], a[96:99]
    ds_read_b64_tr_b16 a[176:177], v183 offset:55296
    v_mfma_f32_16x16x32_bf16 a[100:103], a[152:155], a[136:139], a[100:103]
    buffer_load_dwordx4 v176, s[8:11], s28 offen offset:3072 sc1 lds
    v_mfma_f32_16x16x32_bf16 a[104:107], a[152:155], a[140:143], a[104:107]
    ds_read_b64_tr_b16 a[178:179], v183 offset:58368
    v_mfma_f32_16x16x32_bf16 a[108:111], a[152:155], a[144:147], a[108:111]
    v_mfma_f32_16x16x32_bf16 a[216:219], a[156:159], a[132:135], a[216:219]
    ds_read_b64_tr_b16 a[180:181], v185 offset:55296
    v_mfma_f32_16x16x32_bf16 a[220:223], a[156:159], a[136:139], a[220:223]
    v_mfma_f32_16x16x32_bf16 a[224:227], a[156:159], a[140:143], a[224:227]
    ds_read_b64_tr_b16 a[182:183], v185 offset:58368
    v_mfma_f32_16x16x32_bf16 a[228:231], a[156:159], a[144:147], a[228:231]
    s_waitcnt lgkmcnt(10)
    v_mfma_f32_16x16x32_bf16 v[36:39], a[160:163], a[132:135], v[36:39]
    v_mfma_f32_16x16x32_bf16 v[44:47], a[160:163], a[136:139], v[44:47]
    v_mfma_f32_16x16x32_bf16 v[52:55], a[160:163], a[140:143], v[52:55]
    v_mfma_f32_16x16x32_bf16 v[60:63], a[160:163], a[144:147], v[60:63]
    v_mfma_f32_16x16x32_bf16 v[100:103], a[160:163], a[148:151], v[100:103]
    s_waitcnt lgkmcnt(8)
    v_mfma_f32_16x16x32_bf16 v[40:43], a[164:167], a[132:135], v[40:43]
    v_mfma_f32_16x16x32_bf16 v[48:51], a[164:167], a[136:139], v[48:51]
    s_add_u32 s28, s28, 131072
    v_mfma_f32_16x16x32_bf16 v[56:59], a[164:167], a[140:143], v[56:59]
    v_mfma_f32_16x16x32_bf16 v[64:67], a[164:167], a[144:147], v[64:67]
    s_waitcnt vmcnt(18) lgkmcnt(0)
    s_barrier
    s_sub_u32 s31, s31, 1
    s_branch L_g1_loop0
L_g1_w1:
    s_add_u32 s47, s35, 8192
    v_add_u32 v168, s47, v3
    s_add_u32 s47, s35, 8192
    v_add_u32 v169, s47, v3
    s_add_u32 s47, s35, 8192
    v_add_u32 v170, s47, v3
    s_add_u32 s47, s35, 8192
    v_add_u32 v171, s47, v3
    s_add_u32 s47, s35, 12288
    v_add_u32 v172, s47, v3
    s_add_u32 s47, s35, 12288
    v_add_u32 v173, s47, v3
    s_add_u32 s47, s35, 12288
    v_add_u32 v174, s47, v3
    s_add_u32 s47, s35, 12288
    v_add_u32 v175, s47, v3
    v_add_u32 v178, 5120, v3
    v_add_u32 v179, 80896, v3
    s_waitcnt vmcnt(0)
    s_barrier
    s_add_u32 s8, s82, s42
    s_addc_u32 s9, s83, 0
    s_and_b32 s9, s9, 0xffff
    s_mov_b32 s10, 0
    s_mov_b32 s11, 0x00020000
    s_sub_u32 s10, 4194304, s42
    s_call_b64 s[62:63], L_common
    s_and_b32 s60, s2, 1
    s_bfe_u32 s61, s2, 0x20001
    s_lshl_b32 s61, s61, 2
    s_bfe_u32 s47, s2, 0x20003
    s_add_u32 s61, s61, s47
    s_lshr_b32 s62, s2, 5
    s_lshl_b32 s63, s62, 8
    v_mov_b32 v220, v3
    v_add_u32 v221, 4096, v220
    v_mov_b32 v222, 0x7fffff00
    v_mov_b32 v223, 0x7fffff00
    v_mov_b32 v224, 0x7fffff00
    v_mov_b32 v225, 0x7fffff00
    v_mov_b32 v226, 0x7fffff00
    v_mov_b32 v227, 0x7fffff00
    v_add_u32 v228, 0, v3
    v_add_u32 v229, 65536, v228
    v_add_u32 v230, 2048, v228
    v_add_u32 v231, 65536, v230
    v_lshrrev_b32 v240, 2, v1
    v_and_b32 v241, 7, v240
    v_and_b32 v242, 3, v1
    v_lshlrev_b32 v242, 3, v242
    v_lshl_add_u32 v242, v240, 8, v242
    v_add_u32 v242, 16384, v242
    v_xor_b32 v243, 4, v241
    v_lshl_add_u32 v232, v243, 5, v242
    v_add_u32 v233, 65536, v232
    v_xor_b32 v243, 5, v241
    v_lshl_add_u32 v234, v243, 5, v242
    v_add_u32 v235, 65536, v234
    v_xor_b32 v243, 6, v241
    v_lshl_add_u32 v236, v243, 5, v242
    v_add_u32 v237, 65536, v236
    v_xor_b32 v243, 7, v241
    v_lshl_add_u32 v238, v243, 5, v242
    v_add_u32 v239, 65536, v238
    s_lshl_b32 s47, s61, 8
    s_add_u32 s47, s47, 4096
    v_lshl_add_u32 v245, v1, 2, s47
    v_and_b32 v240, 1, v1
    v_lshlrev_b32 v240, 7, v240
    v_and_b32 v241, 2, v1
    v_lshl_add_u32 v240, v241, 9, v240
    v_and_b32 v241, 4, v1
    v_lshl_add_u32 v240, v241, 7, v240
    s_lshr_b32 s47, s2, 3
    s_lshl_b32 s47, s47, 11
    s_add_u32 s47, s47, 256
    v_add_u32 v240, s47, v240
    v_lshrrev_b32 v241, 4, v1
    v_mul_u32_u24 v241, 7, v241
    v_bfe_u32 v242, v1, 3, 1
    v_lshl_add_u32 v241, v242, 2, v241
    v_lshl_add_u32 v247, v241, 16, v240
    s_cmp_eq_u32 s60, 1
    s_cselect_b32 s47, 7, 1
    v_lshrrev_b32 v241, 3, v1
    v_mul_u32_u24 v241, s47, v241
    v_lshl_add_u32 v246, v241, 16, v240
    s_lshl_b32 s4, s61, 7
    s_add_u32 s4, s4, 0
    s_lshl_b32 s4, s4, 11
    s_add_u32 s5, s63, 128
    s_add_u32 s4, s4, s5
    v_and_b32 v249, 15, v1
    v_lshlrev_b32 v249, 11, v249
    v_and_b32 v241, 16, v1
    v_lshl_add_u32 v249, v241, 1, v249
    v_and_b32 v241, 32, v1
    v_lshrrev_b32 v241, 1, v241
    v_add3_u32 v249, v249, v241, s4
    v_lshlrev_b32 v188, 7, v1
    v_mov_b32 v189, 0x7fffff00
    v_cmp_gt_u32 vcc, 8, v1
    s_nop 1
    v_cndmask_b32 v197, v189, v188, vcc
    s_mov_b32 s48, s68
    s_and_b32 s49, s69, 0xffff
    s_mov_b32 s50, 2097152
    s_mov_b32 s51, 0x00020000
    s_lshl_b32 s60, s2, 13
    s_lshl_b32 s47, s34, 14
    s_add_u32 s47, s47, 4096
    v_add_u32 v194, s47, v3
    s_lshl_b32 s47, s45, 3
    v_add_u32 v195, s47, v194
    s_mov_b32 exec_lo, -1
    s_mov_b32 exec_hi, 0x3
    s_mov_b32 s47, 0x20000
    buffer_load_dword v250, v200, s[84:87], 0 offen sc1
L_poll1:
    s_waitcnt vmcnt(0)
    v_cmp_ne_u32 vcc, s96, v250
    s_nop 4
    s_cbranch_vccz L_pollok1
    buffer_load_dword v250, v200, s[84:87], 0 offen sc1
    s_sub_u32 s47, s47, 1
    s_cmp_lg_u32 s47, 0
    s_cbranch_scc1 L_poll1
    s_branch L_end
L_pollok1:
    s_mov_b64 exec, -1
    s_mov_b32 m0, 9216
    s_nop 0
    buffer_load_dwordx4 v168, s[8:11], s28 offen offset:0 sc1 lds
    buffer_load_dwordx4 v169, s[8:11], s28 offen offset:1024 sc1 lds
    buffer_load_dwordx4 v170, s[8:11], s28 offen offset:2048 sc1 lds
    buffer_load_dwordx4 v171, s[8:11], s28 offen offset:3072 sc1 lds
    s_mov_b32 m0, 13312
    s_nop 0
    buffer_load_dwordx4 v172, s[8:11], s28 offen offset:0 sc1 lds
    buffer_load_dwordx4 v173, s[8:11], s28 offen offset:1024 sc1 lds
    buffer_load_dwordx4 v174, s[8:11], s28 offen offset:2048 sc1 lds
    buffer_load_dwordx4 v175, s[8:11], s28 offen offset:3072 sc1 lds
    s_add_u32 s28, s28, 131072
    s_mov_b32 m0, 47104
    s_nop 0
    buffer_load_dwordx4 v168, s[8:11], s28 offen offset:0 sc1 lds
    buffer_load_dwordx4 v169, s[8:11], s28 offen offset:1024 sc1 lds
    buffer_load_dwordx4 v170, s[8:11], s28 offen offset:2048 sc1 lds
    buffer_load_dwordx4 v171, s[8:11], s28 offen offset:3072 sc1 lds
    s_mov_b32 m0, 51200
    s_nop 0
    buffer_load_dwordx4 v172, s[8:11], s28 offen offset:0 sc1 lds
    buffer_load_dwordx4 v173, s[8:11], s28 offen offset:1024 sc1 lds
    buffer_load_dwordx4 v174, s[8:11], s28 offen offset:2048 sc1 lds
    buffer_load_dwordx4 v175, s[8:11], s28 offen offset:3072 sc1 lds
    s_add_u32 s28, s28, 131072
    s_mov_b32 m0, 84992
    s_nop 0
    buffer_load_dwordx4 v168, s[8:11], s28 offen offset:0 sc1 lds
    buffer_load_dwordx4 v169, s[8:11], s28 offen offset:1024 sc1 lds
    buffer_load_dwordx4 v170, s[8:11], s28 offen offset:2048 sc1 lds
    buffer_load_dwordx4 v171, s[8:11], s28 offen offset:3072 sc1 lds
    s_mov_b32 m0, 89088
    s_nop 0
    buffer_load_dwordx4 v172, s[8:11], s28 offen offset:0 sc1 lds
    buffer_load_dwordx4 v173, s[8:11], s28 offen offset:1024 sc1 lds
    buffer_load_dwordx4 v174, s[8:11], s28 offen offset:2048 sc1 lds
    buffer_load_dwordx4 v175, s[8:11], s28 offen offset:3072 sc1 lds
    s_add_u32 s28, s28, 131072
    s_waitcnt vmcnt(16)
    s_barrier
    .p2align 6
L_g1_loop1:
    ds_read_b128 a[112:115], v178 offset:0
    v_mfma_f32_16x16x32_bf16 v[68:71], a[132:135], a[168:171], v[68:71]
    ds_read_b64_tr_b16 a[152:153], v186 offset:0
    s_mov_b32 m0, 122880
    v_mfma_f32_16x16x32_bf16 v[76:79], a[136:139], a[168:171], v[76:79]
    ds_read_b64_tr_b16 a[154:155], v186 offset:3584
    buffer_load_dwordx4 v168, s[8:11], s28 offen offset:0 sc1 lds
    v_mfma_f32_16x16x32_bf16 v[84:87], a[140:143], a[168:171], v[84:87]
    ds_read_b128 a[116:119], v178 offset:1024
    v_mfma_f32_16x16x32_bf16 v[92:95], a[144:147], a[168:171], v[92:95]
    ds_read_b128 a[120:123], v178 offset:2048
    v_mfma_f32_16x16x32_bf16 v[72:75], a[132:135], a[172:175], v[72:75]
    ds_read_b128 a[124:127], v178 offset:3072
    v_mfma_f32_16x16x32_bf16 v[80:83], a[136:139], a[172:175], v[80:83]
    ds_read_b64_tr_b16 a[156:157], v186 offset:7168
    v_mfma_f32_16x16x32_bf16 v[88:91], a[140:143], a[172:175], v[88:91]
    ds_read_b64_tr_b16 a[158:159], v186 offset:10752
    v_mfma_f32_16x16x32_bf16 v[96:99], a[144:147], a[172:175], v[96:99]
    ds_read_b128 a[128:131], v180 offset:0
    v_mfma_f32_16x16x32_bf16 v[4:7], a[176:179], a[132:135], v[4:7]
    ds_read_b64_tr_b16 a[160:161], v186 offset:32
    v_mfma_f32_16x16x32_bf16 v[12:15], a[176:179], a[136:139], v[12:15]
    ds_read_b64_tr_b16 a[162:163], v186 offset:3616
    v_mfma_f32_16x16x32_bf16 v[20:23], a[176:179], a[140:143], v[20:23]
    ds_read_b64_tr_b16 a[164:165], v186 offset:7200
    v_mfma_f32_16x16x32_bf16 v[28:31], a[176:179], a[144:147], v[28:31]
    ds_read_b64_tr_b16 a[166:167], v186 offset:10784
    v_mfma_f32_16x16x32_bf16 v[8:11], a[180:183], a[132:135], v[8:11]
    buffer_load_dwordx4 v169, s[8:11], s28 offen offset:1024 sc1 lds
    v_mfma_f32_16x16x32_bf16 v[16:19], a[180:183], a[136:139], v[16:19]
    v_mfma_f32_16x16x32_bf16 v[24:27], a[180:183], a[140:143], v[24:27]
    v_mfma_f32_16x16x32_bf16 v[32:35], a[180:183], a[144:147], v[32:35]
    ds_read_b64_tr_b16 a[172:173], v186 offset:7232
    s_waitcnt lgkmcnt(11)
    v_mfma_f32_16x16x32_bf16 a[0:3], a[152:155], a[112:115], a[0:3]
    ds_read_b64_tr_b16 a[168:169], v186 offset:64
    s_waitcnt lgkmcnt(11)
    v_mfma_f32_16x16x32_bf16 a[4:7], a[152:155], a[116:119], a[4:7]
    ds_read_b64_tr_b16 a[174:175], v186 offset:10816
    s_waitcnt lgkmcnt(11)
    v_mfma_f32_16x16x32_bf16 a[8:11], a[152:155], a[120:123], a[8:11]
    ds_read_b64_tr_b16 a[170:171], v186 offset:3648
    s_waitcnt lgkmcnt(11)
    v_mfma_f32_16x16x32_bf16 a[12:15], a[152:155], a[124:127], a[12:15]
    s_waitcnt lgkmcnt(9)
    v_mfma_f32_16x16x32_bf16 v[104:107], a[156:159], a[112:115], v[104:107]
    ds_read_b64_tr_b16 a[176:177], v186 offset:96
    v_mfma_f32_16x16x32_bf16 v[108:111], a[156:159], a[116:119], v[108:111]
    buffer_load_dwordx4 v170, s[8:11], s28 offen offset:2048 sc1 lds
    v_mfma_f32_16x16x32_bf16 v[112:115], a[156:159], a[120:123], v[112:115]
    ds_read_b64_tr_b16 a[178:179], v186 offset:3680
    v_mfma_f32_16x16x32_bf16 v[116:119], a[156:159], a[124:127], v[116:119]
    s_waitcnt lgkmcnt(8)
    v_mfma_f32_16x16x32_bf16 a[16:19], a[160:163], a[112:115], a[16:19]
    ds_read_b64_tr_b16 a[180:181], v186 offset:7264
    v_mfma_f32_16x16x32_bf16 a[20:23], a[160:163], a[116:119], a[20:23]
    buffer_load_dwordx4 v171, s[8:11], s28 offen offset:3072 sc1 lds
    v_mfma_f32_16x16x32_bf16 a[24:27], a[160:163], a[120:123], a[24:27]
    ds_read_b64_tr_b16 a[182:183], v186 offset:10848
    v_mfma_f32_16x16x32_bf16 a[28:31], a[160:163], a[124:127], a[28:31]
    s_waitcnt lgkmcnt(8)
    v_mfma_f32_16x16x32_bf16 v[120:123], a[164:167], a[112:115], v[120:123]
    ds_read_b64_tr_b16 a[152:153], v186 offset:128
    v_mfma_f32_16x16x32_bf16 v[124:127], a[164:167], a[116:119], v[124:127]
    v_mfma_f32_16x16x32_bf16 v[128:131], a[164:167], a[120:123], v[128:131]
    ds_read_b64_tr_b16 a[154:155], v186 offset:3712
    v_mfma_f32_16x16x32_bf16 v[132:135], a[164:167], a[124:127], v[132:135]
    s_waitcnt lgkmcnt(6)
    v_mfma_f32_16x16x32_bf16 a[32:35], a[168:171], a[112:115], a[32:35]
    ds_read_b64_tr_b16 a[156:157], v186 offset:7296
    v_mfma_f32_16x16x32_bf16 a[36:39], a[168:171], a[116:119], a[36:39]
    s_mov_b32 m0, 126976
    v_mfma_f32_16x16x32_bf16 a[40:43], a[168:171], a[120:123], a[40:43]
    ds_read_b64_tr_b16 a[158:159], v186 offset:10880
    v_mfma_f32_16x16x32_bf16 a[44:47], a[168:171], a[124:127], a[44:47]
    buffer_load_dwordx4 v172, s[8:11], s28 offen offset:0 sc1 lds
    v_mfma_f32_16x16x32_bf16 v[136:139], a[172:175], a[112:115], v[136:139]
    ds_read_b64_tr_b16 a[160:161], v186 offset:160
    v_mfma_f32_16x16x32_bf16 v[140:143], a[172:175], a[116:119], v[140:143]
    v_mfma_f32_16x16x32_bf16 v[144:147], a[172:175], a[120:123], v[144:147]
    ds_read_b64_tr_b16 a[162:163], v186 offset:3744
    v_mfma_f32_16x16x32_bf16 v[148:151], a[172:175], a[124:127], v[148:151]
    s_waitcnt lgkmcnt(8)
    v_mfma_f32_16x16x32_bf16 a[48:51], a[176:179], a[112:115], a[48:51]
    ds_read_b64_tr_b16 a[164:165], v186 offset:7328
    v_mfma_f32_16x16x32_bf16 a[52:55], a[176:179], a[116:119], a[52:55]
    v_mfma_f32_16x16x32_bf16 a[56:59], a[176:179], a[120:123], a[56:59]
    ds_read_b64_tr_b16 a[166:167], v186 offset:10912
    v_mfma_f32_16x16x32_bf16 a[60:63], a[176:179], a[124:127], a[60:63]
    ds_read_b64_tr_b16 a[172:173], v186 offset:7360
    s_waitcnt lgkmcnt(9)
    v_mfma_f32_16x16x32_bf16 v[152:155], a[180:183], a[112:115], v[152:155]
    ds_read_b64_tr_b16 a[168:169], v186 offset:192
    v_mfma_f32_16x16x32_bf16 v[156:159], a[180:183], a[116:119], v[156:159]
    ds_read_b64_tr_b16 a[174:175], v186 offset:10944
    buffer_load_dwordx4 v173, s[8:11], s28 offen offset:1024 sc1 lds
    v_mfma_f32_16x16x32_bf16 v[160:163], a[180:183], a[120:123], v[160:163]
    ds_read_b64_tr_b16 a[170:171], v186 offset:3776
    v_mfma_f32_16x16x32_bf16 v[164:167], a[180:183], a[124:127], v[164:167]
    s_waitcnt lgkmcnt(10)
    v_mfma_f32_16x16x32_bf16 a[64:67], a[152:155], a[112:115], a[64:67]
    ds_read_b64_tr_b16 a[176:177], v182 offset:17472
    v_mfma_f32_16x16x32_bf16 a[68:71], a[152:155], a[116:119], a[68:71]
    v_mfma_f32_16x16x32_bf16 a[72:75], a[152:155], a[120:123], a[72:75]
    ds_read_b64_tr_b16 a[178:179], v182 offset:20544
    v_mfma_f32_16x16x32_bf16 a[76:79], a[152:155], a[124:127], a[76:79]
    s_waitcnt lgkmcnt(10)
    v_mfma_f32_16x16x32_bf16 a[184:187], a[156:159], a[112:115], a[184:187]
    ds_read_b64_tr_b16 a[180:181], v184 offset:17472
    v_mfma_f32_16x16x32_bf16 a[188:191], a[156:159], a[116:119], a[188:191]
    buffer_load_dwordx4 v174, s[8:11], s28 offen offset:2048 sc1 lds
    v_mfma_f32_16x16x32_bf16 a[192:195], a[156:159], a[120:123], a[192:195]
    ds_read_b64_tr_b16 a[182:183], v184 offset:20544
    v_mfma_f32_16x16x32_bf16 a[196:199], a[156:159], a[124:127], a[196:199]
    s_waitcnt lgkmcnt(10)
    v_mfma_f32_16x16x32_bf16 a[80:83], a[160:163], a[112:115], a[80:83]
    ds_read_b64_tr_b16 a[152:153], v182 offset:17536
    v_mfma_f32_16x16x32_bf16 a[84:87], a[160:163], a[116:119], a[84:87]
    v_mfma_f32_16x16x32_bf16 a[88:91], a[160:163], a[120:123], a[88:91]
    ds_read_b64_tr_b16 a[154:155], v182 offset:20608
    v_mfma_f32_16x16x32_bf16 a[92:95], a[160:163], a[124:127], a[92:95]
    s_waitcnt lgkmcnt(10)
    v_mfma_f32_16x16x32_bf16 a[200:203], a[164:167], a[112:115], a[200:203]
    ds_read_b64_tr_b16 a[156:157], v184 offset:17536
    v_mfma_f32_16x16x32_bf16 a[204:207], a[164:167], a[116:119], a[204:207]
    buffer_load_dwordx4 v175, s[8:11], s28 offen offset:3072 sc1 lds
    v_mfma_f32_16x16x32_bf16 a[208:211], a[164:167], a[120:123], a[208:211]
    ds_read_b64_tr_b16 a[158:159], v184 offset:20608
    v_mfma_f32_16x16x32_bf16 a[212:215], a[164:167], a[124:127], a[212:215]
    s_waitcnt lgkmcnt(8)
    v_mfma_f32_16x16x32_bf16 a[96:99], a[168:171], a[112:115], a[96:99]
    ds_read_b64_tr_b16 a[160:161], v182 offset:17408
    v_mfma_f32_16x16x32_bf16 a[100:103], a[168:171], a[116:119], a[100:103]
    v_mfma_f32_16x16x32_bf16 a[104:107], a[168:171], a[120:123], a[104:107]
    ds_read_b64_tr_b16 a[162:163], v182 offset:20480
    v_mfma_f32_16x16x32_bf16 a[108:111], a[168:171], a[124:127], a[108:111]
    v_mfma_f32_16x16x32_bf16 a[216:219], a[172:175], a[112:115], a[216:219]
    ds_read_b64_tr_b16 a[164:165], v184 offset:17408
    v_mfma_f32_16x16x32_bf16 a[220:223], a[172:175], a[116:119], a[220:223]
    v_mfma_f32_16x16x32_bf16 a[224:227], a[172:175], a[120:123], a[224:227]
    ds_read_b64_tr_b16 a[166:167], v184 offset:20480
    v_mfma_f32_16x16x32_bf16 a[228:231], a[172:175], a[124:127], a[228:231]
    s_waitcnt lgkmcnt(10)
    v_mfma_f32_16x16x32_bf16 v[36:39], a[176:179], a[112:115], v[36:39]
    v_mfma_f32_16x16x32_bf16 v[44:47], a[176:179], a[116:119], v[44:47]
    v_mfma_f32_16x16x32_bf16 v[52:55], a[176:179], a[120:123], v[52:55]
    v_mfma_f32_16x16x32_bf16 v[60:63], a[176:179], a[124:127], v[60:63]
    buffer_load_dword v196, v199, s[92:95], s59 offen
    s_waitcnt lgkmcnt(8)
    v_mfma_f32_16x16x32_bf16 v[40:43], a[180:183], a[112:115], v[40:43]
    s_add_u32 s59, s59, s97
    v_mfma_f32_16x16x32_bf16 v[48:51], a[180:183], a[116:119], v[48:51]
    buffer_load_dword v196, v197, s[48:51], s60 offen
    v_mfma_f32_16x16x32_bf16 v[56:59], a[180:183], a[120:123], v[56:59]
    s_add_u32 s28, s28, 131072
    s_add_u32 s60, s60, 1024
    v_mfma_f32_16x16x32_bf16 v[64:67], a[180:183], a[124:127], v[64:67]
    v_mfma_f32_16x16x32_bf16 v[100:103], a[180:183], a[128:131], v[100:103]
    s_waitcnt vmcnt(18) lgkmcnt(0)
    s_barrier
    ds_read_b128 a[132:135], v178 offset:37888
    v_mfma_f32_16x16x32_bf16 v[68:71], a[112:115], a[152:155], v[68:71]
    ds_read_b64_tr_b16 a[168:169], v186 offset:37888
    s_mov_b32 m0, 9216
    v_mfma_f32_16x16x32_bf16 v[76:79], a[116:119], a[152:155], v[76:79]
    ds_read_b64_tr_b16 a[170:171], v186 offset:41472
    buffer_load_dwordx4 v168, s[8:11], s28 offen offset:0 sc1 lds
    v_mfma_f32_16x16x32_bf16 v[84:87], a[120:123], a[152:155], v[84:87]
    ds_read_b128 a[136:139], v178 offset:38912
    v_mfma_f32_16x16x32_bf16 v[92:95], a[124:127], a[152:155], v[92:95]
    ds_read_b128 a[140:143], v178 offset:39936
    v_mfma_f32_16x16x32_bf16 v[72:75], a[112:115], a[156:159], v[72:75]
    ds_read_b128 a[144:147], v178 offset:40960
    v_mfma_f32_16x16x32_bf16 v[80:83], a[116:119], a[156:159], v[80:83]
    ds_read_b64_tr_b16 a[172:173], v186 offset:45056
    v_mfma_f32_16x16x32_bf16 v[88:91], a[120:123], a[156:159], v[88:91]
    ds_read_b64_tr_b16 a[174:175], v186 offset:48640
    v_mfma_f32_16x16x32_bf16 v[96:99], a[124:127], a[156:159], v[96:99]
    ds_read_b128 a[148:151], v180 offset:37888
    v_mfma_f32_16x16x32_bf16 v[4:7], a[160:163], a[112:115], v[4:7]
    ds_read_b64_tr_b16 a[176:177], v186 offset:37920
    v_mfma_f32_16x16x32_bf16 v[12:15], a[160:163], a[116:119], v[12:15]
    ds_read_b64_tr_b16 a[178:179], v186 offset:41504
    v_mfma_f32_16x16x32_bf16 v[20:23], a[160:163], a[120:123], v[20:23]
    ds_read_b64_tr_b16 a[180:181], v186 offset:45088
    v_mfma_f32_16x16x32_bf16 v[28:31], a[160:163], a[124:127], v[28:31]
    ds_read_b64_tr_b16 a[182:183], v186 offset:48672
    v_mfma_f32_16x16x32_bf16 v[8:11], a[164:167], a[112:115], v[8:11]
    buffer_load_dwordx4 v169, s[8:11], s28 offen offset:1024 sc1 lds
    v_mfma_f32_16x16x32_bf16 v[16:19], a[164:167], a[116:119], v[16:19]
    v_mfma_f32_16x16x32_bf16 v[24:27], a[164:167], a[120:123], v[24:27]
    v_mfma_f32_16x16x32_bf16 v[32:35], a[164:167], a[124:127], v[32:35]
    ds_read_b64_tr_b16 a[156:157], v186 offset:45120
    s_waitcnt lgkmcnt(11)
    v_mfma_f32_16x16x32_bf16 a[0:3], a[168:171], a[132:135], a[0:3]
    ds_read_b64_tr_b16 a[152:153], v186 offset:37952
    s_waitcnt lgkmcnt(11)
    v_mfma_f32_16x16x32_bf16 a[4:7], a[168:171], a[136:139], a[4:7]
    ds_read_b64_tr_b16 a[158:159], v186 offset:48704
    s_waitcnt lgkmcnt(11)
    v_mfma_f32_16x16x32_bf16 a[8:11], a[168:171], a[140:143], a[8:11]
    ds_read_b64_tr_b16 a[154:155], v186 offset:41536
    s_waitcnt lgkmcnt(11)
    v_mfma_f32_16x16x32_bf16 a[12:15], a[168:171], a[144:147], a[12:15]
    s_waitcnt lgkmcnt(9)
    v_mfma_f32_16x16x32_bf16 v[104:107], a[172:175], a[132:135], v[104:107]
    ds_read_b64_tr_b16 a[160:161], v186 offset:37984
    v_mfma_f32_16x16x32_bf16 v[108:111], a[172:175], a[136:139], v[108:111]
    buffer_load_dwordx4 v170, s[8:11], s28 offen offset:2048 sc1 lds
    v_mfma_f32_16x16x32_bf16 v[112:115], a[172:175], a[140:143], v[112:115]
    ds_read_b64_tr_b16 a[162:163], v186 offset:41568
    v_mfma_f32_16x16x32_bf16 v[116:119], a[172:175], a[144:147], v[116:119]
    s_waitcnt lgkmcnt(8)
    v_mfma_f32_16x16x32_bf16 a[16:19], a[176:179], a[132:135], a[16:19]
    ds_read_b64_tr_b16 a[164:165], v186 offset:45152
    v_mfma_f32_16x16x32_bf16 a[20:23], a[176:179], a[136:139], a[20:23]
    buffer_load_dwordx4 v171, s[8:11], s28 offen offset:3072 sc1 lds
    v_mfma_f32_16x16x32_bf16 a[24:27], a[176:179], a[140:143], a[24:27]
    ds_read_b64_tr_b16 a[166:167], v186 offset:48736
    v_mfma_f32_16x16x32_bf16 a[28:31], a[176:179], a[144:147], a[28:31]
    s_waitcnt lgkmcnt(8)
    v_mfma_f32_16x16x32_bf16 v[120:123], a[180:183], a[132:135], v[120:123]
    ds_read_b64_tr_b16 a[168:169], v186 offset:38016
    v_mfma_f32_16x16x32_bf16 v[124:127], a[180:183], a[136:139], v[124:127]
    v_mfma_f32_16x16x32_bf16 v[128:131], a[180:183], a[140:143], v[128:131]
    ds_read_b64_tr_b16 a[170:171], v186 offset:41600
    v_mfma_f32_16x16x32_bf16 v[132:135], a[180:183], a[144:147], v[132:135]
    s_waitcnt lgkmcnt(6)
    v_mfma_f32_16x16x32_bf16 a[32:35], a[152:155], a[132:135], a[32:35]
    ds_read_b64_tr_b16 a[172:173], v186 offset:45184
    v_mfma_f32_16x16x32_bf16 a[36:39], a[152:155], a[136:139], a[36:39]
    s_mov_b32 m0, 13312
    v_mfma_f32_16x16x32_bf16 a[40:43], a[152:155], a[140:143], a[40:43]
    ds_read_b64_tr_b16 a[174:175], v186 offset:48768
    v_mfma_f32_16x16x32_bf16 a[44:47], a[152:155], a[144:147], a[44:47]
    buffer_load_dwordx4 v172, s[8:11], s28 offen offset:0 sc1 lds
    v_mfma_f32_16x16x32_bf16 v[136:139], a[156:159], a[132:135], v[136:139]
    ds_read_b64_tr_b16 a[176:177], v186 offset:38048
    v_mfma_f32_16x16x32_bf16 v[140:143], a[156:159], a[136:139], v[140:143]
    v_mfma_f32_16x16x32_bf16 v[144:147], a[156:159], a[140:143], v[144:147]
    ds_read_b64_tr_b16 a[178:179], v186 offset:41632
    v_mfma_f32_16x16x32_bf16 v[148:151], a[156:159], a[144:147], v[148:151]
    s_waitcnt lgkmcnt(8)
    v_mfma_f32_16x16x32_bf16 a[48:51], a[160:163], a[132:135], a[48:51]
    ds_read_b64_tr_b16 a[180:181], v186 offset:45216
    v_mfma_f32_16x16x32_bf16 a[52:55], a[160:163], a[136:139], a[52:55]
    v_mfma_f32_16x16x32_bf16 a[56:59], a[160:163], a[140:143], a[56:59]
    ds_read_b64_tr_b16 a[182:183], v186 offset:48800
    v_mfma_f32_16x16x32_bf16 a[60:63], a[160:163], a[144:147], a[60:63]
    ds_read_b64_tr_b16 a[156:157], v186 offset:45248
    s_waitcnt lgkmcnt(9)
    v_mfma_f32_16x16x32_bf16 v[152:155], a[164:167], a[132:135], v[152:155]
    ds_read_b64_tr_b16 a[152:153], v186 offset:38080
    v_mfma_f32_16x16x32_bf16 v[156:159], a[164:167], a[136:139], v[156:159]
    ds_read_b64_tr_b16 a[158:159], v186 offset:48832
    buffer_load_dwordx4 v173, s[8:11], s28 offen offset:1024 sc1 lds
    v_mfma_f32_16x16x32_bf16 v[160:163], a[164:167], a[140:143], v[160:163]
    ds_read_b64_tr_b16 a[154:155], v186 offset:41664
    v_mfma_f32_16x16x32_bf16 v[164:167], a[164:167], a[144:147], v[164:167]
    s_waitcnt lgkmcnt(10)
    v_mfma_f32_16x16x32_bf16 a[64:67], a[168:171], a[132:135], a[64:67]
    ds_read_b64_tr_b16 a[160:161], v182 offset:55360
    v_mfma_f32_16x16x32_bf16 a[68:71], a[168:171], a[136:139], a[68:71]
    v_mfma_f32_16x16x32_bf16 a[72:75], a[168:171], a[140:143], a[72:75]
    ds_read_b64_tr_b16 a[162:163], v182 offset:58432
    v_mfma_f32_16x16x32_bf16 a[76:79], a[168:171], a[144:147], a[76:79]
    s_waitcnt lgkmcnt(10)
    v_mfma_f32_16x16x32_bf16 a[184:187], a[172:175], a[132:135], a[184:187]
    ds_read_b64_tr_b16 a[164:165], v184 offset:55360
    v_mfma_f32_16x16x32_bf16 a[188:191], a[172:175], a[136:139], a[188:191]
    buffer_load_dwordx4 v174, s[8:11], s28 offen offset:2048 sc1 lds
    v_mfma_f32_16x16x32_bf16 a[192:195], a[172:175], a[140:143], a[192:195]
    ds_read_b64_tr_b16 a[166:167], v184 offset:58432
    v_mfma_f32_16x16x32_bf16 a[196:199], a[172:175], a[144:147], a[196:199]
    s_waitcnt lgkmcnt(10)
    v_mfma_f32_16x16x32_bf16 a[80:83], a[176:179], a[132:135], a[80:83]
    ds_read_b64_tr_b16 a[168:169], v182 offset:55424
    v_mfma_f32_16x16x32_bf16 a[84:87], a[176:179], a[136:139], a[84:87]
    v_mfma_f32_16x16x32_bf16 a[88:91], a[176:179], a[140:143], a[88:91]
    ds_read_b64_tr_b16 a[170:171], v182 offset:58496
    v_mfma_f32_16x16x32_bf16 a[92:95], a[176:179], a[144:147], a[92:95]
    s_waitcnt lgkmcnt(10)
    v_mfma_f32_16x16x32_bf16 a[200:203], a[180:183], a[132:135], a[200:203]
    ds_read_b64_tr_b16 a[172:173], v184 offset:55424
    v_mfma_f32_16x16x32_bf16 a[204:207], a[180:183], a[136:139], a[204:207]
    buffer_load_dwordx4 v175, s[8:11], s28 offen offset:3072 sc1 lds
    v_mfma_f32_16x16x32_bf16 a[208:211], a[180:183], a[140:143], a[208:211]
    ds_read_b64_tr_b16 a[174:175], v184 offset:58496
    v_mfma_f32_16x16x32_bf16 a[212:215], a[180:183], a[144:147], a[212:215]
    s_waitcnt lgkmcnt(8)
    v_mfma_f32_16x16x32_bf16 a[96:99], a[152:155], a[132:135], a[96:99]
    ds_read_b64_tr_b16 a[176:177], v182 offset:55296
    v_mfma_f32_16x16x32_bf16 a[100:103], a[152:155], a[136:139], a[100:103]
    v_mfma_f32_16x16x32_bf16 a[104:107], a[152:155], a[140:143], a[104:107]
    ds_read_b64_tr_b16 a[178:179], v182 offset:58368
    v_mfma_f32_16x16x32_bf16 a[108:111], a[152:155], a[144:147], a[108:111]
    v_mfma_f32_16x16x32_bf16 a[216:219], a[156:159], a[132:135], a[216:219]
    ds_read_b64_tr_b16 a[180:181], v184 offset:55296
    v_mfma_f32_16x16x32_bf16 a[220:223], a[156:159], a[136:139], a[220:223]
    v_mfma_f32_16x16x32_bf16 a[224:227], a[156:159], a[140:143], a[224:227]
    ds_read_b64_tr_b16 a[182:183], v184 offset:58368
    v_mfma_f32_16x16x32_bf16 a[228:231], a[156:159], a[144:147], a[228:231]
    s_waitcnt lgkmcnt(10)
    v_mfma_f32_16x16x32_bf16 v[36:39], a[160:163], a[132:135], v[36:39]
    v_mfma_f32_16x16x32_bf16 v[44:47], a[160:163], a[136:139], v[44:47]
    v_mfma_f32_16x16x32_bf16 v[52:55], a[160:163], a[140:143], v[52:55]
    v_mfma_f32_16x16x32_bf16 v[60:63], a[160:163], a[144:147], v[60:63]
    s_waitcnt lgkmcnt(8)
    v_mfma_f32_16x16x32_bf16 v[40:43], a[164:167], a[132:135], v[40:43]
    v_mfma_f32_16x16x32_bf16 v[48:51], a[164:167], a[136:139], v[48:51]
    v_mfma_f32_16x16x32_bf16 v[56:59], a[164:167], a[140:143], v[56:59]
    s_add_u32 s28, s28, 131072
    v_mfma_f32_16x16x32_bf16 v[64:67], a[164:167], a[144:147], v[64:67]
    v_mfma_f32_16x16x32_bf16 v[100:103], a[164:167], a[148:151], v[100:103]
    s_waitcnt vmcnt(18) lgkmcnt(0)
    s_barrier
    s_cmp_eq_u32 s31, 1
    s_cbranch_scc1 L_g1_fin
    ds_read_b128 a[112:115], v179 offset:0
    v_mfma_f32_16x16x32_bf16 v[68:71], a[132:135], a[168:171], v[68:71]
    ds_read_b64_tr_b16 a[152:153], v187 offset:0
    s_mov_b32 m0, 47104
    v_mfma_f32_16x16x32_bf16 v[76:79], a[136:139], a[168:171], v[76:79]
    ds_read_b64_tr_b16 a[154:155], v187 offset:3584
    buffer_load_dwordx4 v168, s[8:11], s28 offen offset:0 sc1 lds
    v_mfma_f32_16x16x32_bf16 v[84:87], a[140:143], a[168:171], v[84:87]
    ds_read_b128 a[116:119], v179 offset:1024
    v_mfma_f32_16x16x32_bf16 v[92:95], a[144:147], a[168:171], v[92:95]
    ds_read_b128 a[120:123], v179 offset:2048
    v_mfma_f32_16x16x32_bf16 v[72:75], a[132:135], a[172:175], v[72:75]
    ds_read_b128 a[124:127], v179 offset:3072
    v_mfma_f32_16x16x32_bf16 v[80:83], a[136:139], a[172:175], v[80:83]
    ds_read_b64_tr_b16 a[156:157], v187 offset:7168
    v_mfma_f32_16x16x32_bf16 v[88:91], a[140:143], a[172:175], v[88:91]
    ds_read_b64_tr_b16 a[158:159], v187 offset:10752
    v_mfma_f32_16x16x32_bf16 v[96:99], a[144:147], a[172:175], v[96:99]
    ds_read_b128 a[128:131], v181 offset:0
    v_mfma_f32_16x16x32_bf16 v[4:7], a[176:179], a[132:135], v[4:7]
    ds_read_b64_tr_b16 a[160:161], v187 offset:32
    v_mfma_f32_16x16x32_bf16 v[12:15], a[176:179], a[136:139], v[12:15]
    ds_read_b64_tr_b16 a[162:163], v187 offset:3616
    v_mfma_f32_16x16x32_bf16 v[20:23], a[176:179], a[140:143], v[20:23]
    ds_read_b64_tr_b16 a[164:165], v187 offset:7200
    v_mfma_f32_16x16x32_bf16 v[28:31], a[176:179], a[144:147], v[28:31]
    ds_read_b64_tr_b16 a[166:167], v187 offset:10784
    v_mfma_f32_16x16x32_bf16 v[8:11], a[180:183], a[132:135], v[8:11]
    buffer_load_dwordx4 v169, s[8:11], s28 offen offset:1024 sc1 lds
    v_mfma_f32_16x16x32_bf16 v[16:19], a[180:183], a[136:139], v[16:19]
    v_mfma_f32_16x16x32_bf16 v[24:27], a[180:183], a[140:143], v[24:27]
    v_mfma_f32_16x16x32_bf16 v[32:35], a[180:183], a[144:147], v[32:35]
    ds_read_b64_tr_b16 a[172:173], v187 offset:7232
    s_waitcnt lgkmcnt(11)
    v_mfma_f32_16x16x32_bf16 a[0:3], a[152:155], a[112:115], a[0:3]
    ds_read_b64_tr_b16 a[168:169], v187 offset:64
    s_waitcnt lgkmcnt(11)
    v_mfma_f32_16x16x32_bf16 a[4:7], a[152:155], a[116:119], a[4:7]
    ds_read_b64_tr_b16 a[174:175], v187 offset:10816
    s_waitcnt lgkmcnt(11)
    v_mfma_f32_16x16x32_bf16 a[8:11], a[152:155], a[120:123], a[8:11]
    ds_read_b64_tr_b16 a[170:171], v187 offset:3648
    s_waitcnt lgkmcnt(11)
    v_mfma_f32_16x16x32_bf16 a[12:15], a[152:155], a[124:127], a[12:15]
    s_waitcnt lgkmcnt(9)
    v_mfma_f32_16x16x32_bf16 v[104:107], a[156:159], a[112:115], v[104:107]
    ds_read_b64_tr_b16 a[176:177], v187 offset:96
    v_mfma_f32_16x16x32_bf16 v[108:111], a[156:159], a[116:119], v[108:111]
    buffer_load_dwordx4 v170, s[8:11], s28 offen offset:2048 sc1 lds
    v_mfma_f32_16x16x32_bf16 v[112:115], a[156:159], a[120:123], v[112:115]
    ds_read_b64_tr_b16 a[178:179], v187 offset:3680
    v_mfma_f32_16x16x32_bf16 v[116:119], a[156:159], a[124:127], v[116:119]
    s_waitcnt lgkmcnt(8)
    v_mfma_f32_16x16x32_bf16 a[16:19], a[160:163], a[112:115], a[16:19]
    ds_read_b64_tr_b16 a[180:181], v187 offset:7264
    v_mfma_f32_16x16x32_bf16 a[20:23], a[160:163], a[116:119], a[20:23]
    buffer_load_dwordx4 v171, s[8:11], s28 offen offset:3072 sc1 lds
    v_mfma_f32_16x16x32_bf16 a[24:27], a[160:163], a[120:123], a[24:27]
    ds_read_b64_tr_b16 a[182:183], v187 offset:10848
    v_mfma_f32_16x16x32_bf16 a[28:31], a[160:163], a[124:127], a[28:31]
    s_waitcnt lgkmcnt(8)
    v_mfma_f32_16x16x32_bf16 v[120:123], a[164:167], a[112:115], v[120:123]
    ds_read_b64_tr_b16 a[152:153], v187 offset:128
    v_mfma_f32_16x16x32_bf16 v[124:127], a[164:167], a[116:119], v[124:127]
    v_mfma_f32_16x16x32_bf16 v[128:131], a[164:167], a[120:123], v[128:131]
    ds_read_b64_tr_b16 a[154:155], v187 offset:3712
    v_mfma_f32_16x16x32_bf16 v[132:135], a[164:167], a[124:127], v[132:135]
    s_waitcnt lgkmcnt(6)
    v_mfma_f32_16x16x32_bf16 a[32:35], a[168:171], a[112:115], a[32:35]
    ds_read_b64_tr_b16 a[156:157], v187 offset:7296
    v_mfma_f32_16x16x32_bf16 a[36:39], a[168:171], a[116:119], a[36:39]
    s_mov_b32 m0, 51200
    v_mfma_f32_16x16x32_bf16 a[40:43], a[168:171], a[120:123], a[40:43]
    ds_read_b64_tr_b16 a[158:159], v187 offset:10880
    v_mfma_f32_16x16x32_bf16 a[44:47], a[168:171], a[124:127], a[44:47]
    buffer_load_dwordx4 v172, s[8:11], s28 offen offset:0 sc1 lds
    v_mfma_f32_16x16x32_bf16 v[136:139], a[172:175], a[112:115], v[136:139]
    ds_read_b64_tr_b16 a[160:161], v187 offset:160
    v_mfma_f32_16x16x32_bf16 v[140:143], a[172:175], a[116:119], v[140:143]
    v_mfma_f32_16x16x32_bf16 v[144:147], a[172:175], a[120:123], v[144:147]
    ds_read_b64_tr_b16 a[162:163], v187 offset:3744
    v_mfma_f32_16x16x32_bf16 v[148:151], a[172:175], a[124:127], v[148:151]
    s_waitcnt lgkmcnt(8)
    v_mfma_f32_16x16x32_bf16 a[48:51], a[176:179], a[112:115], a[48:51]
    ds_read_b64_tr_b16 a[164:165], v187 offset:7328
    v_mfma_f32_16x16x32_bf16 a[52:55], a[176:179], a[116:119], a[52:55]
    v_mfma_f32_16x16x32_bf16 a[56:59], a[176:179], a[120:123], a[56:59]
    ds_read_b64_tr_b16 a[166:167], v187 offset:10912
    v_mfma_f32_16x16x32_bf16 a[60:63], a[176:179], a[124:127], a[60:63]
    ds_read_b64_tr_b16 a[172:173], v187 offset:7360
    s_waitcnt lgkmcnt(9)
    v_mfma_f32_16x16x32_bf16 v[152:155], a[180:183], a[112:115], v[152:155]
    ds_read_b64_tr_b16 a[168:169], v187 offset:192
    v_mfma_f32_16x16x32_bf16 v[156:159], a[180:183], a[116:119], v[156:159]
    ds_read_b64_tr_b16 a[174:175], v187 offset:10944
    buffer_load_dwordx4 v173, s[8:11], s28 offen offset:1024 sc1 lds
    v_mfma_f32_16x16x32_bf16 v[160:163], a[180:183], a[120:123], v[160:163]
    ds_read_b64_tr_b16 a[170:171], v187 offset:3776
    v_mfma_f32_16x16x32_bf16 v[164:167], a[180:183], a[124:127], v[164:167]
    s_waitcnt lgkmcnt(10)
    v_mfma_f32_16x16x32_bf16 a[64:67], a[152:155], a[112:115], a[64:67]
    ds_read_b64_tr_b16 a[176:177], v183 offset:17472
    v_mfma_f32_16x16x32_bf16 a[68:71], a[152:155], a[116:119], a[68:71]
    v_mfma_f32_16x16x32_bf16 a[72:75], a[152:155], a[120:123], a[72:75]
    ds_read_b64_tr_b16 a[178:179], v183 offset:20544
    v_mfma_f32_16x16x32_bf16 a[76:79], a[152:155], a[124:127], a[76:79]
    s_waitcnt lgkmcnt(10)
    v_mfma_f32_16x16x32_bf16 a[184:187], a[156:159], a[112:115], a[184:187]
    ds_read_b64_tr_b16 a[180:181], v185 offset:17472
    v_mfma_f32_16x16x32_bf16 a[188:191], a[156:159], a[116:119], a[188:191]
    buffer_load_dwordx4 v174, s[8:11], s28 offen offset:2048 sc1 lds
    v_mfma_f32_16x16x32_bf16 a[192:195], a[156:159], a[120:123], a[192:195]
    ds_read_b64_tr_b16 a[182:183], v185 offset:20544
    v_mfma_f32_16x16x32_bf16 a[196:199], a[156:159], a[124:127], a[196:199]
    s_waitcnt lgkmcnt(10)
    v_mfma_f32_16x16x32_bf16 a[80:83], a[160:163], a[112:115], a[80:83]
    ds_read_b64_tr_b16 a[152:153], v183 offset:17536
    v_mfma_f32_16x16x32_bf16 a[84:87], a[160:163], a[116:119], a[84:87]
    v_mfma_f32_16x16x32_bf16 a[88:91], a[160:163], a[120:123], a[88:91]
    ds_read_b64_tr_b16 a[154:155], v183 offset:20608
    v_mfma_f32_16x16x32_bf16 a[92:95], a[160:163], a[124:127], a[92:95]
    s_waitcnt lgkmcnt(10)
    v_mfma_f32_16x16x32_bf16 a[200:203], a[164:167], a[112:115], a[200:203]
    ds_read_b64_tr_b16 a[156:157], v185 offset:17536
    v_mfma_f32_16x16x32_bf16 a[204:207], a[164:167], a[116:119], a[204:207]
    buffer_load_dwordx4 v175, s[8:11], s28 offen offset:3072 sc1 lds
    v_mfma_f32_16x16x32_bf16 a[208:211], a[164:167], a[120:123], a[208:211]
    ds_read_b64_tr_b16 a[158:159], v185 offset:20608
    v_mfma_f32_16x16x32_bf16 a[212:215], a[164:167], a[124:127], a[212:215]
    s_waitcnt lgkmcnt(8)
    v_mfma_f32_16x16x32_bf16 a[96:99], a[168:171], a[112:115], a[96:99]
    ds_read_b64_tr_b16 a[160:161], v183 offset:17408
    v_mfma_f32_16x16x32_bf16 a[100:103], a[168:171], a[116:119], a[100:103]
    v_mfma_f32_16x16x32_bf16 a[104:107], a[168:171], a[120:123], a[104:107]
    ds_read_b64_tr_b16 a[162:163], v183 offset:20480
    v_mfma_f32_16x16x32_bf16 a[108:111], a[168:171], a[124:127], a[108:111]
    v_mfma_f32_16x16x32_bf16 a[216:219], a[172:175], a[112:115], a[216:219]
    ds_read_b64_tr_b16 a[164:165], v185 offset:17408
    v_mfma_f32_16x16x32_bf16 a[220:223], a[172:175], a[116:119], a[220:223]
    v_mfma_f32_16x16x32_bf16 a[224:227], a[172:175], a[120:123], a[224:227]
    ds_read_b64_tr_b16 a[166:167], v185 offset:20480
    v_mfma_f32_16x16x32_bf16 a[228:231], a[172:175], a[124:127], a[228:231]
    s_waitcnt lgkmcnt(10)
    v_mfma_f32_16x16x32_bf16 v[36:39], a[176:179], a[112:115], v[36:39]
    v_mfma_f32_16x16x32_bf16 v[44:47], a[176:179], a[116:119], v[44:47]
    v_mfma_f32_16x16x32_bf16 v[52:55], a[176:179], a[120:123], v[52:55]
    v_mfma_f32_16x16x32_bf16 v[60:63], a[176:179], a[124:127], v[60:63]
    s_waitcnt lgkmcnt(8)
    v_mfma_f32_16x16x32_bf16 v[40:43], a[180:183], a[112:115], v[40:43]
    v_mfma_f32_16x16x32_bf16 v[48:51], a[180:183], a[116:119], v[48:51]
    v_mfma_f32_16x16x32_bf16 v[56:59], a[180:183], a[120:123], v[56:59]
    s_add_u32 s28, s28, 131072
    v_mfma_f32_16x16x32_bf16 v[64:67], a[180:183], a[124:127], v[64:67]
    v_mfma_f32_16x16x32_bf16 v[100:103], a[180:183], a[128:131], v[100:103]
    s_waitcnt vmcnt(18) lgkmcnt(0)
    s_barrier
    ds_read_b128 a[132:135], v179 offset:37888
    v_mfma_f32_16x16x32_bf16 v[68:71], a[112:115], a[152:155], v[68:71]
    ds_read_b64_tr_b16 a[168:169], v187 offset:37888
    s_mov_b32 m0, 84992
    v_mfma_f32_16x16x32_bf16 v[76:79], a[116:119], a[152:155], v[76:79]
    ds_read_b64_tr_b16 a[170:171], v187 offset:41472
    buffer_load_dwordx4 v168, s[8:11], s28 offen offset:0 sc1 lds
    v_mfma_f32_16x16x32_bf16 v[84:87], a[120:123], a[152:155], v[84:87]
    ds_read_b128 a[136:139], v179 offset:38912
    v_mfma_f32_16x16x32_bf16 v[92:95], a[124:127], a[152:155], v[92:95]
    ds_read_b128 a[140:143], v179 offset:39936
    v_mfma_f32_16x16x32_bf16 v[72:75], a[112:115], a[156:159], v[72:75]
    ds_read_b128 a[144:147], v179 offset:40960
    v_mfma_f32_16x16x32_bf16 v[80:83], a[116:119], a[156:159], v[80:83]
    ds_read_b64_tr_b16 a[172:173], v187 offset:45056
    v_mfma_f32_16x16x32_bf16 v[88:91], a[120:123], a[156:159], v[88:91]
    ds_read_b64_tr_b16 a[174:175], v187 offset:48640
    v_mfma_f32_16x16x32_bf16 v[96:99], a[124:127], a[156:159], v[96:99]
    ds_read_b128 a[148:151], v181 offset:37888
    v_mfma_f32_16x16x32_bf16 v[4:7], a[160:163], a[112:115], v[4:7]
    ds_read_b64_tr_b16 a[176:177], v187 offset:37920
    v_mfma_f32_16x16x32_bf16 v[12:15], a[160:163], a[116:119], v[12:15]
    ds_read_b64_tr_b16 a[178:179], v187 offset:41504
    v_mfma_f32_16x16x32_bf16 v[20:23], a[160:163], a[120:123], v[20:23]
    ds_read_b64_tr_b16 a[180:181], v187 offset:45088
    v_mfma_f32_16x16x32_bf16 v[28:31], a[160:163], a[124:127], v[28:31]
    ds_read_b64_tr_b16 a[182:183], v187 offset:48672
    v_mfma_f32_16x16x32_bf16 v[8:11], a[164:167], a[112:115], v[8:11]
    buffer_load_dwordx4 v169, s[8:11], s28 offen offset:1024 sc1 lds
    v_mfma_f32_16x16x32_bf16 v[16:19], a[164:167], a[116:119], v[16:19]
    v_mfma_f32_16x16x32_bf16 v[24:27], a[164:167], a[120:123], v[24:27]
    v_mfma_f32_16x16x32_bf16 v[32:35], a[164:167], a[124:127], v[32:35]
    ds_read_b64_tr_b16 a[156:157], v187 offset:45120
    s_waitcnt lgkmcnt(11)
    v_mfma_f32_16x16x32_bf16 a[0:3], a[168:171], a[132:135], a[0:3]
    ds_read_b64_tr_b16 a[152:153], v187 offset:37952
    s_waitcnt lgkmcnt(11)
    v_mfma_f32_16x16x32_bf16 a[4:7], a[168:171], a[136:139], a[4:7]
    ds_read_b64_tr_b16 a[158:159], v187 offset:48704
    s_waitcnt lgkmcnt(11)
    v_mfma_f32_16x16x32_bf16 a[8:11], a[168:171], a[140:143], a[8:11]
    ds_read_b64_tr_b16 a[154:155], v187 offset:41536
    s_waitcnt lgkmcnt(11)
    v_mfma_f32_16x16x32_bf16 a[12:15], a[168:171], a[144:147], a[12:15]
    s_waitcnt lgkmcnt(9)
    v_mfma_f32_16x16x32_bf16 v[104:107], a[172:175], a[132:135], v[104:107]
    ds_read_b64_tr_b16 a[160:161], v187 offset:37984
    v_mfma_f32_16x16x32_bf16 v[108:111], a[172:175], a[136:139], v[108:111]
    buffer_load_dwordx4 v170, s[8:11], s28 offen offset:2048 sc1 lds
    v_mfma_f32_16x16x32_bf16 v[112:115], a[172:175], a[140:143], v[112:115]
    ds_read_b64_tr_b16 a[162:163], v187 offset:41568
    v_mfma_f32_16x16x32_bf16 v[116:119], a[172:175], a[144:147], v[116:119]
    s_waitcnt lgkmcnt(8)
    v_mfma_f32_16x16x32_bf16 a[16:19], a[176:179], a[132:135], a[16:19]
    ds_read_b64_tr_b16 a[164:165], v187 offset:45152
    v_mfma_f32_16x16x32_bf16 a[20:23], a[176:179], a[136:139], a[20:23]
    buffer_load_dwordx4 v171, s[8:11], s28 offen offset:3072 sc1 lds
    v_mfma_f32_16x16x32_bf16 a[24:27], a[176:179], a[140:143], a[24:27]
    ds_read_b64_tr_b16 a[166:167], v187 offset:48736
    v_mfma_f32_16x16x32_bf16 a[28:31], a[176:179], a[144:147], a[28:31]
    s_waitcnt lgkmcnt(8)
    v_mfma_f32_16x16x32_bf16 v[120:123], a[180:183], a[132:135], v[120:123]
    ds_read_b64_tr_b16 a[168:169], v187 offset:38016
    v_mfma_f32_16x16x32_bf16 v[124:127], a[180:183], a[136:139], v[124:127]
    v_mfma_f32_16x16x32_bf16 v[128:131], a[180:183], a[140:143], v[128:131]
    ds_read_b64_tr_b16 a[170:171], v187 offset:41600
    v_mfma_f32_16x16x32_bf16 v[132:135], a[180:183], a[144:147], v[132:135]
    s_waitcnt lgkmcnt(6)
    v_mfma_f32_16x16x32_bf16 a[32:35], a[152:155], a[132:135], a[32:35]
    ds_read_b64_tr_b16 a[172:173], v187 offset:45184
    v_mfma_f32_16x16x32_bf16 a[36:39], a[152:155], a[136:139], a[36:39]
    s_mov_b32 m0, 89088
    v_mfma_f32_16x16x32_bf16 a[40:43], a[152:155], a[140:143], a[40:43]
    ds_read_b64_tr_b16 a[174:175], v187 offset:48768
    v_mfma_f32_16x16x32_bf16 a[44:47], a[152:155], a[144:147], a[44:47]
    buffer_load_dwordx4 v172, s[8:11], s28 offen offset:0 sc1 lds
    v_mfma_f32_16x16x32_bf16 v[136:139], a[156:159], a[132:135], v[136:139]
    ds_read_b64_tr_b16 a[176:177], v187 offset:38048
    v_mfma_f32_16x16x32_bf16 v[140:143], a[156:159], a[136:139], v[140:143]
    v_mfma_f32_16x16x32_bf16 v[144:147], a[156:159], a[140:143], v[144:147]
    ds_read_b64_tr_b16 a[178:179], v187 offset:41632
    v_mfma_f32_16x16x32_bf16 v[148:151], a[156:159], a[144:147], v[148:151]
    s_waitcnt lgkmcnt(8)
    v_mfma_f32_16x16x32_bf16 a[48:51], a[160:163], a[132:135], a[48:51]
    ds_read_b64_tr_b16 a[180:181], v187 offset:45216
    v_mfma_f32_16x16x32_bf16 a[52:55], a[160:163], a[136:139], a[52:55]
    v_mfma_f32_16x16x32_bf16 a[56:59], a[160:163], a[140:143], a[56:59]
    ds_read_b64_tr_b16 a[182:183], v187 offset:48800
    v_mfma_f32_16x16x32_bf16 a[60:63], a[160:163], a[144:147], a[60:63]
    ds_read_b64_tr_b16 a[156:157], v187 offset:45248
    s_waitcnt lgkmcnt(9)
    v_mfma_f32_16x16x32_bf16 v[152:155], a[164:167], a[132:135], v[152:155]
    ds_read_b64_tr_b16 a[152:153], v187 offset:38080
    v_mfma_f32_16x16x32_bf16 v[156:159], a[164:167], a[136:139], v[156:159]
    ds_read_b64_tr_b16 a[158:159], v187 offset:48832
    buffer_load_dwordx4 v173, s[8:11], s28 offen offset:1024 sc1 lds
    v_mfma_f32_16x16x32_bf16 v[160:163], a[164:167], a[140:143], v[160:163]
    ds_read_b64_tr_b16 a[154:155], v187 offset:41664
    v_mfma_f32_16x16x32_bf16 v[164:167], a[164:167], a[144:147], v[164:167]
    s_waitcnt lgkmcnt(10)
    v_mfma_f32_16x16x32_bf16 a[64:67], a[168:171], a[132:135], a[64:67]
    ds_read_b64_tr_b16 a[160:161], v183 offset:55360
    v_mfma_f32_16x16x32_bf16 a[68:71], a[168:171], a[136:139], a[68:71]
    v_mfma_f32_16x16x32_bf16 a[72:75], a[168:171], a[140:143], a[72:75]
    ds_read_b64_tr_b16 a[162:163], v183 offset:58432
    v_mfma_f32_16x16x32_bf16 a[76:79], a[168:171], a[144:147], a[76:79]
    s_waitcnt lgkmcnt(10)
    v_mfma_f32_16x16x32_bf16 a[184:187], a[172:175], a[132:135], a[184:187]
    ds_read_b64_tr_b16 a[164:165], v185 offset:55360
    v_mfma_f32_16x16x32_bf16 a[188:191], a[172:175], a[136:139], a[188:191]
    buffer_load_dwordx4 v174, s[8:11], s28 offen offset:2048 sc1 lds
    v_mfma_f32_16x16x32_bf16 a[192:195], a[172:175], a[140:143], a[192:195]
    ds_read_b64_tr_b16 a[166:167], v185 offset:58432
    v_mfma_f32_16x16x32_bf16 a[196:199], a[172:175], a[144:147], a[196:199]
    s_waitcnt lgkmcnt(10)
    v_mfma_f32_16x16x32_bf16 a[80:83], a[176:179], a[132:135], a[80:83]
    ds_read_b64_tr_b16 a[168:169], v183 offset:55424
    v_mfma_f32_16x16x32_bf16 a[84:87], a[176:179], a[136:139], a[84:87]
    v_mfma_f32_16x16x32_bf16 a[88:91], a[176:179], a[140:143], a[88:91]
    ds_read_b64_tr_b16 a[170:171], v183 offset:58496
    v_mfma_f32_16x16x32_bf16 a[92:95], a[176:179], a[144:147], a[92:95]
    s_waitcnt lgkmcnt(10)
    v_mfma_f32_16x16x32_bf16 a[200:203], a[180:183], a[132:135], a[200:203]
    ds_read_b64_tr_b16 a[172:173], v185 offset:55424
    v_mfma_f32_16x16x32_bf16 a[204:207], a[180:183], a[136:139], a[204:207]
    buffer_load_dwordx4 v175, s[8:11], s28 offen offset:3072 sc1 lds
    v_mfma_f32_16x16x32_bf16 a[208:211], a[180:183], a[140:143], a[208:211]
    ds_read_b64_tr_b16 a[174:175], v185 offset:58496
    v_mfma_f32_16x16x32_bf16 a[212:215], a[180:183], a[144:147], a[212:215]
    s_waitcnt lgkmcnt(8)
    v_mfma_f32_16x16x32_bf16 a[96:99], a[152:155], a[132:135], a[96:99]
    ds_read_b64_tr_b16 a[176:177], v183 offset:55296
    v_mfma_f32_16x16x32_bf16 a[100:103], a[152:155], a[136:139], a[100:103]
    v_mfma_f32_16x16x32_bf16 a[104:107], a[152:155], a[140:143], a[104:107]
    ds_read_b64_tr_b16 a[178:179], v183 offset:58368
    v_mfma_f32_16x16x32_bf16 a[108:111], a[152:155], a[144:147], a[108:111]
    v_mfma_f32_16x16x32_bf16 a[216:219], a[156:159], a[132:135], a[216:219]
    ds_read_b64_tr_b16 a[180:181], v185 offset:55296
    v_mfma_f32_16x16x32_bf16 a[220:223], a[156:159], a[136:139], a[220:223]
    v_mfma_f32_16x16x32_bf16 a[224:227], a[156:159], a[140:143], a[224:227]
    ds_read_b64_tr_b16 a[182:183], v185 offset:58368
    v_mfma_f32_16x16x32_bf16 a[228:231], a[156:159], a[144:147], a[228:231]
    s_waitcnt lgkmcnt(10)
    v_mfma_f32_16x16x32_bf16 v[36:39], a[160:163], a[132:135], v[36:39]
    v_mfma_f32_16x16x32_bf16 v[44:47], a[160:163], a[136:139], v[44:47]
    v_mfma_f32_16x16x32_bf16 v[52:55], a[160:163], a[140:143], v[52:55]
    v_mfma_f32_16x16x32_bf16 v[60:63], a[160:163], a[144:147], v[60:63]
    s_waitcnt lgkmcnt(8)
    v_mfma_f32_16x16x32_bf16 v[40:43], a[164:167], a[132:135], v[40:43]
    v_mfma_f32_16x16x32_bf16 v[48:51], a[164:167], a[136:139], v[48:51]
    v_mfma_f32_16x16x32_bf16 v[56:59], a[164:167], a[140:143], v[56:59]
    s_add_u32 s28, s28, 131072
    v_mfma_f32_16x16x32_bf16 v[64:67], a[164:167], a[144:147], v[64:67]
    v_mfma_f32_16x16x32_bf16 v[100:103], a[164:167], a[148:151], v[100:103]
    s_waitcnt vmcnt(16) lgkmcnt(0)
    s_barrier
    s_sub_u32 s31, s31, 1
    s_branch L_g1_loop1
L_g1_w2:
    v_add_u32 v188, 0, v1
    v_mul_u32_u24 v189, s52, v188
    v_lshrrev_b32 v189, 16, v189
    v_mul_u32_u24 v190, 12, v189
    v_sub_u32 v190, v188, v190
    v_bfe_u32 v191, v189, 2, 2
    v_lshlrev_b32 v191, 3, v191
    v_lshrrev_b32 v192, 4, v189
    v_lshl_add_u32 v191, v192, 2, v191
    v_and_b32 v192, 3, v189
    v_add_u32 v191, v191, v192
    v_mul_u32_u24 v191, s54, v191
    v_lshrrev_b32 v192, 2, v190
    v_lshl_add_u32 v191, v192, 11, v191
    v_lshrrev_b32 v192, 1, v189
    v_xor_b32 v192, v192, v190
    v_and_b32 v192, 2, v192
    v_and_or_b32 v192, v190, 1, v192
    v_lshl_add_u32 v191, v192, 4, v191
    v_subrev_u32 v168, 0, v191
    v_add_u32 v188, 64, v1
    v_mul_u32_u24 v189, s52, v188
    v_lshrrev_b32 v189, 16, v189
    v_mul_u32_u24 v190, 12, v189
    v_sub_u32 v190, v188, v190
    v_bfe_u32 v191, v189, 2, 2
    v_lshlrev_b32 v191, 3, v191
    v_lshrrev_b32 v192, 4, v189
    v_lshl_add_u32 v191, v192, 2, v191
    v_and_b32 v192, 3, v189
    v_add_u32 v191, v191, v192
    v_mul_u32_u24 v191, s54, v191
    v_lshrrev_b32 v192, 2, v190
    v_lshl_add_u32 v191, v192, 11, v191
    v_lshrrev_b32 v192, 1, v189
    v_xor_b32 v192, v192, v190
    v_and_b32 v192, 2, v192
    v_and_or_b32 v192, v190, 1, v192
    v_lshl_add_u32 v191, v192, 4, v191
    v_subrev_u32 v169, 1024, v191
    v_add_u32 v188, 128, v1
    v_mul_u32_u24 v189, s52, v188
    v_lshrrev_b32 v189, 16, v189
    v_mul_u32_u24 v190, 12, v189
    v_sub_u32 v190, v188, v190
    v_bfe_u32 v191, v189, 2, 2
    v_lshlrev_b32 v191, 3, v191
    v_lshrrev_b32 v192, 4, v189
    v_lshl_add_u32 v191, v192, 2, v191
    v_and_b32 v192, 3, v189
    v_add_u32 v191, v191, v192
    v_mul_u32_u24 v191, s54, v191
    v_lshrrev_b32 v192, 2, v190
    v_lshl_add_u32 v191, v192, 11, v191
    v_lshrrev_b32 v192, 1, v189
    v_xor_b32 v192, v192, v190
    v_and_b32 v192, 2, v192
    v_and_or_b32 v192, v190, 1, v192
    v_lshl_add_u32 v191, v192, 4, v191
    v_subrev_u32 v170, 2048, v191
    v_add_u32 v188, 192, v1
    v_mul_u32_u24 v189, s52, v188
    v_lshrrev_b32 v189, 16, v189
    v_mul_u32_u24 v190, 12, v189
    v_sub_u32 v190, v188, v190
    v_bfe_u32 v191, v189, 2, 2
    v_lshlrev_b32 v191, 3, v191
    v_lshrrev_b32 v192, 4, v189
    v_lshl_add_u32 v191, v192, 2, v191
    v_and_b32 v192, 3, v189
    v_add_u32 v191, v191, v192
    v_mul_u32_u24 v191, s54, v191
    v_lshrrev_b32 v192, 2, v190
    v_lshl_add_u32 v191, v192, 11, v191
    v_lshrrev_b32 v192, 1, v189
    v_xor_b32 v192, v192, v190
    v_and_b32 v192, 2, v192
    v_and_or_b32 v192, v190, 1, v192
    v_lshl_add_u32 v191, v192, 4, v191
    v_subrev_u32 v171, 3072, v191
    v_add_u32 v188, 256, v1
    v_mul_u32_u24 v189, s52, v188
    v_lshrrev_b32 v189, 16, v189
    v_mul_u32_u24 v190, 12, v189
    v_sub_u32 v190, v188, v190
    v_bfe_u32 v191, v189, 2, 2
    v_lshlrev_b32 v191, 3, v191
    v_lshrrev_b32 v192, 4, v189
    v_lshl_add_u32 v191, v192, 2, v191
    v_and_b32 v192, 3, v189
    v_add_u32 v191, v191, v192
    v_mul_u32_u24 v191, s54, v191
    v_lshrrev_b32 v192, 2, v190
    v_lshl_add_u32 v191, v192, 11, v191
    v_lshrrev_b32 v192, 1, v189
    v_xor_b32 v192, v192, v190
    v_and_b32 v192, 2, v192
    v_and_or_b32 v192, v190, 1, v192
    v_lshl_add_u32 v191, v192, 4, v191
    v_subrev_u32 v172, 0, v191
    v_add_u32 v188, 320, v1
    v_mul_u32_u24 v189, s52, v188
    v_lshrrev_b32 v189, 16, v189
    v_mul_u32_u24 v190, 12, v189
    v_sub_u32 v190, v188, v190
    v_bfe_u32 v191, v189, 2, 2
    v_lshlrev_b32 v191, 3, v191
    v_lshrrev_b32 v192, 4, v189
    v_lshl_add_u32 v191, v192, 2, v191
    v_and_b32 v192, 3, v189
    v_add_u32 v191, v191, v192
    v_mul_u32_u24 v191, s54, v191
    v_lshrrev_b32 v192, 2, v190
    v_lshl_add_u32 v191, v192, 11, v191
    v_lshrrev_b32 v192, 1, v189
    v_xor_b32 v192, v192, v190
    v_and_b32 v192, 2, v192
    v_and_or_b32 v192, v190, 1, v192
    v_lshl_add_u32 v191, v192, 4, v191
    v_subrev_u32 v173, 1024, v191
    v_add_u32 v188, 0, v1
    v_mul_u32_u24 v189, s53, v188
    v_lshrrev_b32 v189, 16, v189
    v_mul_u32_u24 v190, 14, v189
    v_sub_u32 v190, v188, v190
    v_add_u32 v190, s46, v190
    v_subrev_u32 v192, 14, v190
    v_min_u32 v190, v190, v192
    v_bfe_u32 v191, v189, 2, 2
    v_lshlrev_b32 v191, 3, v191
    v_lshrrev_b32 v192, 4, v189
    v_lshl_add_u32 v191, v192, 2, v191
    v_and_b32 v192, 3, v189
    v_add_u32 v191, v191, v192
    v_mul_u32_u24 v191, s55, v191
    v_lshl_add_u32 v191, v190, 4, v191
    v_subrev_u32 v174, 2048, v191
    v_add_u32 v188, 64, v1
    v_mul_u32_u24 v189, s53, v188
    v_lshrrev_b32 v189, 16, v189
    v_mul_u32_u24 v190, 14, v189
    v_sub_u32 v190, v188, v190
    v_add_u32 v190, s46, v190
    v_subrev_u32 v192, 14, v190
    v_min_u32 v190, v190, v192
    v_bfe_u32 v191, v189, 2, 2
    v_lshlrev_b32 v191, 3, v191
    v_lshrrev_b32 v192, 4, v189
    v_lshl_add_u32 v191, v192, 2, v191
    v_and_b32 v192, 3, v189
    v_add_u32 v191, v191, v192
    v_mul_u32_u24 v191, s55, v191
    v_lshl_add_u32 v191, v190, 4, v191
    v_subrev_u32 v175, 3072, v191
    v_add_u32 v188, 128, v1
    v_mul_u32_u24 v189, s53, v188
    v_lshrrev_b32 v189, 16, v189
    v_mul_u32_u24 v190, 14, v189
    v_sub_u32 v190, v188, v190
    v_add_u32 v190, s46, v190
    v_subrev_u32 v192, 14, v190
    v_min_u32 v190, v190, v192
    v_bfe_u32 v191, v189, 2, 2
    v_lshlrev_b32 v191, 3, v191
    v_lshrrev_b32 v192, 4, v189
    v_lshl_add_u32 v191, v192, 2, v191
    v_and_b32 v192, 3, v189
    v_add_u32 v191, v191, v192
    v_mul_u32_u24 v191, s55, v191
    v_lshl_add_u32 v191, v190, 4, v191
    v_subrev_u32 v176, 0, v191
    v_add_u32 v188, 192, v1
    v_mul_u32_u24 v189, s53, v188
    v_lshrrev_b32 v189, 16, v189
    v_mul_u32_u24 v190, 14, v189
    v_sub_u32 v190, v188, v190
    v_add_u32 v190, s46, v190
    v_subrev_u32 v192, 14, v190
    v_min_u32 v190, v190, v192
    v_bfe_u32 v191, v189, 2, 2
    v_lshlrev_b32 v191, 3, v191
    v_lshrrev_b32 v192, 4, v189
    v_lshl_add_u32 v191, v192, 2, v191
    v_and_b32 v192, 3, v189
    v_add_u32 v191, v191, v192
    v_mul_u32_u24 v191, s55, v191
    v_lshl_add_u32 v191, v190, 4, v191
    v_subrev_u32 v177, 1024, v191
    v_add_u32 v178, 9216, v3
    v_add_u32 v179, 84992, v3
    s_waitcnt vmcnt(0)
    s_barrier
    s_add_u32 s8, s82, s42
    s_addc_u32 s9, s83, 0
    s_and_b32 s9, s9, 0xffff
    s_mov_b32 s10, 0
    s_mov_b32 s11, 0x00020000
    s_sub_u32 s10, 4194304, s42
    s_mov_b32 m0, 17408
    s_nop 0
    buffer_load_dwordx4 v168, s[12:15], s29 offen offset:0 sc1 lds
    buffer_load_dwordx4 v169, s[12:15], s29 offen offset:1024 sc1 lds
    buffer_load_dwordx4 v170, s[12:15], s29 offen offset:2048 sc1 lds
    buffer_load_dwordx4 v171, s[12:15], s29 offen offset:3072 sc1 lds
    s_mov_b32 m0, 21504
    s_nop 0
    buffer_load_dwordx4 v172, s[12:15], s29 offen offset:0 sc1 lds
    buffer_load_dwordx4 v173, s[12:15], s29 offen offset:1024 sc1 lds
    buffer_load_dwordx4 v174, s[16:19], s30 offen offset:2048 sc1 lds
    buffer_load_dwordx4 v175, s[16:19], s30 offen offset:3072 sc1 lds
    s_mov_b32 m0, 25600
    s_nop 0
    buffer_load_dwordx4 v176, s[16:19], s30 offen offset:0 sc1 lds
    buffer_load_dwordx4 v177, s[16:19], s30 offen offset:1024 sc1 lds
    s_add_u32 s29, s29, 196608
    s_add_u32 s30, s30, 229376
    s_mov_b32 m0, 55296
    s_nop 0
    buffer_load_dwordx4 v168, s[12:15], s29 offen offset:0 sc1 lds
    buffer_load_dwordx4 v169, s[12:15], s29 offen offset:1024 sc1 lds
    buffer_load_dwordx4 v170, s[12:15], s29 offen offset:2048 sc1 lds
    buffer_load_dwordx4 v171, s[12:15], s29 offen offset:3072 sc1 lds
    s_mov_b32 m0, 59392
    s_nop 0
    buffer_load_dwordx4 v172, s[12:15], s29 offen offset:0 sc1 lds
    buffer_load_dwordx4 v173, s[12:15], s29 offen offset:1024 sc1 lds
    buffer_load_dwordx4 v174, s[16:19], s30 offen offset:2048 sc1 lds
    buffer_load_dwordx4 v175, s[16:19], s30 offen offset:3072 sc1 lds
    s_mov_b32 m0, 63488
    s_nop 0
    buffer_load_dwordx4 v176, s[16:19], s30 offen offset:0 sc1 lds
    buffer_load_dwordx4 v177, s[16:19], s30 offen offset:1024 sc1 lds
    s_add_u32 s29, s29, 196608
    s_add_u32 s30, s30, 229376
    s_mov_b32 m0, 93184
    s_nop 0
    buffer_load_dwordx4 v168, s[12:15], s29 offen offset:0 sc1 lds
    buffer_load_dwordx4 v169, s[12:15], s29 offen offset:1024 sc1 lds
    buffer_load_dwordx4 v170, s[12:15], s29 offen offset:2048 sc1 lds
    buffer_load_dwordx4 v171, s[12:15], s29 offen offset:3072 sc1 lds
    s_mov_b32 m0, 97280
    s_nop 0
    buffer_load_dwordx4 v172, s[12:15], s29 offen offset:0 sc1 lds
    buffer_load_dwordx4 v173, s[12:15], s29 offen offset:1024 sc1 lds
    buffer_load_dwordx4 v174, s[16:19], s30 offen offset:2048 sc1 lds
    buffer_load_dwordx4 v175, s[16:19], s30 offen offset:3072 sc1 lds
    s_mov_b32 m0, 101376
    s_nop 0
    buffer_load_dwordx4 v176, s[16:19], s30 offen offset:0 sc1 lds
    buffer_load_dwordx4 v177, s[16:19], s30 offen offset:1024 sc1 lds
    s_add_u32 s29, s29, 196608
    s_add_u32 s30, s30, 229376
    s_call_b64 s[62:63], L_common
    s_and_b32 s60, s2, 1
    s_bfe_u32 s61, s2, 0x20001
    s_lshl_b32 s61, s61, 2
    s_bfe_u32 s47, s2, 0x20003
    s_add_u32 s61, s61, s47
    s_lshr_b32 s62, s2, 5
    s_lshl_b32 s63, s62, 8
    v_lshrrev_b32 v240, 4, v1
    v_bfe_u32 v241, v1, 1, 3
    v_and_b32 v242, 1, v1
    v_add_u32 v243, 0, v240
    v_xor_b32 v244, v243, v241
    v_lshl_or_b32 v244, v244, 1, v242
    v_lshlrev_b32 v243, 11, v243
    v_lshl_add_u32 v243, v244, 4, v243
    v_add_u32 v220, 0, v243
    v_add_u32 v222, 14336, v243
    v_add_u32 v224, 32768, v243
    v_add_u32 v226, 47104, v243
    v_add_u32 v243, 4, v240
    v_xor_b32 v244, v243, v241
    v_lshl_or_b32 v244, v244, 1, v242
    v_lshlrev_b32 v243, 11, v243
    v_lshl_add_u32 v243, v244, 4, v243
    v_add_u32 v221, -1024, v243
    v_add_u32 v223, 13312, v243
    v_add_u32 v225, 31744, v243
    v_add_u32 v227, 46080, v243
    v_add_u32 v228, 4096, v3
    v_add_u32 v229, 65536, v228
    v_add_u32 v230, 2048, v228
    v_add_u32 v231, 65536, v230
    v_lshrrev_b32 v240, 2, v1
    v_and_b32 v241, 7, v240
    v_and_b32 v242, 3, v1
    v_lshlrev_b32 v242, 3, v242
    v_lshl_add_u32 v242, v240, 8, v242
    v_add_u32 v242, 16384, v242
    v_xor_b32 v243, 0, v241
    v_lshl_add_u32 v232, v243, 5, v242
    v_add_u32 v233, 65536, v232
    v_xor_b32 v243, 1, v241
    v_lshl_add_u32 v234, v243, 5, v242
    v_add_u32 v235, 65536, v234
    v_xor_b32 v243, 2, v241
    v_lshl_add_u32 v236, v243, 5, v242
    v_add_u32 v237, 65536, v236
    v_xor_b32 v243, 3, v241
    v_lshl_add_u32 v238, v243, 5, v242
    v_add_u32 v239, 65536, v238
    s_lshl_b32 s47, s61, 8
    s_add_u32 s47, s47, 4096
    v_lshl_add_u32 v245, v1, 2, s47
    v_and_b32 v240, 1, v1
    v_lshlrev_b32 v240, 7, v240
    v_and_b32 v241, 2, v1
    v_lshl_add_u32 v240, v241, 9, v240
    v_and_b32 v241, 4, v1
    v_lshl_add_u32 v240, v241, 7, v240
    s_lshr_b32 s47, s2, 3
    s_lshl_b32 s47, s47, 11
    s_add_u32 s47, s47, 256
    v_add_u32 v240, s47, v240
    v_lshrrev_b32 v241, 4, v1
    v_mul_u32_u24 v241, 7, v241
    v_bfe_u32 v242, v1, 3, 1
    v_lshl_add_u32 v241, v242, 2, v241
    v_lshl_add_u32 v247, v241, 16, v240
    s_cmp_eq_u32 s60, 1
    s_cselect_b32 s47, 7, 1
    v_lshrrev_b32 v241, 3, v1
    v_mul_u32_u24 v241, s47, v241
    v_lshl_add_u32 v246, v241, 16, v240
    s_lshl_b32 s4, s61, 7
    s_add_u32 s4, s4, 64
    s_lshl_b32 s4, s4, 11
    s_add_u32 s5, s63, 0
    s_add_u32 s4, s4, s5
    v_and_b32 v249, 15, v1
    v_lshlrev_b32 v249, 11, v249
    v_and_b32 v241, 16, v1
    v_lshl_add_u32 v249, v241, 1, v249
    v_and_b32 v241, 32, v1
    v_lshrrev_b32 v241, 1, v241
    v_add3_u32 v249, v249, v241, s4
    v_lshlrev_b32 v188, 7, v1
    v_mov_b32 v189, 0x7fffff00
    v_cmp_gt_u32 vcc, 8, v1
    s_nop 1
    v_cndmask_b32 v197, v189, v188, vcc
    s_mov_b32 s48, s68
    s_and_b32 s49, s69, 0xffff
    s_mov_b32 s50, 2097152
    s_mov_b32 s51, 0x00020000
    s_lshl_b32 s60, s2, 13
    s_lshl_b32 s47, s34, 14
    s_add_u32 s47, s47, 8192
    v_add_u32 v194, s47, v3
    s_lshl_b32 s47, s45, 3
    v_add_u32 v195, s47, v194
    s_waitcnt vmcnt(20)
    s_barrier
    .p2align 6
L_g1_loop2:
    ds_read_b128 a[112:115], v178 offset:0
    v_mfma_f32_16x16x32_bf16 v[68:71], a[132:135], a[168:171], v[68:71]
    ds_read_b64_tr_b16 a[152:153], v186 offset:0
    s_mov_b32 m0, 131072
    v_mfma_f32_16x16x32_bf16 v[76:79], a[136:139], a[168:171], v[76:79]
    ds_read_b64_tr_b16 a[154:155], v186 offset:3584
    buffer_load_dwordx4 v168, s[12:15], s29 offen offset:0 sc1 lds
    v_mfma_f32_16x16x32_bf16 v[84:87], a[140:143], a[168:171], v[84:87]
    ds_read_b128 a[116:119], v178 offset:1024
    v_mfma_f32_16x16x32_bf16 v[92:95], a[144:147], a[168:171], v[92:95]
    ds_read_b128 a[120:123], v178 offset:2048
    v_mfma_f32_16x16x32_bf16 v[100:103], a[148:151], a[168:171], v[100:103]
    ds_read_b128 a[124:127], v178 offset:3072
    v_mfma_f32_16x16x32_bf16 v[72:75], a[132:135], a[172:175], v[72:75]
    ds_read_b64_tr_b16 a[156:157], v186 offset:7168
    v_mfma_f32_16x16x32_bf16 v[80:83], a[136:139], a[172:175], v[80:83]
    ds_read_b64_tr_b16 a[158:159], v186 offset:10752
    v_mfma_f32_16x16x32_bf16 v[88:91], a[140:143], a[172:175], v[88:91]
    ds_read_b128 a[128:131], v180 offset:0
    v_mfma_f32_16x16x32_bf16 v[96:99], a[144:147], a[172:175], v[96:99]
    ds_read_b64_tr_b16 a[160:161], v186 offset:32
    buffer_load_dwordx4 v169, s[12:15], s29 offen offset:1024 sc1 lds
    v_mfma_f32_16x16x32_bf16 v[4:7], a[176:179], a[132:135], v[4:7]
    ds_read_b64_tr_b16 a[162:163], v186 offset:3616
    v_mfma_f32_16x16x32_bf16 v[12:15], a[176:179], a[136:139], v[12:15]
    ds_read_b64_tr_b16 a[164:165], v186 offset:7200
    v_mfma_f32_16x16x32_bf16 v[20:23], a[176:179], a[140:143], v[20:23]
    ds_read_b64_tr_b16 a[166:167], v186 offset:10784
    v_mfma_f32_16x16x32_bf16 v[28:31], a[176:179], a[144:147], v[28:31]
    v_mfma_f32_16x16x32_bf16 v[8:11], a[180:183], a[132:135], v[8:11]
    v_mfma_f32_16x16x32_bf16 v[16:19], a[180:183], a[136:139], v[16:19]
    v_mfma_f32_16x16x32_bf16 v[24:27], a[180:183], a[140:143], v[24:27]
    buffer_load_dwordx4 v170, s[12:15], s29 offen offset:2048 sc1 lds
    v_mfma_f32_16x16x32_bf16 v[32:35], a[180:183], a[144:147], v[32:35]
    ds_read_b64_tr_b16 a[172:173], v186 offset:7232
    s_waitcnt lgkmcnt(11)
    v_mfma_f32_16x16x32_bf16 a[0:3], a[152:155], a[112:115], a[0:3]
    ds_read_b64_tr_b16 a[168:169], v186 offset:64
    s_waitcnt lgkmcnt(11)
    v_mfma_f32_16x16x32_bf16 a[4:7], a[152:155], a[116:119], a[4:7]
    ds_read_b64_tr_b16 a[174:175], v186 offset:10816
    s_waitcnt lgkmcnt(11)
    v_mfma_f32_16x16x32_bf16 a[8:11], a[152:155], a[120:123], a[8:11]
    ds_read_b64_tr_b16 a[170:171], v186 offset:3648
    s_waitcnt lgkmcnt(11)
    v_mfma_f32_16x16x32_bf16 a[12:15], a[152:155], a[124:127], a[12:15]
    s_waitcnt lgkmcnt(9)
    v_mfma_f32_16x16x32_bf16 v[104:107], a[156:159], a[112:115], v[104:107]
    ds_read_b64_tr_b16 a[176:177], v186 offset:96
    v_mfma_f32_16x16x32_bf16 v[108:111], a[156:159], a[116:119], v[108:111]
    buffer_load_dwordx4 v171, s[12:15], s29 offen offset:3072 sc1 lds
    v_mfma_f32_16x16x32_bf16 v[112:115], a[156:159], a[120:123], v[112:115]
    ds_read_b64_tr_b16 a[178:179], v186 offset:3680
    v_mfma_f32_16x16x32_bf16 v[116:119], a[156:159], a[124:127], v[116:119]
    s_waitcnt lgkmcnt(8)
    v_mfma_f32_16x16x32_bf16 a[16:19], a[160:163], a[112:115], a[16:19]
    ds_read_b64_tr_b16 a[180:181], v186 offset:7264
    v_mfma_f32_16x16x32_bf16 a[20:23], a[160:163], a[116:119], a[20:23]
    s_mov_b32 m0, 135168
    v_mfma_f32_16x16x32_bf16 a[24:27], a[160:163], a[120:123], a[24:27]
    ds_read_b64_tr_b16 a[182:183], v186 offset:10848
    v_mfma_f32_16x16x32_bf16 a[28:31], a[160:163], a[124:127], a[28:31]
    s_waitcnt lgkmcnt(8)
    v_mfma_f32_16x16x32_bf16 v[120:123], a[164:167], a[112:115], v[120:123]
    ds_read_b64_tr_b16 a[152:153], v186 offset:128
    v_mfma_f32_16x16x32_bf16 v[124:127], a[164:167], a[116:119], v[124:127]
    buffer_load_dwordx4 v172, s[12:15], s29 offen offset:0 sc1 lds
    v_mfma_f32_16x16x32_bf16 v[128:131], a[164:167], a[120:123], v[128:131]
    ds_read_b64_tr_b16 a[154:155], v186 offset:3712
    v_mfma_f32_16x16x32_bf16 v[132:135], a[164:167], a[124:127], v[132:135]
    s_waitcnt lgkmcnt(6)
    v_mfma_f32_16x16x32_bf16 a[32:35], a[168:171], a[112:115], a[32:35]
    ds_read_b64_tr_b16 a[156:157], v186 offset:7296
    v_mfma_f32_16x16x32_bf16 a[36:39], a[168:171], a[116:119], a[36:39]
    v_mfma_f32_16x16x32_bf16 a[40:43], a[168:171], a[120:123], a[40:43]
    ds_read_b64_tr_b16 a[158:159], v186 offset:10880
    v_mfma_f32_16x16x32_bf16 a[44:47], a[168:171], a[124:127], a[44:47]
    buffer_load_dwordx4 v173, s[12:15], s29 offen offset:1024 sc1 lds
    v_mfma_f32_16x16x32_bf16 v[136:139], a[172:175], a[112:115], v[136:139]
    ds_read_b64_tr_b16 a[160:161], v186 offset:160
    v_mfma_f32_16x16x32_bf16 v[140:143], a[172:175], a[116:119], v[140:143]
    v_mfma_f32_16x16x32_bf16 v[144:147], a[172:175], a[120:123], v[144:147]
    ds_read_b64_tr_b16 a[162:163], v186 offset:3744
    v_mfma_f32_16x16x32_bf16 v[148:151], a[172:175], a[124:127], v[148:151]
    s_waitcnt lgkmcnt(8)
    v_mfma_f32_16x16x32_bf16 a[48:51], a[176:179], a[112:115], a[48:51]
    ds_read_b64_tr_b16 a[164:165], v186 offset:7328
    v_mfma_f32_16x16x32_bf16 a[52:55], a[176:179], a[116:119], a[52:55]
    buffer_load_dwordx4 v174, s[16:19], s30 offen offset:2048 sc1 lds
    v_mfma_f32_16x16x32_bf16 a[56:59], a[176:179], a[120:123], a[56:59]
    ds_read_b64_tr_b16 a[166:167], v186 offset:10912
    v_mfma_f32_16x16x32_bf16 a[60:63], a[176:179], a[124:127], a[60:63]
    ds_read_b64_tr_b16 a[172:173], v186 offset:7360
    s_waitcnt lgkmcnt(9)
    v_mfma_f32_16x16x32_bf16 v[152:155], a[180:183], a[112:115], v[152:155]
    ds_read_b64_tr_b16 a[168:169], v186 offset:192
    v_mfma_f32_16x16x32_bf16 v[156:159], a[180:183], a[116:119], v[156:159]
    ds_read_b64_tr_b16 a[174:175], v186 offset:10944
    v_mfma_f32_16x16x32_bf16 v[160:163], a[180:183], a[120:123], v[160:163]
    ds_read_b64_tr_b16 a[170:171], v186 offset:3776
    v_mfma_f32_16x16x32_bf16 v[164:167], a[180:183], a[124:127], v[164:167]
    s_waitcnt lgkmcnt(10)
    v_mfma_f32_16x16x32_bf16 a[64:67], a[152:155], a[112:115], a[64:67]
    ds_read_b64_tr_b16 a[176:177], v182 offset:17472
    v_mfma_f32_16x16x32_bf16 a[68:71], a[152:155], a[116:119], a[68:71]
    buffer_load_dwordx4 v175, s[16:19], s30 offen offset:3072 sc1 lds
    v_mfma_f32_16x16x32_bf16 a[72:75], a[152:155], a[120:123], a[72:75]
    ds_read_b64_tr_b16 a[178:179], v182 offset:20544
    v_mfma_f32_16x16x32_bf16 a[76:79], a[152:155], a[124:127], a[76:79]
    s_waitcnt lgkmcnt(10)
    v_mfma_f32_16x16x32_bf16 a[184:187], a[156:159], a[112:115], a[184:187]
    ds_read_b64_tr_b16 a[180:181], v184 offset:17472
    v_mfma_f32_16x16x32_bf16 a[188:191], a[156:159], a[116:119], a[188:191]
    s_mov_b32 m0, 139264
    v_mfma_f32_16x16x32_bf16 a[192:195], a[156:159], a[120:123], a[192:195]
    ds_read_b64_tr_b16 a[182:183], v184 offset:20544
    v_mfma_f32_16x16x32_bf16 a[196:199], a[156:159], a[124:127], a[196:199]
    s_waitcnt lgkmcnt(10)
    v_mfma_f32_16x16x32_bf16 a[80:83], a[160:163], a[112:115], a[80:83]
    ds_read_b64_tr_b16 a[152:153], v182 offset:17536
    v_mfma_f32_16x16x32_bf16 a[84:87], a[160:163], a[116:119], a[84:87]
    buffer_load_dwordx4 v176, s[16:19], s30 offen offset:0 sc1 lds
    v_mfma_f32_16x16x32_bf16 a[88:91], a[160:163], a[120:123], a[88:91]
    ds_read_b64_tr_b16 a[154:155], v182 offset:20608
    v_mfma_f32_16x16x32_bf16 a[92:95], a[160:163], a[124:127], a[92:95]
    s_waitcnt lgkmcnt(10)
    v_mfma_f32_16x16x32_bf16 a[200:203], a[164:167], a[112:115], a[200:203]
    ds_read_b64_tr_b16 a[156:157], v184 offset:17536
    v_mfma_f32_16x16x32_bf16 a[204:207], a[164:167], a[116:119], a[204:207]
    buffer_load_dwordx4 v177, s[16:19], s30 offen offset:1024 sc1 lds
    v_mfma_f32_16x16x32_bf16 a[208:211], a[164:167], a[120:123], a[208:211]
    ds_read_b64_tr_b16 a[158:159], v184 offset:20608
    v_mfma_f32_16x16x32_bf16 a[212:215], a[164:167], a[124:127], a[212:215]
    s_waitcnt lgkmcnt(8)
    v_mfma_f32_16x16x32_bf16 a[96:99], a[168:171], a[112:115], a[96:99]
    ds_read_b64_tr_b16 a[160:161], v182 offset:17408
    v_mfma_f32_16x16x32_bf16 a[100:103], a[168:171], a[116:119], a[100:103]
    v_mfma_f32_16x16x32_bf16 a[104:107], a[168:171], a[120:123], a[104:107]
    ds_read_b64_tr_b16 a[162:163], v182 offset:20480
    v_mfma_f32_16x16x32_bf16 a[108:111], a[168:171], a[124:127], a[108:111]
    v_mfma_f32_16x16x32_bf16 a[216:219], a[172:175], a[112:115], a[216:219]
    ds_read_b64_tr_b16 a[164:165], v184 offset:17408
    v_mfma_f32_16x16x32_bf16 a[220:223], a[172:175], a[116:119], a[220:223]
    v_mfma_f32_16x16x32_bf16 a[224:227], a[172:175], a[120:123], a[224:227]
    ds_read_b64_tr_b16 a[166:167], v184 offset:20480
    v_mfma_f32_16x16x32_bf16 a[228:231], a[172:175], a[124:127], a[228:231]
    s_waitcnt lgkmcnt(10)
    v_mfma_f32_16x16x32_bf16 v[36:39], a[176:179], a[112:115], v[36:39]
    v_mfma_f32_16x16x32_bf16 v[44:47], a[176:179], a[116:119], v[44:47]
    v_mfma_f32_16x16x32_bf16 v[52:55], a[176:179], a[120:123], v[52:55]
    v_mfma_f32_16x16x32_bf16 v[60:63], a[176:179], a[124:127], v[60:63]
    s_waitcnt lgkmcnt(8)
    v_mfma_f32_16x16x32_bf16 v[40:43], a[180:183], a[112:115], v[40:43]
    buffer_load_dword v196, v199, s[92:95], s59 offen
    v_mfma_f32_16x16x32_bf16 v[48:51], a[180:183], a[116:119], v[48:51]
    s_add_u32 s29, s29, 196608
    s_add_u32 s30, s30, 229376
    s_add_u32 s59, s59, s97
    v_mfma_f32_16x16x32_bf16 v[56:59], a[180:183], a[120:123], v[56:59]
    v_mfma_f32_16x16x32_bf16 v[64:67], a[180:183], a[124:127], v[64:67]
    s_waitcnt vmcnt(21) lgkmcnt(0)
    s_barrier
    ds_read_b128 a[132:135], v178 offset:37888
    v_mfma_f32_16x16x32_bf16 v[68:71], a[112:115], a[152:155], v[68:71]
    ds_read_b64_tr_b16 a[168:169], v186 offset:37888
    s_mov_b32 m0, 17408
    v_mfma_f32_16x16x32_bf16 v[76:79], a[116:119], a[152:155], v[76:79]
    ds_read_b64_tr_b16 a[170:171], v186 offset:41472
    buffer_load_dwordx4 v168, s[12:15], s29 offen offset:0 sc1 lds
    v_mfma_f32_16x16x32_bf16 v[84:87], a[120:123], a[152:155], v[84:87]
    ds_read_b128 a[136:139], v178 offset:38912
    v_mfma_f32_16x16x32_bf16 v[92:95], a[124:127], a[152:155], v[92:95]
    ds_read_b128 a[140:143], v178 offset:39936
    v_mfma_f32_16x16x32_bf16 v[100:103], a[128:131], a[152:155], v[100:103]
    ds_read_b128 a[144:147], v178 offset:40960
    v_mfma_f32_16x16x32_bf16 v[72:75], a[112:115], a[156:159], v[72:75]
    ds_read_b64_tr_b16 a[172:173], v186 offset:45056
    v_mfma_f32_16x16x32_bf16 v[80:83], a[116:119], a[156:159], v[80:83]
    ds_read_b64_tr_b16 a[174:175], v186 offset:48640
    v_mfma_f32_16x16x32_bf16 v[88:91], a[120:123], a[156:159], v[88:91]
    ds_read_b128 a[148:151], v180 offset:37888
    v_mfma_f32_16x16x32_bf16 v[96:99], a[124:127], a[156:159], v[96:99]
    ds_read_b64_tr_b16 a[176:177], v186 offset:37920
    buffer_load_dwordx4 v169, s[12:15], s29 offen offset:1024 sc1 lds
    v_mfma_f32_16x16x32_bf16 v[4:7], a[160:163], a[112:115], v[4:7]
    ds_read_b64_tr_b16 a[178:179], v186 offset:41504
    v_mfma_f32_16x16x32_bf16 v[12:15], a[160:163], a[116:119], v[12:15]
    ds_read_b64_tr_b16 a[180:181], v186 offset:45088
    v_mfma_f32_16x16x32_bf16 v[20:23], a[160:163], a[120:123], v[20:23]
    ds_read_b64_tr_b16 a[182:183], v186 offset:48672
    v_mfma_f32_16x16x32_bf16 v[28:31], a[160:163], a[124:127], v[28:31]
    v_mfma_f32_16x16x32_bf16 v[8:11], a[164:167], a[112:115], v[8:11]
    v_mfma_f32_16x16x32_bf16 v[16:19], a[164:167], a[116:119], v[16:19]
    v_mfma_f32_16x16x32_bf16 v[24:27], a[164:167], a[120:123], v[24:27]
    buffer_load_dwordx4 v170, s[12:15], s29 offen offset:2048 sc1 lds
    v_mfma_f32_16x16x32_bf16 v[32:35], a[164:167], a[124:127], v[32:35]
    ds_read_b64_tr_b16 a[156:157], v186 offset:45120
    s_waitcnt lgkmcnt(11)
    v_mfma_f32_16x16x32_bf16 a[0:3], a[168:171], a[132:135], a[0:3]
    ds_read_b64_tr_b16 a[152:153], v186 offset:37952
    s_waitcnt lgkmcnt(11)
    v_mfma_f32_16x16x32_bf16 a[4:7], a[168:171], a[136:139], a[4:7]
    ds_read_b64_tr_b16 a[158:159], v186 offset:48704
    s_waitcnt lgkmcnt(11)
    v_mfma_f32_16x16x32_bf16 a[8:11], a[168:171], a[140:143], a[8:11]
    ds_read_b64_tr_b16 a[154:155], v186 offset:41536
    s_waitcnt lgkmcnt(11)
    v_mfma_f32_16x16x32_bf16 a[12:15], a[168:171], a[144:147], a[12:15]
    s_waitcnt lgkmcnt(9)
    v_mfma_f32_16x16x32_bf16 v[104:107], a[172:175], a[132:135], v[104:107]
    ds_read_b64_tr_b16 a[160:161], v186 offset:37984
    v_mfma_f32_16x16x32_bf16 v[108:111], a[172:175], a[136:139], v[108:111]
    buffer_load_dwordx4 v171, s[12:15], s29 offen offset:3072 sc1 lds
    v_mfma_f32_16x16x32_bf16 v[112:115], a[172:175], a[140:143], v[112:115]
    ds_read_b64_tr_b16 a[162:163], v186 offset:41568
    v_mfma_f32_16x16x32_bf16 v[116:119], a[172:175], a[144:147], v[116:119]
    s_waitcnt lgkmcnt(8)
    v_mfma_f32_16x16x32_bf16 a[16:19], a[176:179], a[132:135], a[16:19]
    ds_read_b64_tr_b16 a[164:165], v186 offset:45152
    v_mfma_f32_16x16x32_bf16 a[20:23], a[176:179], a[136:139], a[20:23]
    s_mov_b32 m0, 21504
    v_mfma_f32_16x16x32_bf16 a[24:27], a[176:179], a[140:143], a[24:27]
    ds_read_b64_tr_b16 a[166:167], v186 offset:48736
    v_mfma_f32_16x16x32_bf16 a[28:31], a[176:179], a[144:147], a[28:31]
    s_waitcnt lgkmcnt(8)
    v_mfma_f32_16x16x32_bf16 v[120:123], a[180:183], a[132:135], v[120:123]
    ds_read_b64_tr_b16 a[168:169], v186 offset:38016
    v_mfma_f32_16x16x32_bf16 v[124:127], a[180:183], a[136:139], v[124:127]
    buffer_load_dwordx4 v172, s[12:15], s29 offen offset:0 sc1 lds
    v_mfma_f32_16x16x32_bf16 v[128:131], a[180:183], a[140:143], v[128:131]
    ds_read_b64_tr_b16 a[170:171], v186 offset:41600
    v_mfma_f32_16x16x32_bf16 v[132:135], a[180:183], a[144:147], v[132:135]
    s_waitcnt lgkmcnt(6)
    v_mfma_f32_16x16x32_bf16 a[32:35], a[152:155], a[132:135], a[32:35]
    ds_read_b64_tr_b16 a[172:173], v186 offset:45184
    v_mfma_f32_16x16x32_bf16 a[36:39], a[152:155], a[136:139], a[36:39]
    v_mfma_f32_16x16x32_bf16 a[40:43], a[152:155], a[140:143], a[40:43]
    ds_read_b64_tr_b16 a[174:175], v186 offset:48768
    v_mfma_f32_16x16x32_bf16 a[44:47], a[152:155], a[144:147], a[44:47]
    buffer_load_dwordx4 v173, s[12:15], s29 offen offset:1024 sc1 lds
    v_mfma_f32_16x16x32_bf16 v[136:139], a[156:159], a[132:135], v[136:139]
    ds_read_b64_tr_b16 a[176:177], v186 offset:38048
    v_mfma_f32_16x16x32_bf16 v[140:143], a[156:159], a[136:139], v[140:143]
    v_mfma_f32_16x16x32_bf16 v[144:147], a[156:159], a[140:143], v[144:147]
    ds_read_b64_tr_b16 a[178:179], v186 offset:41632
    v_mfma_f32_16x16x32_bf16 v[148:151], a[156:159], a[144:147], v[148:151]
    s_waitcnt lgkmcnt(8)
    v_mfma_f32_16x16x32_bf16 a[48:51], a[160:163], a[132:135], a[48:51]
    ds_read_b64_tr_b16 a[180:181], v186 offset:45216
    v_mfma_f32_16x16x32_bf16 a[52:55], a[160:163], a[136:139], a[52:55]
    buffer_load_dwordx4 v174, s[16:19], s30 offen offset:2048 sc1 lds
    v_mfma_f32_16x16x32_bf16 a[56:59], a[160:163], a[140:143], a[56:59]
    ds_read_b64_tr_b16 a[182:183], v186 offset:48800
    v_mfma_f32_16x16x32_bf16 a[60:63], a[160:163], a[144:147], a[60:63]
    ds_read_b64_tr_b16 a[156:157], v186 offset:45248
    s_waitcnt lgkmcnt(9)
    v_mfma_f32_16x16x32_bf16 v[152:155], a[164:167], a[132:135], v[152:155]
    ds_read_b64_tr_b16 a[152:153], v186 offset:38080
    v_mfma_f32_16x16x32_bf16 v[156:159], a[164:167], a[136:139], v[156:159]
    ds_read_b64_tr_b16 a[158:159], v186 offset:48832
    v_mfma_f32_16x16x32_bf16 v[160:163], a[164:167], a[140:143], v[160:163]
    ds_read_b64_tr_b16 a[154:155], v186 offset:41664
    v_mfma_f32_16x16x32_bf16 v[164:167], a[164:167], a[144:147], v[164:167]
    s_waitcnt lgkmcnt(10)
    v_mfma_f32_16x16x32_bf16 a[64:67], a[168:171], a[132:135], a[64:67]
    ds_read_b64_tr_b16 a[160:161], v182 offset:55360
    v_mfma_f32_16x16x32_bf16 a[68:71], a[168:171], a[136:139], a[68:71]
    buffer_load_dwordx4 v175, s[16:19], s30 offen offset:3072 sc1 lds
    v_mfma_f32_16x16x32_bf16 a[72:75], a[168:171], a[140:143], a[72:75]
    ds_read_b64_tr_b16 a[162:163], v182 offset:58432
    v_mfma_f32_16x16x32_bf16 a[76:79], a[168:171], a[144:147], a[76:79]
    s_waitcnt lgkmcnt(10)
    v_mfma_f32_16x16x32_bf16 a[184:187], a[172:175], a[132:135], a[184:187]
    ds_read_b64_tr_b16 a[164:165], v184 offset:55360
    v_mfma_f32_16x16x32_bf16 a[188:191], a[172:175], a[136:139], a[188:191]
    s_mov_b32 m0, 25600
    v_mfma_f32_16x16x32_bf16 a[192:195], a[172:175], a[140:143], a[192:195]
    ds_read_b64_tr_b16 a[166:167], v184 offset:58432
    v_mfma_f32_16x16x32_bf16 a[196:199], a[172:175], a[144:147], a[196:199]
    s_waitcnt lgkmcnt(10)
    v_mfma_f32_16x16x32_bf16 a[80:83], a[176:179], a[132:135], a[80:83]
    ds_read_b64_tr_b16 a[168:169], v182 offset:55424
    v_mfma_f32_16x16x32_bf16 a[84:87], a[176:179], a[136:139], a[84:87]
    buffer_load_dwordx4 v176, s[16:19], s30 offen offset:0 sc1 lds
    v_mfma_f32_16x16x32_bf16 a[88:91], a[176:179], a[140:143], a[88:91]
    ds_read_b64_tr_b16 a[170:171], v182 offset:58496
    v_mfma_f32_16x16x32_bf16 a[92:95], a[176:179], a[144:147], a[92:95]
    s_waitcnt lgkmcnt(10)
    v_mfma_f32_16x16x32_bf16 a[200:203], a[180:183], a[132:135], a[200:203]
    ds_read_b64_tr_b16 a[172:173], v184 offset:55424
    v_mfma_f32_16x16x32_bf16 a[204:207], a[180:183], a[136:139], a[204:207]
    buffer_load_dwordx4 v177, s[16:19], s30 offen offset:1024 sc1 lds
    v_mfma_f32_16x16x32_bf16 a[208:211], a[180:183], a[140:143], a[208:211]
    ds_read_b64_tr_b16 a[174:175], v184 offset:58496
    v_mfma_f32_16x16x32_bf16 a[212:215], a[180:183], a[144:147], a[212:215]
    s_waitcnt lgkmcnt(8)
    v_mfma_f32_16x16x32_bf16 a[96:99], a[152:155], a[132:135], a[96:99]
    ds_read_b64_tr_b16 a[176:177], v182 offset:55296
    v_mfma_f32_16x16x32_bf16 a[100:103], a[152:155], a[136:139], a[100:103]
    v_mfma_f32_16x16x32_bf16 a[104:107], a[152:155], a[140:143], a[104:107]
    ds_read_b64_tr_b16 a[178:179], v182 offset:58368
    v_mfma_f32_16x16x32_bf16 a[108:111], a[152:155], a[144:147], a[108:111]
    v_mfma_f32_16x16x32_bf16 a[216:219], a[156:159], a[132:135], a[216:219]
    ds_read_b64_tr_b16 a[180:181], v184 offset:55296
    v_mfma_f32_16x16x32_bf16 a[220:223], a[156:159], a[136:139], a[220:223]
    v_mfma_f32_16x16x32_bf16 a[224:227], a[156:159], a[140:143], a[224:227]
    ds_read_b64_tr_b16 a[182:183], v184 offset:58368
    v_mfma_f32_16x16x32_bf16 a[228:231], a[156:159], a[144:147], a[228:231]
    s_waitcnt lgkmcnt(10)
    v_mfma_f32_16x16x32_bf16 v[36:39], a[160:163], a[132:135], v[36:39]
    v_mfma_f32_16x16x32_bf16 v[44:47], a[160:163], a[136:139], v[44:47]
    v_mfma_f32_16x16x32_bf16 v[52:55], a[160:163], a[140:143], v[52:55]
    v_mfma_f32_16x16x32_bf16 v[60:63], a[160:163], a[144:147], v[60:63]
    s_waitcnt lgkmcnt(8)
    v_mfma_f32_16x16x32_bf16 v[40:43], a[164:167], a[132:135], v[40:43]
    v_mfma_f32_16x16x32_bf16 v[48:51], a[164:167], a[136:139], v[48:51]
    s_add_u32 s29, s29, 196608
    s_add_u32 s30, s30, 229376
    v_mfma_f32_16x16x32_bf16 v[56:59], a[164:167], a[140:143], v[56:59]
    v_mfma_f32_16x16x32_bf16 v[64:67], a[164:167], a[144:147], v[64:67]
    s_waitcnt vmcnt(21) lgkmcnt(0)
    s_barrier
    s_cmp_eq_u32 s31, 1
    s_cbranch_scc1 L_g1_fin
    ds_read_b128 a[112:115], v179 offset:0
    v_mfma_f32_16x16x32_bf16 v[68:71], a[132:135], a[168:171], v[68:71]
    ds_read_b64_tr_b16 a[152:153], v187 offset:0
    s_mov_b32 m0, 55296
    v_mfma_f32_16x16x32_bf16 v[76:79], a[136:139], a[168:171], v[76:79]
    ds_read_b64_tr_b16 a[154:155], v187 offset:3584
    buffer_load_dwordx4 v168, s[12:15], s29 offen offset:0 sc1 lds
    v_mfma_f32_16x16x32_bf16 v[84:87], a[140:143], a[168:171], v[84:87]
    ds_read_b128 a[116:119], v179 offset:1024
    v_mfma_f32_16x16x32_bf16 v[92:95], a[144:147], a[168:171], v[92:95]
    ds_read_b128 a[120:123], v179 offset:2048
    v_mfma_f32_16x16x32_bf16 v[100:103], a[148:151], a[168:171], v[100:103]
    ds_read_b128 a[124:127], v179 offset:3072
    v_mfma_f32_16x16x32_bf16 v[72:75], a[132:135], a[172:175], v[72:75]
    ds_read_b64_tr_b16 a[156:157], v187 offset:7168
    v_mfma_f32_16x16x32_bf16 v[80:83], a[136:139], a[172:175], v[80:83]
    ds_read_b64_tr_b16 a[158:159], v187 offset:10752
    v_mfma_f32_16x16x32_bf16 v[88:91], a[140:143], a[172:175], v[88:91]
    ds_read_b128 a[128:131], v181 offset:0
    v_mfma_f32_16x16x32_bf16 v[96:99], a[144:147], a[172:175], v[96:99]
    ds_read_b64_tr_b16 a[160:161], v187 offset:32
    buffer_load_dwordx4 v169, s[12:15], s29 offen offset:1024 sc1 lds
    v_mfma_f32_16x16x32_bf16 v[4:7], a[176:179], a[132:135], v[4:7]
    ds_read_b64_tr_b16 a[162:163], v187 offset:3616
    v_mfma_f32_16x16x32_bf16 v[12:15], a[176:179], a[136:139], v[12:15]
    ds_read_b64_tr_b16 a[164:165], v187 offset:7200
    v_mfma_f32_16x16x32_bf16 v[20:23], a[176:179], a[140:143], v[20:23]
    ds_read_b64_tr_b16 a[166:167], v187 offset:10784
    v_mfma_f32_16x16x32_bf16 v[28:31], a[176:179], a[144:147], v[28:31]
    v_mfma_f32_16x16x32_bf16 v[8:11], a[180:183], a[132:135], v[8:11]
    v_mfma_f32_16x16x32_bf16 v[16:19], a[180:183], a[136:139], v[16:19]
    v_mfma_f32_16x16x32_bf16 v[24:27], a[180:183], a[140:143], v[24:27]
    buffer_load_dwordx4 v170, s[12:15], s29 offen offset:2048 sc1 lds
    v_mfma_f32_16x16x32_bf16 v[32:35], a[180:183], a[144:147], v[32:35]
    ds_read_b64_tr_b16 a[172:173], v187 offset:7232
    s_waitcnt lgkmcnt(11)
    v_mfma_f32_16x16x32_bf16 a[0:3], a[152:155], a[112:115], a[0:3]
    ds_read_b64_tr_b16 a[168:169], v187 offset:64
    s_waitcnt lgkmcnt(11)
    v_mfma_f32_16x16x32_bf16 a[4:7], a[152:155], a[116:119], a[4:7]
    ds_read_b64_tr_b16 a[174:175], v187 offset:10816
    s_waitcnt lgkmcnt(11)
    v_mfma_f32_16x16x32_bf16 a[8:11], a[152:155], a[120:123], a[8:11]
    ds_read_b64_tr_b16 a[170:171], v187 offset:3648
    s_waitcnt lgkmcnt(11)
    v_mfma_f32_16x16x32_bf16 a[12:15], a[152:155], a[124:127], a[12:15]
    s_waitcnt lgkmcnt(9)
    v_mfma_f32_16x16x32_bf16 v[104:107], a[156:159], a[112:115], v[104:107]
    ds_read_b64_tr_b16 a[176:177], v187 offset:96
    v_mfma_f32_16x16x32_bf16 v[108:111], a[156:159], a[116:119], v[108:111]
    buffer_load_dwordx4 v171, s[12:15], s29 offen offset:3072 sc1 lds
    v_mfma_f32_16x16x32_bf16 v[112:115], a[156:159], a[120:123], v[112:115]
    ds_read_b64_tr_b16 a[178:179], v187 offset:3680
    v_mfma_f32_16x16x32_bf16 v[116:119], a[156:159], a[124:127], v[116:119]
    s_waitcnt lgkmcnt(8)
    v_mfma_f32_16x16x32_bf16 a[16:19], a[160:163], a[112:115], a[16:19]
    ds_read_b64_tr_b16 a[180:181], v187 offset:7264
    v_mfma_f32_16x16x32_bf16 a[20:23], a[160:163], a[116:119], a[20:23]
    s_mov_b32 m0, 59392
    v_mfma_f32_16x16x32_bf16 a[24:27], a[160:163], a[120:123], a[24:27]
    ds_read_b64_tr_b16 a[182:183], v187 offset:10848
    v_mfma_f32_16x16x32_bf16 a[28:31], a[160:163], a[124:127], a[28:31]
    s_waitcnt lgkmcnt(8)
    v_mfma_f32_16x16x32_bf16 v[120:123], a[164:167], a[112:115], v[120:123]
    ds_read_b64_tr_b16 a[152:153], v187 offset:128
    v_mfma_f32_16x16x32_bf16 v[124:127], a[164:167], a[116:119], v[124:127]
    buffer_load_dwordx4 v172, s[12:15], s29 offen offset:0 sc1 lds
    v_mfma_f32_16x16x32_bf16 v[128:131], a[164:167], a[120:123], v[128:131]
    ds_read_b64_tr_b16 a[154:155], v187 offset:3712
    v_mfma_f32_16x16x32_bf16 v[132:135], a[164:167], a[124:127], v[132:135]
    s_waitcnt lgkmcnt(6)
    v_mfma_f32_16x16x32_bf16 a[32:35], a[168:171], a[112:115], a[32:35]
    ds_read_b64_tr_b16 a[156:157], v187 offset:7296
    v_mfma_f32_16x16x32_bf16 a[36:39], a[168:171], a[116:119], a[36:39]
    v_mfma_f32_16x16x32_bf16 a[40:43], a[168:171], a[120:123], a[40:43]
    ds_read_b64_tr_b16 a[158:159], v187 offset:10880
    v_mfma_f32_16x16x32_bf16 a[44:47], a[168:171], a[124:127], a[44:47]
    buffer_load_dwordx4 v173, s[12:15], s29 offen offset:1024 sc1 lds
    v_mfma_f32_16x16x32_bf16 v[136:139], a[172:175], a[112:115], v[136:139]
    ds_read_b64_tr_b16 a[160:161], v187 offset:160
    v_mfma_f32_16x16x32_bf16 v[140:143], a[172:175], a[116:119], v[140:143]
    v_mfma_f32_16x16x32_bf16 v[144:147], a[172:175], a[120:123], v[144:147]
    ds_read_b64_tr_b16 a[162:163], v187 offset:3744
    v_mfma_f32_16x16x32_bf16 v[148:151], a[172:175], a[124:127], v[148:151]
    s_waitcnt lgkmcnt(8)
    v_mfma_f32_16x16x32_bf16 a[48:51], a[176:179], a[112:115], a[48:51]
    ds_read_b64_tr_b16 a[164:165], v187 offset:7328
    v_mfma_f32_16x16x32_bf16 a[52:55], a[176:179], a[116:119], a[52:55]
    buffer_load_dwordx4 v174, s[16:19], s30 offen offset:2048 sc1 lds
    v_mfma_f32_16x16x32_bf16 a[56:59], a[176:179], a[120:123], a[56:59]
    ds_read_b64_tr_b16 a[166:167], v187 offset:10912
    v_mfma_f32_16x16x32_bf16 a[60:63], a[176:179], a[124:127], a[60:63]
    ds_read_b64_tr_b16 a[172:173], v187 offset:7360
    s_waitcnt lgkmcnt(9)
    v_mfma_f32_16x16x32_bf16 v[152:155], a[180:183], a[112:115], v[152:155]
    ds_read_b64_tr_b16 a[168:169], v187 offset:192
    v_mfma_f32_16x16x32_bf16 v[156:159], a[180:183], a[116:119], v[156:159]
    ds_read_b64_tr_b16 a[174:175], v187 offset:10944
    v_mfma_f32_16x16x32_bf16 v[160:163], a[180:183], a[120:123], v[160:163]
    ds_read_b64_tr_b16 a[170:171], v187 offset:3776
    v_mfma_f32_16x16x32_bf16 v[164:167], a[180:183], a[124:127], v[164:167]
    s_waitcnt lgkmcnt(10)
    v_mfma_f32_16x16x32_bf16 a[64:67], a[152:155], a[112:115], a[64:67]
    ds_read_b64_tr_b16 a[176:177], v183 offset:17472
    v_mfma_f32_16x16x32_bf16 a[68:71], a[152:155], a[116:119], a[68:71]
    buffer_load_dwordx4 v175, s[16:19], s30 offen offset:3072 sc1 lds
    v_mfma_f32_16x16x32_bf16 a[72:75], a[152:155], a[120:123], a[72:75]
    ds_read_b64_tr_b16 a[178:179], v183 offset:20544
    v_mfma_f32_16x16x32_bf16 a[76:79], a[152:155], a[124:127], a[76:79]
    s_waitcnt lgkmcnt(10)
    v_mfma_f32_16x16x32_bf16 a[184:187], a[156:159], a[112:115], a[184:187]
    ds_read_b64_tr_b16 a[180:181], v185 offset:17472
    v_mfma_f32_16x16x32_bf16 a[188:191], a[156:159], a[116:119], a[188:191]
    s_mov_b32 m0, 63488
    v_mfma_f32_16x16x32_bf16 a[192:195], a[156:159], a[120:123], a[192:195]
    ds_read_b64_tr_b16 a[182:183], v185 offset:20544
    v_mfma_f32_16x16x32_bf16 a[196:199], a[156:159], a[124:127], a[196:199]
    s_waitcnt lgkmcnt(10)
    v_mfma_f32_16x16x32_bf16 a[80:83], a[160:163], a[112:115], a[80:83]
    ds_read_b64_tr_b16 a[152:153], v183 offset:17536
    v_mfma_f32_16x16x32_bf16 a[84:87], a[160:163], a[116:119], a[84:87]
    buffer_load_dwordx4 v176, s[16:19], s30 offen offset:0 sc1 lds
    v_mfma_f32_16x16x32_bf16 a[88:91], a[160:163], a[120:123], a[88:91]
    ds_read_b64_tr_b16 a[154:155], v183 offset:20608
    v_mfma_f32_16x16x32_bf16 a[92:95], a[160:163], a[124:127], a[92:95]
    s_waitcnt lgkmcnt(10)
    v_mfma_f32_16x16x32_bf16 a[200:203], a[164:167], a[112:115], a[200:203]
    ds_read_b64_tr_b16 a[156:157], v185 offset:17536
    v_mfma_f32_16x16x32_bf16 a[204:207], a[164:167], a[116:119], a[204:207]
    buffer_load_dwordx4 v177, s[16:19], s30 offen offset:1024 sc1 lds
    v_mfma_f32_16x16x32_bf16 a[208:211], a[164:167], a[120:123], a[208:211]
    ds_read_b64_tr_b16 a[158:159], v185 offset:20608
    v_mfma_f32_16x16x32_bf16 a[212:215], a[164:167], a[124:127], a[212:215]
    s_waitcnt lgkmcnt(8)
    v_mfma_f32_16x16x32_bf16 a[96:99], a[168:171], a[112:115], a[96:99]
    ds_read_b64_tr_b16 a[160:161], v183 offset:17408
    v_mfma_f32_16x16x32_bf16 a[100:103], a[168:171], a[116:119], a[100:103]
    v_mfma_f32_16x16x32_bf16 a[104:107], a[168:171], a[120:123], a[104:107]
    ds_read_b64_tr_b16 a[162:163], v183 offset:20480
    v_mfma_f32_16x16x32_bf16 a[108:111], a[168:171], a[124:127], a[108:111]
    v_mfma_f32_16x16x32_bf16 a[216:219], a[172:175], a[112:115], a[216:219]
    ds_read_b64_tr_b16 a[164:165], v185 offset:17408
    v_mfma_f32_16x16x32_bf16 a[220:223], a[172:175], a[116:119], a[220:223]
    v_mfma_f32_16x16x32_bf16 a[224:227], a[172:175], a[120:123], a[224:227]
    ds_read_b64_tr_b16 a[166:167], v185 offset:20480
    v_mfma_f32_16x16x32_bf16 a[228:231], a[172:175], a[124:127], a[228:231]
    s_waitcnt lgkmcnt(10)
    v_mfma_f32_16x16x32_bf16 v[36:39], a[176:179], a[112:115], v[36:39]
    v_mfma_f32_16x16x32_bf16 v[44:47], a[176:179], a[116:119], v[44:47]
    v_mfma_f32_16x16x32_bf16 v[52:55], a[176:179], a[120:123], v[52:55]
    v_mfma_f32_16x16x32_bf16 v[60:63], a[176:179], a[124:127], v[60:63]
    s_waitcnt lgkmcnt(8)
    v_mfma_f32_16x16x32_bf16 v[40:43], a[180:183], a[112:115], v[40:43]
    v_mfma_f32_16x16x32_bf16 v[48:51], a[180:183], a[116:119], v[48:51]
    s_add_u32 s29, s29, 196608
    s_add_u32 s30, s30, 229376
    v_mfma_f32_16x16x32_bf16 v[56:59], a[180:183], a[120:123], v[56:59]
    v_mfma_f32_16x16x32_bf16 v[64:67], a[180:183], a[124:127], v[64:67]
    s_waitcnt vmcnt(21) lgkmcnt(0)
    s_barrier
    ds_read_b128 a[132:135], v179 offset:37888
    v_mfma_f32_16x16x32_bf16 v[68:71], a[112:115], a[152:155], v[68:71]
    ds_read_b64_tr_b16 a[168:169], v187 offset:37888
    s_mov_b32 m0, 93184
    v_mfma_f32_16x16x32_bf16 v[76:79], a[116:119], a[152:155], v[76:79]
    ds_read_b64_tr_b16 a[170:171], v187 offset:41472
    buffer_load_dwordx4 v168, s[12:15], s29 offen offset:0 sc1 lds
    v_mfma_f32_16x16x32_bf16 v[84:87], a[120:123], a[152:155], v[84:87]
    ds_read_b128 a[136:139], v179 offset:38912
    v_mfma_f32_16x16x32_bf16 v[92:95], a[124:127], a[152:155], v[92:95]
    ds_read_b128 a[140:143], v179 offset:39936
    v_mfma_f32_16x16x32_bf16 v[100:103], a[128:131], a[152:155], v[100:103]
    ds_read_b128 a[144:147], v179 offset:40960
    v_mfma_f32_16x16x32_bf16 v[72:75], a[112:115], a[156:159], v[72:75]
    ds_read_b64_tr_b16 a[172:173], v187 offset:45056
    v_mfma_f32_16x16x32_bf16 v[80:83], a[116:119], a[156:159], v[80:83]
    ds_read_b64_tr_b16 a[174:175], v187 offset:48640
    v_mfma_f32_16x16x32_bf16 v[88:91], a[120:123], a[156:159], v[88:91]
    ds_read_b128 a[148:151], v181 offset:37888
    v_mfma_f32_16x16x32_bf16 v[96:99], a[124:127], a[156:159], v[96:99]
    ds_read_b64_tr_b16 a[176:177], v187 offset:37920
    buffer_load_dwordx4 v169, s[12:15], s29 offen offset:1024 sc1 lds
    v_mfma_f32_16x16x32_bf16 v[4:7], a[160:163], a[112:115], v[4:7]
    ds_read_b64_tr_b16 a[178:179], v187 offset:41504
    v_mfma_f32_16x16x32_bf16 v[12:15], a[160:163], a[116:119], v[12:15]
    ds_read_b64_tr_b16 a[180:181], v187 offset:45088
    v_mfma_f32_16x16x32_bf16 v[20:23], a[160:163], a[120:123], v[20:23]
    ds_read_b64_tr_b16 a[182:183], v187 offset:48672
    v_mfma_f32_16x16x32_bf16 v[28:31], a[160:163], a[124:127], v[28:31]
    v_mfma_f32_16x16x32_bf16 v[8:11], a[164:167], a[112:115], v[8:11]
    v_mfma_f32_16x16x32_bf16 v[16:19], a[164:167], a[116:119], v[16:19]
    v_mfma_f32_16x16x32_bf16 v[24:27], a[164:167], a[120:123], v[24:27]
    buffer_load_dwordx4 v170, s[12:15], s29 offen offset:2048 sc1 lds
    v_mfma_f32_16x16x32_bf16 v[32:35], a[164:167], a[124:127], v[32:35]
    ds_read_b64_tr_b16 a[156:157], v187 offset:45120
    s_waitcnt lgkmcnt(11)
    v_mfma_f32_16x16x32_bf16 a[0:3], a[168:171], a[132:135], a[0:3]
    ds_read_b64_tr_b16 a[152:153], v187 offset:37952
    s_waitcnt lgkmcnt(11)
    v_mfma_f32_16x16x32_bf16 a[4:7], a[168:171], a[136:139], a[4:7]
    ds_read_b64_tr_b16 a[158:159], v187 offset:48704
    s_waitcnt lgkmcnt(11)
    v_mfma_f32_16x16x32_bf16 a[8:11], a[168:171], a[140:143], a[8:11]
    ds_read_b64_tr_b16 a[154:155], v187 offset:41536
    s_waitcnt lgkmcnt(11)
    v_mfma_f32_16x16x32_bf16 a[12:15], a[168:171], a[144:147], a[12:15]
    s_waitcnt lgkmcnt(9)
    v_mfma_f32_16x16x32_bf16 v[104:107], a[172:175], a[132:135], v[104:107]
    ds_read_b64_tr_b16 a[160:161], v187 offset:37984
    v_mfma_f32_16x16x32_bf16 v[108:111], a[172:175], a[136:139], v[108:111]
    buffer_load_dwordx4 v171, s[12:15], s29 offen offset:3072 sc1 lds
    v_mfma_f32_16x16x32_bf16 v[112:115], a[172:175], a[140:143], v[112:115]
    ds_read_b64_tr_b16 a[162:163], v187 offset:41568
    v_mfma_f32_16x16x32_bf16 v[116:119], a[172:175], a[144:147], v[116:119]
    s_waitcnt lgkmcnt(8)
    v_mfma_f32_16x16x32_bf16 a[16:19], a[176:179], a[132:135], a[16:19]
    ds_read_b64_tr_b16 a[164:165], v187 offset:45152
    v_mfma_f32_16x16x32_bf16 a[20:23], a[176:179], a[136:139], a[20:23]
    s_mov_b32 m0, 97280
    v_mfma_f32_16x16x32_bf16 a[24:27], a[176:179], a[140:143], a[24:27]
    ds_read_b64_tr_b16 a[166:167], v187 offset:48736
    v_mfma_f32_16x16x32_bf16 a[28:31], a[176:179], a[144:147], a[28:31]
    s_waitcnt lgkmcnt(8)
    v_mfma_f32_16x16x32_bf16 v[120:123], a[180:183], a[132:135], v[120:123]
    ds_read_b64_tr_b16 a[168:169], v187 offset:38016
    v_mfma_f32_16x16x32_bf16 v[124:127], a[180:183], a[136:139], v[124:127]
    buffer_load_dwordx4 v172, s[12:15], s29 offen offset:0 sc1 lds
    v_mfma_f32_16x16x32_bf16 v[128:131], a[180:183], a[140:143], v[128:131]
    ds_read_b64_tr_b16 a[170:171], v187 offset:41600
    v_mfma_f32_16x16x32_bf16 v[132:135], a[180:183], a[144:147], v[132:135]
    s_waitcnt lgkmcnt(6)
    v_mfma_f32_16x16x32_bf16 a[32:35], a[152:155], a[132:135], a[32:35]
    ds_read_b64_tr_b16 a[172:173], v187 offset:45184
    v_mfma_f32_16x16x32_bf16 a[36:39], a[152:155], a[136:139], a[36:39]
    v_mfma_f32_16x16x32_bf16 a[40:43], a[152:155], a[140:143], a[40:43]
    ds_read_b64_tr_b16 a[174:175], v187 offset:48768
    v_mfma_f32_16x16x32_bf16 a[44:47], a[152:155], a[144:147], a[44:47]
    buffer_load_dwordx4 v173, s[12:15], s29 offen offset:1024 sc1 lds
    v_mfma_f32_16x16x32_bf16 v[136:139], a[156:159], a[132:135], v[136:139]
    ds_read_b64_tr_b16 a[176:177], v187 offset:38048
    v_mfma_f32_16x16x32_bf16 v[140:143], a[156:159], a[136:139], v[140:143]
    v_mfma_f32_16x16x32_bf16 v[144:147], a[156:159], a[140:143], v[144:147]
    ds_read_b64_tr_b16 a[178:179], v187 offset:41632
    v_mfma_f32_16x16x32_bf16 v[148:151], a[156:159], a[144:147], v[148:151]
    s_waitcnt lgkmcnt(8)
    v_mfma_f32_16x16x32_bf16 a[48:51], a[160:163], a[132:135], a[48:51]
    ds_read_b64_tr_b16 a[180:181], v187 offset:45216
    v_mfma_f32_16x16x32_bf16 a[52:55], a[160:163], a[136:139], a[52:55]
    buffer_load_dwordx4 v174, s[16:19], s30 offen offset:2048 sc1 lds
    v_mfma_f32_16x16x32_bf16 a[56:59], a[160:163], a[140:143], a[56:59]
    ds_read_b64_tr_b16 a[182:183], v187 offset:48800
    v_mfma_f32_16x16x32_bf16 a[60:63], a[160:163], a[144:147], a[60:63]
    ds_read_b64_tr_b16 a[156:157], v187 offset:45248
    s_waitcnt lgkmcnt(9)
    v_mfma_f32_16x16x32_bf16 v[152:155], a[164:167], a[132:135], v[152:155]
    ds_read_b64_tr_b16 a[152:153], v187 offset:38080
    v_mfma_f32_16x16x32_bf16 v[156:159], a[164:167], a[136:139], v[156:159]
    ds_read_b64_tr_b16 a[158:159], v187 offset:48832
    v_mfma_f32_16x16x32_bf16 v[160:163], a[164:167], a[140:143], v[160:163]
    ds_read_b64_tr_b16 a[154:155], v187 offset:41664
    v_mfma_f32_16x16x32_bf16 v[164:167], a[164:167], a[144:147], v[164:167]
    s_waitcnt lgkmcnt(10)
    v_mfma_f32_16x16x32_bf16 a[64:67], a[168:171], a[132:135], a[64:67]
    ds_read_b64_tr_b16 a[160:161], v183 offset:55360
    v_mfma_f32_16x16x32_bf16 a[68:71], a[168:171], a[136:139], a[68:71]
    buffer_load_dwordx4 v175, s[16:19], s30 offen offset:3072 sc1 lds
    v_mfma_f32_16x16x32_bf16 a[72:75], a[168:171], a[140:143], a[72:75]
    ds_read_b64_tr_b16 a[162:163], v183 offset:58432
    v_mfma_f32_16x16x32_bf16 a[76:79], a[168:171], a[144:147], a[76:79]
    s_waitcnt lgkmcnt(10)
    v_mfma_f32_16x16x32_bf16 a[184:187], a[172:175], a[132:135], a[184:187]
    ds_read_b64_tr_b16 a[164:165], v185 offset:55360
    v_mfma_f32_16x16x32_bf16 a[188:191], a[172:175], a[136:139], a[188:191]
    s_mov_b32 m0, 101376
    v_mfma_f32_16x16x32_bf16 a[192:195], a[172:175], a[140:143], a[192:195]
    ds_read_b64_tr_b16 a[166:167], v185 offset:58432
    v_mfma_f32_16x16x32_bf16 a[196:199], a[172:175], a[144:147], a[196:199]
    s_waitcnt lgkmcnt(10)
    v_mfma_f32_16x16x32_bf16 a[80:83], a[176:179], a[132:135], a[80:83]
    ds_read_b64_tr_b16 a[168:169], v183 offset:55424
    v_mfma_f32_16x16x32_bf16 a[84:87], a[176:179], a[136:139], a[84:87]
    buffer_load_dwordx4 v176, s[16:19], s30 offen offset:0 sc1 lds
    v_mfma_f32_16x16x32_bf16 a[88:91], a[176:179], a[140:143], a[88:91]
    ds_read_b64_tr_b16 a[170:171], v183 offset:58496
    v_mfma_f32_16x16x32_bf16 a[92:95], a[176:179], a[144:147], a[92:95]
    s_waitcnt lgkmcnt(10)
    v_mfma_f32_16x16x32_bf16 a[200:203], a[180:183], a[132:135], a[200:203]
    ds_read_b64_tr_b16 a[172:173], v185 offset:55424
    v_mfma_f32_16x16x32_bf16 a[204:207], a[180:183], a[136:139], a[204:207]
    buffer_load_dwordx4 v177, s[16:19], s30 offen offset:1024 sc1 lds
    v_mfma_f32_16x16x32_bf16 a[208:211], a[180:183], a[140:143], a[208:211]
    ds_read_b64_tr_b16 a[174:175], v185 offset:58496
    v_mfma_f32_16x16x32_bf16 a[212:215], a[180:183], a[144:147], a[212:215]
    s_waitcnt lgkmcnt(8)
    v_mfma_f32_16x16x32_bf16 a[96:99], a[152:155], a[132:135], a[96:99]
    ds_read_b64_tr_b16 a[176:177], v183 offset:55296
    v_mfma_f32_16x16x32_bf16 a[100:103], a[152:155], a[136:139], a[100:103]
    v_mfma_f32_16x16x32_bf16 a[104:107], a[152:155], a[140:143], a[104:107]
    ds_read_b64_tr_b16 a[178:179], v183 offset:58368
    v_mfma_f32_16x16x32_bf16 a[108:111], a[152:155], a[144:147], a[108:111]
    v_mfma_f32_16x16x32_bf16 a[216:219], a[156:159], a[132:135], a[216:219]
    ds_read_b64_tr_b16 a[180:181], v185 offset:55296
    v_mfma_f32_16x16x32_bf16 a[220:223], a[156:159], a[136:139], a[220:223]
    v_mfma_f32_16x16x32_bf16 a[224:227], a[156:159], a[140:143], a[224:227]
    ds_read_b64_tr_b16 a[182:183], v185 offset:58368
    v_mfma_f32_16x16x32_bf16 a[228:231], a[156:159], a[144:147], a[228:231]
    s_waitcnt lgkmcnt(10)
    v_mfma_f32_16x16x32_bf16 v[36:39], a[160:163], a[132:135], v[36:39]
    v_mfma_f32_16x16x32_bf16 v[44:47], a[160:163], a[136:139], v[44:47]
    v_mfma_f32_16x16x32_bf16 v[52:55], a[160:163], a[140:143], v[52:55]
    v_mfma_f32_16x16x32_bf16 v[60:63], a[160:163], a[144:147], v[60:63]
    s_waitcnt lgkmcnt(8)
    v_mfma_f32_16x16x32_bf16 v[40:43], a[164:167], a[132:135], v[40:43]
    v_mfma_f32_16x16x32_bf16 v[48:51], a[164:167], a[136:139], v[48:51]
    s_add_u32 s29, s29, 196608
    s_add_u32 s30, s30, 229376
    v_mfma_f32_16x16x32_bf16 v[56:59], a[164:167], a[140:143], v[56:59]
    v_mfma_f32_16x16x32_bf16 v[64:67], a[164:167], a[144:147], v[64:67]
    s_waitcnt vmcnt(20) lgkmcnt(0)
    s_barrier
    s_sub_u32 s31, s31, 1
    s_branch L_g1_loop2
L_g1_w3:
    v_add_u32 v188, 256, v1
    v_mul_u32_u24 v189, s53, v188
    v_lshrrev_b32 v189, 16, v189
    v_mul_u32_u24 v190, 14, v189
    v_sub_u32 v190, v188, v190
    v_add_u32 v190, s46, v190
    v_subrev_u32 v192, 14, v190
    v_min_u32 v190, v190, v192
    v_bfe_u32 v191, v189, 2, 2
    v_lshlrev_b32 v191, 3, v191
    v_lshrrev_b32 v192, 4, v189
    v_lshl_add_u32 v191, v192, 2, v191
    v_and_b32 v192, 3, v189
    v_add_u32 v191, v191, v192
    v_mul_u32_u24 v191, s55, v191
    v_lshl_add_u32 v191, v190, 4, v191
    v_subrev_u32 v168, 0, v191
    v_add_u32 v188, 320, v1
    v_mul_u32_u24 v189, s53, v188
    v_lshrrev_b32 v189, 16, v189
    v_mul_u32_u24 v190, 14, v189
    v_sub_u32 v190, v188, v190
    v_add_u32 v190, s46, v190
    v_subrev_u32 v192, 14, v190
    v_min_u32 v190, v190, v192
    v_bfe_u32 v191, v189, 2, 2
    v_lshlrev_b32 v191, 3, v191
    v_lshrrev_b32 v192, 4, v189
    v_lshl_add_u32 v191, v192, 2, v191
    v_and_b32 v192, 3, v189
    v_add_u32 v191, v191, v192
    v_mul_u32_u24 v191, s55, v191
    v_lshl_add_u32 v191, v190, 4, v191
    v_subrev_u32 v169, 1024, v191
    v_add_u32 v188, 384, v1
    v_mul_u32_u24 v189, s53, v188
    v_lshrrev_b32 v189, 16, v189
    v_mul_u32_u24 v190, 14, v189
    v_sub_u32 v190, v188, v190
    v_add_u32 v190, s46, v190
    v_subrev_u32 v192, 14, v190
    v_min_u32 v190, v190, v192
    v_bfe_u32 v191, v189, 2, 2
    v_lshlrev_b32 v191, 3, v191
    v_lshrrev_b32 v192, 4, v189
    v_lshl_add_u32 v191, v192, 2, v191
    v_and_b32 v192, 3, v189
    v_add_u32 v191, v191, v192
    v_mul_u32_u24 v191, s55, v191
    v_lshl_add_u32 v191, v190, 4, v191
    v_subrev_u32 v170, 2048, v191
    v_add_u32 v188, 0, v1
    v_mul_u32_u24 v189, s53, v188
    v_lshrrev_b32 v189, 16, v189
    v_mul_u32_u24 v190, 14, v189
    v_sub_u32 v190, v188, v190
    v_add_u32 v190, s46, v190
    v_subrev_u32 v192, 14, v190
    v_min_u32 v190, v190, v192
    v_bfe_u32 v191, v189, 2, 2
    v_lshlrev_b32 v191, 3, v191
    v_lshrrev_b32 v192, 4, v189
    v_lshl_add_u32 v191, v192, 2, v191
    v_and_b32 v192, 3, v189
    v_add_u32 v191, v191, v192
    v_mul_u32_u24 v191, s55, v191
    v_lshl_add_u32 v191, v190, 4, v191
    v_subrev_u32 v171, 3072, v191
    v_add_u32 v188, 64, v1
    v_mul_u32_u24 v189, s53, v188
    v_lshrrev_b32 v189, 16, v189
    v_mul_u32_u24 v190, 14, v189
    v_sub_u32 v190, v188, v190
    v_add_u32 v190, s46, v190
    v_subrev_u32 v192, 14, v190
    v_min_u32 v190, v190, v192
    v_bfe_u32 v191, v189, 2, 2
    v_lshlrev_b32 v191, 3, v191
    v_lshrrev_b32 v192, 4, v189
    v_lshl_add_u32 v191, v192, 2, v191
    v_and_b32 v192, 3, v189
    v_add_u32 v191, v191, v192
    v_mul_u32_u24 v191, s55, v191
    v_lshl_add_u32 v191, v190, 4, v191
    v_subrev_u32 v172, 0, v191
    v_add_u32 v188, 128, v1
    v_mul_u32_u24 v189, s53, v188
    v_lshrrev_b32 v189, 16, v189
    v_mul_u32_u24 v190, 14, v189
    v_sub_u32 v190, v188, v190
    v_add_u32 v190, s46, v190
    v_subrev_u32 v192, 14, v190
    v_min_u32 v190, v190, v192
    v_bfe_u32 v191, v189, 2, 2
    v_lshlrev_b32 v191, 3, v191
    v_lshrrev_b32 v192, 4, v189
    v_lshl_add_u32 v191, v192, 2, v191
    v_and_b32 v192, 3, v189
    v_add_u32 v191, v191, v192
    v_mul_u32_u24 v191, s55, v191
    v_lshl_add_u32 v191, v190, 4, v191
    v_subrev_u32 v173, 1024, v191
    v_add_u32 v188, 192, v1
    v_mul_u32_u24 v189, s53, v188
    v_lshrrev_b32 v189, 16, v189
    v_mul_u32_u24 v190, 14, v189
    v_sub_u32 v190, v188, v190
    v_add_u32 v190, s46, v190
    v_subrev_u32 v192, 14, v190
    v_min_u32 v190, v190, v192
    v_bfe_u32 v191, v189, 2, 2
    v_lshlrev_b32 v191, 3, v191
    v_lshrrev_b32 v192, 4, v189
    v_lshl_add_u32 v191, v192, 2, v191
    v_and_b32 v192, 3, v189
    v_add_u32 v191, v191, v192
    v_mul_u32_u24 v191, s55, v191
    v_lshl_add_u32 v191, v190, 4, v191
    v_subrev_u32 v174, 2048, v191
    v_add_u32 v188, 256, v1
    v_mul_u32_u24 v189, s53, v188
    v_lshrrev_b32 v189, 16, v189
    v_mul_u32_u24 v190, 14, v189
    v_sub_u32 v190, v188, v190
    v_add_u32 v190, s46, v190
    v_subrev_u32 v192, 14, v190
    v_min_u32 v190, v190, v192
    v_bfe_u32 v191, v189, 2, 2
    v_lshlrev_b32 v191, 3, v191
    v_lshrrev_b32 v192, 4, v189
    v_lshl_add_u32 v191, v192, 2, v191
    v_and_b32 v192, 3, v189
    v_add_u32 v191, v191, v192
    v_mul_u32_u24 v191, s55, v191
    v_lshl_add_u32 v191, v190, 4, v191
    v_subrev_u32 v175, 3072, v191
    v_add_u32 v188, 320, v1
    v_mul_u32_u24 v189, s53, v188
    v_lshrrev_b32 v189, 16, v189
    v_mul_u32_u24 v190, 14, v189
    v_sub_u32 v190, v188, v190
    v_add_u32 v190, s46, v190
    v_subrev_u32 v192, 14, v190
    v_min_u32 v190, v190, v192
    v_bfe_u32 v191, v189, 2, 2
    v_lshlrev_b32 v191, 3, v191
    v_lshrrev_b32 v192, 4, v189
    v_lshl_add_u32 v191, v192, 2, v191
    v_and_b32 v192, 3, v189
    v_add_u32 v191, v191, v192
    v_mul_u32_u24 v191, s55, v191
    v_lshl_add_u32 v191, v190, 4, v191
    v_subrev_u32 v176, 0, v191
    v_add_u32 v188, 384, v1
    v_mul_u32_u24 v189, s53, v188
    v_lshrrev_b32 v189, 16, v189
    v_mul_u32_u24 v190, 14, v189
    v_sub_u32 v190, v188, v190
    v_add_u32 v190, s46, v190
    v_subrev_u32 v192, 14, v190
    v_min_u32 v190, v190, v192
    v_bfe_u32 v191, v189, 2, 2
    v_lshlrev_b32 v191, 3, v191
    v_lshrrev_b32 v192, 4, v189
    v_lshl_add_u32 v191, v192, 2, v191
    v_and_b32 v192, 3, v189
    v_add_u32 v191, v191, v192
    v_mul_u32_u24 v191, s55, v191
    v_lshl_add_u32 v191, v190, 4, v191
    v_subrev_u32 v177, 1024, v191
    v_add_u32 v178, 13312, v3
    v_add_u32 v179, 89088, v3
    s_waitcnt vmcnt(0)
    s_barrier
    s_add_u32 s8, s82, s42
    s_addc_u32 s9, s83, 0
    s_and_b32 s9, s9, 0xffff
    s_mov_b32 s10, 0
    s_mov_b32 s11, 0x00020000
    s_sub_u32 s10, 4194304, s42
    s_mov_b32 m0, 27648
    s_nop 0
    buffer_load_dwordx4 v168, s[16:19], s30 offen offset:0 sc1 lds
    buffer_load_dwordx4 v169, s[16:19], s30 offen offset:1024 sc1 lds
    buffer_load_dwordx4 v170, s[16:19], s30 offen offset:2048 sc1 lds
    buffer_load_dwordx4 v171, s[20:23], s30 offen offset:3072 sc1 lds
    s_mov_b32 m0, 31744
    s_nop 0
    buffer_load_dwordx4 v172, s[20:23], s30 offen offset:0 sc1 lds
    buffer_load_dwordx4 v173, s[20:23], s30 offen offset:1024 sc1 lds
    buffer_load_dwordx4 v174, s[20:23], s30 offen offset:2048 sc1 lds
    buffer_load_dwordx4 v175, s[20:23], s30 offen offset:3072 sc1 lds
    s_mov_b32 m0, 35840
    s_nop 0
    buffer_load_dwordx4 v176, s[20:23], s30 offen offset:0 sc1 lds
    buffer_load_dwordx4 v177, s[20:23], s30 offen offset:1024 sc1 lds
    s_add_u32 s30, s30, 229376
    s_mov_b32 m0, 65536
    s_nop 0
    buffer_load_dwordx4 v168, s[16:19], s30 offen offset:0 sc1 lds
    buffer_load_dwordx4 v169, s[16:19], s30 offen offset:1024 sc1 lds
    buffer_load_dwordx4 v170, s[16:19], s30 offen offset:2048 sc1 lds
    buffer_load_dwordx4 v171, s[20:23], s30 offen offset:3072 sc1 lds
    s_mov_b32 m0, 69632
    s_nop 0
    buffer_load_dwordx4 v172, s[20:23], s30 offen offset:0 sc1 lds
    buffer_load_dwordx4 v173, s[20:23], s30 offen offset:1024 sc1 lds
    buffer_load_dwordx4 v174, s[20:23], s30 offen offset:2048 sc1 lds
    buffer_load_dwordx4 v175, s[20:23], s30 offen offset:3072 sc1 lds
    s_mov_b32 m0, 73728
    s_nop 0
    buffer_load_dwordx4 v176, s[20:23], s30 offen offset:0 sc1 lds
    buffer_load_dwordx4 v177, s[20:23], s30 offen offset:1024 sc1 lds
    s_add_u32 s30, s30, 229376
    s_mov_b32 m0, 103424
    s_nop 0
    buffer_load_dwordx4 v168, s[16:19], s30 offen offset:0 sc1 lds
    buffer_load_dwordx4 v169, s[16:19], s30 offen offset:1024 sc1 lds
    buffer_load_dwordx4 v170, s[16:19], s30 offen offset:2048 sc1 lds
    buffer_load_dwordx4 v171, s[20:23], s30 offen offset:3072 sc1 lds
    s_mov_b32 m0, 107520
    s_nop 0
    buffer_load_dwordx4 v172, s[20:23], s30 offen offset:0 sc1 lds
    buffer_load_dwordx4 v173, s[20:23], s30 offen offset:1024 sc1 lds
    buffer_load_dwordx4 v174, s[20:23], s30 offen offset:2048 sc1 lds
    buffer_load_dwordx4 v175, s[20:23], s30 offen offset:3072 sc1 lds
    s_mov_b32 m0, 111616
    s_nop 0
    buffer_load_dwordx4 v176, s[20:23], s30 offen offset:0 sc1 lds
    buffer_load_dwordx4 v177, s[20:23], s30 offen offset:1024 sc1 lds
    s_add_u32 s30, s30, 229376
    s_call_b64 s[62:63], L_common
    s_and_b32 s60, s2, 1
    s_bfe_u32 s61, s2, 0x20001
    s_lshl_b32 s61, s61, 2
    s_bfe_u32 s47, s2, 0x20003
    s_add_u32 s61, s61, s47
    s_lshr_b32 s62, s2, 5
    s_lshl_b32 s63, s62, 8
    v_lshrrev_b32 v240, 4, v1
    v_bfe_u32 v241, v1, 1, 3
    v_and_b32 v242, 1, v1
    v_add_u32 v243, 0, v240
    v_xor_b32 v244, v243, v241
    v_lshl_or_b32 v244, v244, 1, v242
    v_lshlrev_b32 v243, 11, v243
    v_lshl_add_u32 v243, v244, 4, v243
    v_add_u32 v220, 0, v243
    v_add_u32 v222, 14336, v243
    v_add_u32 v224, 32768, v243
    v_add_u32 v226, 47104, v243
    v_add_u32 v243, 4, v240
    v_xor_b32 v244, v243, v241
    v_lshl_or_b32 v244, v244, 1, v242
    v_lshlrev_b32 v243, 11, v243
    v_lshl_add_u32 v243, v244, 4, v243
    v_add_u32 v221, -1024, v243
    v_add_u32 v223, 13312, v243
    v_add_u32 v225, 31744, v243
    v_add_u32 v227, 46080, v243
    v_add_u32 v228, 4096, v3
    v_add_u32 v229, 65536, v228
    v_add_u32 v230, 2048, v228
    v_add_u32 v231, 65536, v230
    v_lshrrev_b32 v240, 2, v1
    v_and_b32 v241, 7, v240
    v_and_b32 v242, 3, v1
    v_lshlrev_b32 v242, 3, v242
    v_lshl_add_u32 v242, v240, 8, v242
    v_add_u32 v242, 16384, v242
    v_xor_b32 v243, 4, v241
    v_lshl_add_u32 v232, v243, 5, v242
    v_add_u32 v233, 65536, v232
    v_xor_b32 v243, 5, v241
    v_lshl_add_u32 v234, v243, 5, v242
    v_add_u32 v235, 65536, v234
    v_xor_b32 v243, 6, v241
    v_lshl_add_u32 v236, v243, 5, v242
    v_add_u32 v237, 65536, v236
    v_xor_b32 v243, 7, v241
    v_lshl_add_u32 v238, v243, 5, v242
    v_add_u32 v239, 65536, v238
    s_lshl_b32 s47, s61, 8
    s_add_u32 s47, s47, 4096
    v_lshl_add_u32 v245, v1, 2, s47
    v_and_b32 v240, 1, v1
    v_lshlrev_b32 v240, 7, v240
    v_and_b32 v241, 2, v1
    v_lshl_add_u32 v240, v241, 9, v240
    v_and_b32 v241, 4, v1
    v_lshl_add_u32 v240, v241, 7, v240
    s_lshr_b32 s47, s2, 3
    s_lshl_b32 s47, s47, 11
    s_add_u32 s47, s47, 256
    v_add_u32 v240, s47, v240
    v_lshrrev_b32 v241, 4, v1
    v_mul_u32_u24 v241, 7, v241
    v_bfe_u32 v242, v1, 3, 1
    v_lshl_add_u32 v241, v242, 2, v241
    v_lshl_add_u32 v247, v241, 16, v240
    s_cmp_eq_u32 s60, 1
    s_cselect_b32 s47, 7, 1
    v_lshrrev_b32 v241, 3, v1
    v_mul_u32_u24 v241, s47, v241
    v_lshl_add_u32 v246, v241, 16, v240
    s_lshl_b32 s4, s61, 7
    s_add_u32 s4, s4, 64
    s_lshl_b32 s4, s4, 11
    s_add_u32 s5, s63, 128
    s_add_u32 s4, s4, s5
    v_and_b32 v249, 15, v1
    v_lshlrev_b32 v249, 11, v249
    v_and_b32 v241, 16, v1
    v_lshl_add_u32 v249, v241, 1, v249
    v_and_b32 v241, 32, v1
    v_lshrrev_b32 v241, 1, v241
    v_add3_u32 v249, v249, v241, s4
    v_lshlrev_b32 v188, 7, v1
    v_mov_b32 v189, 0x7fffff00
    v_cmp_gt_u32 vcc, 8, v1
    s_nop 1
    v_cndmask_b32 v197, v189, v188, vcc
    s_mov_b32 s48, s68
    s_and_b32 s49, s69, 0xffff
    s_mov_b32 s50, 2097152
    s_mov_b32 s51, 0x00020000
    s_lshl_b32 s60, s2, 13
    s_lshl_b32 s47, s34, 14
    s_add_u32 s47, s47, 12288
    v_add_u32 v194, s47, v3
    s_lshl_b32 s47, s45, 3
    v_add_u32 v195, s47, v194
    s_waitcnt vmcnt(20)
    s_barrier
    .p2align 6
L_g1_loop3:
    ds_read_b128 a[112:115], v178 offset:0
    v_mfma_f32_16x16x32_bf16 v[68:71], a[132:135], a[168:171], v[68:71]
    ds_read_b64_tr_b16 a[152:153], v186 offset:0
    s_mov_b32 m0, 141312
    v_mfma_f32_16x16x32_bf16 v[76:79], a[136:139], a[168:171], v[76:79]
    ds_read_b64_tr_b16 a[154:155], v186 offset:3584
    buffer_load_dwordx4 v168, s[16:19], s30 offen offset:0 sc1 lds
    v_mfma_f32_16x16x32_bf16 v[84:87], a[140:143], a[168:171], v[84:87]
    ds_read_b128 a[116:119], v178 offset:1024
    v_mfma_f32_16x16x32_bf16 v[92:95], a[144:147], a[168:171], v[92:95]
    ds_read_b128 a[120:123], v178 offset:2048
    v_mfma_f32_16x16x32_bf16 v[72:75], a[132:135], a[172:175], v[72:75]
    ds_read_b128 a[124:127], v178 offset:3072
    v_mfma_f32_16x16x32_bf16 v[80:83], a[136:139], a[172:175], v[80:83]
    ds_read_b64_tr_b16 a[156:157], v186 offset:7168
    v_mfma_f32_16x16x32_bf16 v[88:91], a[140:143], a[172:175], v[88:91]
    ds_read_b64_tr_b16 a[158:159], v186 offset:10752
    v_mfma_f32_16x16x32_bf16 v[96:99], a[144:147], a[172:175], v[96:99]
    ds_read_b128 a[128:131], v180 offset:0
    v_mfma_f32_16x16x32_bf16 v[100:103], a[148:151], a[172:175], v[100:103]
    ds_read_b64_tr_b16 a[160:161], v186 offset:32
    buffer_load_dwordx4 v169, s[16:19], s30 offen offset:1024 sc1 lds
    v_mfma_f32_16x16x32_bf16 v[4:7], a[176:179], a[132:135], v[4:7]
    ds_read_b64_tr_b16 a[162:163], v186 offset:3616
    v_mfma_f32_16x16x32_bf16 v[12:15], a[176:179], a[136:139], v[12:15]
    ds_read_b64_tr_b16 a[164:165], v186 offset:7200
    v_mfma_f32_16x16x32_bf16 v[20:23], a[176:179], a[140:143], v[20:23]
    ds_read_b64_tr_b16 a[166:167], v186 offset:10784
    v_mfma_f32_16x16x32_bf16 v[28:31], a[176:179], a[144:147], v[28:31]
    v_mfma_f32_16x16x32_bf16 v[8:11], a[180:183], a[132:135], v[8:11]
    v_mfma_f32_16x16x32_bf16 v[16:19], a[180:183], a[136:139], v[16:19]
    v_mfma_f32_16x16x32_bf16 v[24:27], a[180:183], a[140:143], v[24:27]
    buffer_load_dwordx4 v170, s[16:19], s30 offen offset:2048 sc1 lds
    v_mfma_f32_16x16x32_bf16 v[32:35], a[180:183], a[144:147], v[32:35]
    ds_read_b64_tr_b16 a[172:173], v186 offset:7232
    s_waitcnt lgkmcnt(11)
    v_mfma_f32_16x16x32_bf16 a[0:3], a[152:155], a[112:115], a[0:3]
    ds_read_b64_tr_b16 a[168:169], v186 offset:64
    s_waitcnt lgkmcnt(11)
    v_mfma_f32_16x16x32_bf16 a[4:7], a[152:155], a[116:119], a[4:7]
    ds_read_b64_tr_b16 a[174:175], v186 offset:10816
    s_waitcnt lgkmcnt(11)
    v_mfma_f32_16x16x32_bf16 a[8:11], a[152:155], a[120:123], a[8:11]
    ds_read_b64_tr_b16 a[170:171], v186 offset:3648
    s_waitcnt lgkmcnt(11)
    v_mfma_f32_16x16x32_bf16 a[12:15], a[152:155], a[124:127], a[12:15]
    s_waitcnt lgkmcnt(9)
    v_mfma_f32_16x16x32_bf16 v[104:107], a[156:159], a[112:115], v[104:107]
    ds_read_b64_tr_b16 a[176:177], v186 offset:96
    v_mfma_f32_16x16x32_bf16 v[108:111], a[156:159], a[116:119], v[108:111]
    buffer_load_dwordx4 v171, s[20:23], s30 offen offset:3072 sc1 lds
    v_mfma_f32_16x16x32_bf16 v[112:115], a[156:159], a[120:123], v[112:115]
    ds_read_b64_tr_b16 a[178:179], v186 offset:3680
    v_mfma_f32_16x16x32_bf16 v[116:119], a[156:159], a[124:127], v[116:119]
    s_waitcnt lgkmcnt(8)
    v_mfma_f32_16x16x32_bf16 a[16:19], a[160:163], a[112:115], a[16:19]
    ds_read_b64_tr_b16 a[180:181], v186 offset:7264
    v_mfma_f32_16x16x32_bf16 a[20:23], a[160:163], a[116:119], a[20:23]
    s_mov_b32 m0, 145408
    v_mfma_f32_16x16x32_bf16 a[24:27], a[160:163], a[120:123], a[24:27]
    ds_read_b64_tr_b16 a[182:183], v186 offset:10848
    v_mfma_f32_16x16x32_bf16 a[28:31], a[160:163], a[124:127], a[28:31]
    s_waitcnt lgkmcnt(8)
    v_mfma_f32_16x16x32_bf16 v[120:123], a[164:167], a[112:115], v[120:123]
    ds_read_b64_tr_b16 a[152:153], v186 offset:128
    v_mfma_f32_16x16x32_bf16 v[124:127], a[164:167], a[116:119], v[124:127]
    buffer_load_dwordx4 v172, s[20:23], s30 offen offset:0 sc1 lds
    v_mfma_f32_16x16x32_bf16 v[128:131], a[164:167], a[120:123], v[128:131]
    ds_read_b64_tr_b16 a[154:155], v186 offset:3712
    v_mfma_f32_16x16x32_bf16 v[132:135], a[164:167], a[124:127], v[132:135]
    s_waitcnt lgkmcnt(6)
    v_mfma_f32_16x16x32_bf16 a[32:35], a[168:171], a[112:115], a[32:35]
    ds_read_b64_tr_b16 a[156:157], v186 offset:7296
    v_mfma_f32_16x16x32_bf16 a[36:39], a[168:171], a[116:119], a[36:39]
    v_mfma_f32_16x16x32_bf16 a[40:43], a[168:171], a[120:123], a[40:43]
    ds_read_b64_tr_b16 a[158:159], v186 offset:10880
    v_mfma_f32_16x16x32_bf16 a[44:47], a[168:171], a[124:127], a[44:47]
    buffer_load_dwordx4 v173, s[20:23], s30 offen offset:1024 sc1 lds
    v_mfma_f32_16x16x32_bf16 v[136:139], a[172:175], a[112:115], v[136:139]
    ds_read_b64_tr_b16 a[160:161], v186 offset:160
    v_mfma_f32_16x16x32_bf16 v[140:143], a[172:175], a[116:119], v[140:143]
    v_mfma_f32_16x16x32_bf16 v[144:147], a[172:175], a[120:123], v[144:147]
    ds_read_b64_tr_b16 a[162:163], v186 offset:3744
    v_mfma_f32_16x16x32_bf16 v[148:151], a[172:175], a[124:127], v[148:151]
    s_waitcnt lgkmcnt(8)
    v_mfma_f32_16x16x32_bf16 a[48:51], a[176:179], a[112:115], a[48:51]
    ds_read_b64_tr_b16 a[164:165], v186 offset:7328
    v_mfma_f32_16x16x32_bf16 a[52:55], a[176:179], a[116:119], a[52:55]
    buffer_load_dwordx4 v174, s[20:23], s30 offen offset:2048 sc1 lds
    v_mfma_f32_16x16x32_bf16 a[56:59], a[176:179], a[120:123], a[56:59]
    ds_read_b64_tr_b16 a[166:167], v186 offset:10912
    v_mfma_f32_16x16x32_bf16 a[60:63], a[176:179], a[124:127], a[60:63]
    ds_read_b64_tr_b16 a[172:173], v186 offset:7360
    s_waitcnt lgkmcnt(9)
    v_mfma_f32_16x16x32_bf16 v[152:155], a[180:183], a[112:115], v[152:155]
    ds_read_b64_tr_b16 a[168:169], v186 offset:192
    v_mfma_f32_16x16x32_bf16 v[156:159], a[180:183], a[116:119], v[156:159]
    ds_read_b64_tr_b16 a[174:175], v186 offset:10944
    v_mfma_f32_16x16x32_bf16 v[160:163], a[180:183], a[120:123], v[160:163]
    ds_read_b64_tr_b16 a[170:171], v186 offset:3776
    v_mfma_f32_16x16x32_bf16 v[164:167], a[180:183], a[124:127], v[164:167]
    s_waitcnt lgkmcnt(10)
    v_mfma_f32_16x16x32_bf16 a[64:67], a[152:155], a[112:115], a[64:67]
    ds_read_b64_tr_b16 a[176:177], v182 offset:17472
    v_mfma_f32_16x16x32_bf16 a[68:71], a[152:155], a[116:119], a[68:71]
    buffer_load_dwordx4 v175, s[20:23], s30 offen offset:3072 sc1 lds
    v_mfma_f32_16x16x32_bf16 a[72:75], a[152:155], a[120:123], a[72:75]
    ds_read_b64_tr_b16 a[178:179], v182 offset:20544
    v_mfma_f32_16x16x32_bf16 a[76:79], a[152:155], a[124:127], a[76:79]
    s_waitcnt lgkmcnt(10)
    v_mfma_f32_16x16x32_bf16 a[184:187], a[156:159], a[112:115], a[184:187]
    ds_read_b64_tr_b16 a[180:181], v184 offset:17472
    v_mfma_f32_16x16x32_bf16 a[188:191], a[156:159], a[116:119], a[188:191]
    s_mov_b32 m0, 149504
    v_mfma_f32_16x16x32_bf16 a[192:195], a[156:159], a[120:123], a[192:195]
    ds_read_b64_tr_b16 a[182:183], v184 offset:20544
    v_mfma_f32_16x16x32_bf16 a[196:199], a[156:159], a[124:127], a[196:199]
    s_waitcnt lgkmcnt(10)
    v_mfma_f32_16x16x32_bf16 a[80:83], a[160:163], a[112:115], a[80:83]
    ds_read_b64_tr_b16 a[152:153], v182 offset:17536
    v_mfma_f32_16x16x32_bf16 a[84:87], a[160:163], a[116:119], a[84:87]
    buffer_load_dwordx4 v176, s[20:23], s30 offen offset:0 sc1 lds
    v_mfma_f32_16x16x32_bf16 a[88:91], a[160:163], a[120:123], a[88:91]
    ds_read_b64_tr_b16 a[154:155], v182 offset:20608
    v_mfma_f32_16x16x32_bf16 a[92:95], a[160:163], a[124:127], a[92:95]
    s_waitcnt lgkmcnt(10)
    v_mfma_f32_16x16x32_bf16 a[200:203], a[164:167], a[112:115], a[200:203]
    ds_read_b64_tr_b16 a[156:157], v184 offset:17536
    v_mfma_f32_16x16x32_bf16 a[204:207], a[164:167], a[116:119], a[204:207]
    buffer_load_dwordx4 v177, s[20:23], s30 offen offset:1024 sc1 lds
    v_mfma_f32_16x16x32_bf16 a[208:211], a[164:167], a[120:123], a[208:211]
    ds_read_b64_tr_b16 a[158:159], v184 offset:20608
    v_mfma_f32_16x16x32_bf16 a[212:215], a[164:167], a[124:127], a[212:215]
    s_waitcnt lgkmcnt(8)
    v_mfma_f32_16x16x32_bf16 a[96:99], a[168:171], a[112:115], a[96:99]
    ds_read_b64_tr_b16 a[160:161], v182 offset:17408
    v_mfma_f32_16x16x32_bf16 a[100:103], a[168:171], a[116:119], a[100:103]
    v_mfma_f32_16x16x32_bf16 a[104:107], a[168:171], a[120:123], a[104:107]
    ds_read_b64_tr_b16 a[162:163], v182 offset:20480
    v_mfma_f32_16x16x32_bf16 a[108:111], a[168:171], a[124:127], a[108:111]
    v_mfma_f32_16x16x32_bf16 a[216:219], a[172:175], a[112:115], a[216:219]
    ds_read_b64_tr_b16 a[164:165], v184 offset:17408
    v_mfma_f32_16x16x32_bf16 a[220:223], a[172:175], a[116:119], a[220:223]
    v_mfma_f32_16x16x32_bf16 a[224:227], a[172:175], a[120:123], a[224:227]
    ds_read_b64_tr_b16 a[166:167], v184 offset:20480
    v_mfma_f32_16x16x32_bf16 a[228:231], a[172:175], a[124:127], a[228:231]
    s_waitcnt lgkmcnt(10)
    v_mfma_f32_16x16x32_bf16 v[36:39], a[176:179], a[112:115], v[36:39]
    v_mfma_f32_16x16x32_bf16 v[44:47], a[176:179], a[116:119], v[44:47]
    v_mfma_f32_16x16x32_bf16 v[52:55], a[176:179], a[120:123], v[52:55]
    v_mfma_f32_16x16x32_bf16 v[60:63], a[176:179], a[124:127], v[60:63]
    s_waitcnt lgkmcnt(8)
    v_mfma_f32_16x16x32_bf16 v[40:43], a[180:183], a[112:115], v[40:43]
    buffer_load_dword v196, v199, s[92:95], s59 offen
    v_mfma_f32_16x16x32_bf16 v[48:51], a[180:183], a[116:119], v[48:51]
    s_add_u32 s30, s30, 229376
    s_add_u32 s59, s59, s97
    v_mfma_f32_16x16x32_bf16 v[56:59], a[180:183], a[120:123], v[56:59]
    v_mfma_f32_16x16x32_bf16 v[64:67], a[180:183], a[124:127], v[64:67]
    s_waitcnt vmcnt(21) lgkmcnt(0)
    s_barrier
    s_cmp_lg_u32 s31, 1
    s_cbranch_scc1 L_g1_nopfo
    s_mov_b32 s48, s76
    s_and_b32 s49, s77, 0xffff
    s_mov_b32 s50, 7340032
    s_mov_b32 s51, 0x00020000
    s_bitcmp1_b32 s2, 0
    s_cselect_b32 s47, 0, 3670016
    buffer_load_dword v196, v247, s[48:51], s47 offen
    s_add_u32 s47, s47, 1835008
    buffer_load_dword v196, v247, s[48:51], s47 offen
L_g1_nopfo:
    ds_read_b128 a[132:135], v178 offset:37888
    v_mfma_f32_16x16x32_bf16 v[68:71], a[112:115], a[152:155], v[68:71]
    ds_read_b64_tr_b16 a[168:169], v186 offset:37888
    s_mov_b32 m0, 27648
    v_mfma_f32_16x16x32_bf16 v[76:79], a[116:119], a[152:155], v[76:79]
    ds_read_b64_tr_b16 a[170:171], v186 offset:41472
    buffer_load_dwordx4 v168, s[16:19], s30 offen offset:0 sc1 lds
    v_mfma_f32_16x16x32_bf16 v[84:87], a[120:123], a[152:155], v[84:87]
    ds_read_b128 a[136:139], v178 offset:38912
    v_mfma_f32_16x16x32_bf16 v[92:95], a[124:127], a[152:155], v[92:95]
    ds_read_b128 a[140:143], v178 offset:39936
    v_mfma_f32_16x16x32_bf16 v[72:75], a[112:115], a[156:159], v[72:75]
    ds_read_b128 a[144:147], v178 offset:40960
    v_mfma_f32_16x16x32_bf16 v[80:83], a[116:119], a[156:159], v[80:83]
    ds_read_b64_tr_b16 a[172:173], v186 offset:45056
    v_mfma_f32_16x16x32_bf16 v[88:91], a[120:123], a[156:159], v[88:91]
    ds_read_b64_tr_b16 a[174:175], v186 offset:48640
    v_mfma_f32_16x16x32_bf16 v[96:99], a[124:127], a[156:159], v[96:99]
    ds_read_b128 a[148:151], v180 offset:37888
    v_mfma_f32_16x16x32_bf16 v[100:103], a[128:131], a[156:159], v[100:103]
    ds_read_b64_tr_b16 a[176:177], v186 offset:37920
    buffer_load_dwordx4 v169, s[16:19], s30 offen offset:1024 sc1 lds
    v_mfma_f32_16x16x32_bf16 v[4:7], a[160:163], a[112:115], v[4:7]
    ds_read_b64_tr_b16 a[178:179], v186 offset:41504
    v_mfma_f32_16x16x32_bf16 v[12:15], a[160:163], a[116:119], v[12:15]
    ds_read_b64_tr_b16 a[180:181], v186 offset:45088
    v_mfma_f32_16x16x32_bf16 v[20:23], a[160:163], a[120:123], v[20:23]
    ds_read_b64_tr_b16 a[182:183], v186 offset:48672
    v_mfma_f32_16x16x32_bf16 v[28:31], a[160:163], a[124:127], v[28:31]
    v_mfma_f32_16x16x32_bf16 v[8:11], a[164:167], a[112:115], v[8:11]
    v_mfma_f32_16x16x32_bf16 v[16:19], a[164:167], a[116:119], v[16:19]
    v_mfma_f32_16x16x32_bf16 v[24:27], a[164:167], a[120:123], v[24:27]
    buffer_load_dwordx4 v170, s[16:19], s30 offen offset:2048 sc1 lds
    v_mfma_f32_16x16x32_bf16 v[32:35], a[164:167], a[124:127], v[32:35]
    ds_read_b64_tr_b16 a[156:157], v186 offset:45120
    s_waitcnt lgkmcnt(11)
    v_mfma_f32_16x16x32_bf16 a[0:3], a[168:171], a[132:135], a[0:3]
    ds_read_b64_tr_b16 a[152:153], v186 offset:37952
    s_waitcnt lgkmcnt(11)
    v_mfma_f32_16x16x32_bf16 a[4:7], a[168:171], a[136:139], a[4:7]
    ds_read_b64_tr_b16 a[158:159], v186 offset:48704
    s_waitcnt lgkmcnt(11)
    v_mfma_f32_16x16x32_bf16 a[8:11], a[168:171], a[140:143], a[8:11]
    ds_read_b64_tr_b16 a[154:155], v186 offset:41536
    s_waitcnt lgkmcnt(11)
    v_mfma_f32_16x16x32_bf16 a[12:15], a[168:171], a[144:147], a[12:15]
    s_waitcnt lgkmcnt(9)
    v_mfma_f32_16x16x32_bf16 v[104:107], a[172:175], a[132:135], v[104:107]
    ds_read_b64_tr_b16 a[160:161], v186 offset:37984
    v_mfma_f32_16x16x32_bf16 v[108:111], a[172:175], a[136:139], v[108:111]
    buffer_load_dwordx4 v171, s[20:23], s30 offen offset:3072 sc1 lds
    v_mfma_f32_16x16x32_bf16 v[112:115], a[172:175], a[140:143], v[112:115]
    ds_read_b64_tr_b16 a[162:163], v186 offset:41568
    v_mfma_f32_16x16x32_bf16 v[116:119], a[172:175], a[144:147], v[116:119]
    s_waitcnt lgkmcnt(8)
    v_mfma_f32_16x16x32_bf16 a[16:19], a[176:179], a[132:135], a[16:19]
    ds_read_b64_tr_b16 a[164:165], v186 offset:45152
    v_mfma_f32_16x16x32_bf16 a[20:23], a[176:179], a[136:139], a[20:23]
    s_mov_b32 m0, 31744
    v_mfma_f32_16x16x32_bf16 a[24:27], a[176:179], a[140:143], a[24:27]
    ds_read_b64_tr_b16 a[166:167], v186 offset:48736
    v_mfma_f32_16x16x32_bf16 a[28:31], a[176:179], a[144:147], a[28:31]
    s_waitcnt lgkmcnt(8)
    v_mfma_f32_16x16x32_bf16 v[120:123], a[180:183], a[132:135], v[120:123]
    ds_read_b64_tr_b16 a[168:169], v186 offset:38016
    v_mfma_f32_16x16x32_bf16 v[124:127], a[180:183], a[136:139], v[124:127]
    buffer_load_dwordx4 v172, s[20:23], s30 offen offset:0 sc1 lds
    v_mfma_f32_16x16x32_bf16 v[128:131], a[180:183], a[140:143], v[128:131]
    ds_read_b64_tr_b16 a[170:171], v186 offset:41600
    v_mfma_f32_16x16x32_bf16 v[132:135], a[180:183], a[144:147], v[132:135]
    s_waitcnt lgkmcnt(6)
    v_mfma_f32_16x16x32_bf16 a[32:35], a[152:155], a[132:135], a[32:35]
    ds_read_b64_tr_b16 a[172:173], v186 offset:45184
    v_mfma_f32_16x16x32_bf16 a[36:39], a[152:155], a[136:139], a[36:39]
    v_mfma_f32_16x16x32_bf16 a[40:43], a[152:155], a[140:143], a[40:43]
    ds_read_b64_tr_b16 a[174:175], v186 offset:48768
    v_mfma_f32_16x16x32_bf16 a[44:47], a[152:155], a[144:147], a[44:47]
    buffer_load_dwordx4 v173, s[20:23], s30 offen offset:1024 sc1 lds
    v_mfma_f32_16x16x32_bf16 v[136:139], a[156:159], a[132:135], v[136:139]
    ds_read_b64_tr_b16 a[176:177], v186 offset:38048
    v_mfma_f32_16x16x32_bf16 v[140:143], a[156:159], a[136:139], v[140:143]
    v_mfma_f32_16x16x32_bf16 v[144:147], a[156:159], a[140:143], v[144:147]
    ds_read_b64_tr_b16 a[178:179], v186 offset:41632
    v_mfma_f32_16x16x32_bf16 v[148:151], a[156:159], a[144:147], v[148:151]
    s_waitcnt lgkmcnt(8)
    v_mfma_f32_16x16x32_bf16 a[48:51], a[160:163], a[132:135], a[48:51]
    ds_read_b64_tr_b16 a[180:181], v186 offset:45216
    v_mfma_f32_16x16x32_bf16 a[52:55], a[160:163], a[136:139], a[52:55]
    buffer_load_dwordx4 v174, s[20:23], s30 offen offset:2048 sc1 lds
    v_mfma_f32_16x16x32_bf16 a[56:59], a[160:163], a[140:143], a[56:59]
    ds_read_b64_tr_b16 a[182:183], v186 offset:48800
    v_mfma_f32_16x16x32_bf16 a[60:63], a[160:163], a[144:147], a[60:63]
    ds_read_b64_tr_b16 a[156:157], v186 offset:45248
    s_waitcnt lgkmcnt(9)
    v_mfma_f32_16x16x32_bf16 v[152:155], a[164:167], a[132:135], v[152:155]
    ds_read_b64_tr_b16 a[152:153], v186 offset:38080
    v_mfma_f32_16x16x32_bf16 v[156:159], a[164:167], a[136:139], v[156:159]
    ds_read_b64_tr_b16 a[158:159], v186 offset:48832
    v_mfma_f32_16x16x32_bf16 v[160:163], a[164:167], a[140:143], v[160:163]
    ds_read_b64_tr_b16 a[154:155], v186 offset:41664
    v_mfma_f32_16x16x32_bf16 v[164:167], a[164:167], a[144:147], v[164:167]
    s_waitcnt lgkmcnt(10)
    v_mfma_f32_16x16x32_bf16 a[64:67], a[168:171], a[132:135], a[64:67]
    ds_read_b64_tr_b16 a[160:161], v182 offset:55360
    v_mfma_f32_16x16x32_bf16 a[68:71], a[168:171], a[136:139], a[68:71]
    buffer_load_dwordx4 v175, s[20:23], s30 offen offset:3072 sc1 lds
    v_mfma_f32_16x16x32_bf16 a[72:75], a[168:171], a[140:143], a[72:75]
    ds_read_b64_tr_b16 a[162:163], v182 offset:58432
    v_mfma_f32_16x16x32_bf16 a[76:79], a[168:171], a[144:147], a[76:79]
    s_waitcnt lgkmcnt(10)
    v_mfma_f32_16x16x32_bf16 a[184:187], a[172:175], a[132:135], a[184:187]
    ds_read_b64_tr_b16 a[164:165], v184 offset:55360
    v_mfma_f32_16x16x32_bf16 a[188:191], a[172:175], a[136:139], a[188:191]
    s_mov_b32 m0, 35840
    v_mfma_f32_16x16x32_bf16 a[192:195], a[172:175], a[140:143], a[192:195]
    ds_read_b64_tr_b16 a[166:167], v184 offset:58432
    v_mfma_f32_16x16x32_bf16 a[196:199], a[172:175], a[144:147], a[196:199]
    s_waitcnt lgkmcnt(10)
    v_mfma_f32_16x16x32_bf16 a[80:83], a[176:179], a[132:135], a[80:83]
    ds_read_b64_tr_b16 a[168:169], v182 offset:55424
    v_mfma_f32_16x16x32_bf16 a[84:87], a[176:179], a[136:139], a[84:87]
    buffer_load_dwordx4 v176, s[20:23], s30 offen offset:0 sc1 lds
    v_mfma_f32_16x16x32_bf16 a[88:91], a[176:179], a[140:143], a[88:91]
    ds_read_b64_tr_b16 a[170:171], v182 offset:58496
    v_mfma_f32_16x16x32_bf16 a[92:95], a[176:179], a[144:147], a[92:95]
    s_waitcnt lgkmcnt(10)
    v_mfma_f32_16x16x32_bf16 a[200:203], a[180:183], a[132:135], a[200:203]
    ds_read_b64_tr_b16 a[172:173], v184 offset:55424
    v_mfma_f32_16x16x32_bf16 a[204:207], a[180:183], a[136:139], a[204:207]
    buffer_load_dwordx4 v177, s[20:23], s30 offen offset:1024 sc1 lds
    v_mfma_f32_16x16x32_bf16 a[208:211], a[180:183], a[140:143], a[208:211]
    ds_read_b64_tr_b16 a[174:175], v184 offset:58496
    v_mfma_f32_16x16x32_bf16 a[212:215], a[180:183], a[144:147], a[212:215]
    s_waitcnt lgkmcnt(8)
    v_mfma_f32_16x16x32_bf16 a[96:99], a[152:155], a[132:135], a[96:99]
    ds_read_b64_tr_b16 a[176:177], v182 offset:55296
    v_mfma_f32_16x16x32_bf16 a[100:103], a[152:155], a[136:139], a[100:103]
    v_mfma_f32_16x16x32_bf16 a[104:107], a[152:155], a[140:143], a[104:107]
    ds_read_b64_tr_b16 a[178:179], v182 offset:58368
    v_mfma_f32_16x16x32_bf16 a[108:111], a[152:155], a[144:147], a[108:111]
    v_mfma_f32_16x16x32_bf16 a[216:219], a[156:159], a[132:135], a[216:219]
    ds_read_b64_tr_b16 a[180:181], v184 offset:55296
    v_mfma_f32_16x16x32_bf16 a[220:223], a[156:159], a[136:139], a[220:223]
    v_mfma_f32_16x16x32_bf16 a[224:227], a[156:159], a[140:143], a[224:227]
    ds_read_b64_tr_b16 a[182:183], v184 offset:58368
    v_mfma_f32_16x16x32_bf16 a[228:231], a[156:159], a[144:147], a[228:231]
    s_waitcnt lgkmcnt(10)
    v_mfma_f32_16x16x32_bf16 v[36:39], a[160:163], a[132:135], v[36:39]
    v_mfma_f32_16x16x32_bf16 v[44:47], a[160:163], a[136:139], v[44:47]
    v_mfma_f32_16x16x32_bf16 v[52:55], a[160:163], a[140:143], v[52:55]
    v_mfma_f32_16x16x32_bf16 v[60:63], a[160:163], a[144:147], v[60:63]
    s_waitcnt lgkmcnt(8)
    v_mfma_f32_16x16x32_bf16 v[40:43], a[164:167], a[132:135], v[40:43]
    v_mfma_f32_16x16x32_bf16 v[48:51], a[164:167], a[136:139], v[48:51]
    s_add_u32 s30, s30, 229376
    v_mfma_f32_16x16x32_bf16 v[56:59], a[164:167], a[140:143], v[56:59]
    v_mfma_f32_16x16x32_bf16 v[64:67], a[164:167], a[144:147], v[64:67]
    s_waitcnt vmcnt(21) lgkmcnt(0)
    s_barrier
    s_cmp_eq_u32 s31, 1
    s_cbranch_scc1 L_g1_fin
    ds_read_b128 a[112:115], v179 offset:0
    v_mfma_f32_16x16x32_bf16 v[68:71], a[132:135], a[168:171], v[68:71]
    ds_read_b64_tr_b16 a[152:153], v187 offset:0
    s_mov_b32 m0, 65536
    v_mfma_f32_16x16x32_bf16 v[76:79], a[136:139], a[168:171], v[76:79]
    ds_read_b64_tr_b16 a[154:155], v187 offset:3584
    buffer_load_dwordx4 v168, s[16:19], s30 offen offset:0 sc1 lds
    v_mfma_f32_16x16x32_bf16 v[84:87], a[140:143], a[168:171], v[84:87]
    ds_read_b128 a[116:119], v179 offset:1024
    v_mfma_f32_16x16x32_bf16 v[92:95], a[144:147], a[168:171], v[92:95]
    ds_read_b128 a[120:123], v179 offset:2048
    v_mfma_f32_16x16x32_bf16 v[72:75], a[132:135], a[172:175], v[72:75]
    ds_read_b128 a[124:127], v179 offset:3072
    v_mfma_f32_16x16x32_bf16 v[80:83], a[136:139], a[172:175], v[80:83]
    ds_read_b64_tr_b16 a[156:157], v187 offset:7168
    v_mfma_f32_16x16x32_bf16 v[88:91], a[140:143], a[172:175], v[88:91]
    ds_read_b64_tr_b16 a[158:159], v187 offset:10752
    v_mfma_f32_16x16x32_bf16 v[96:99], a[144:147], a[172:175], v[96:99]
    ds_read_b128 a[128:131], v181 offset:0
    v_mfma_f32_16x16x32_bf16 v[100:103], a[148:151], a[172:175], v[100:103]
    ds_read_b64_tr_b16 a[160:161], v187 offset:32
    buffer_load_dwordx4 v169, s[16:19], s30 offen offset:1024 sc1 lds
    v_mfma_f32_16x16x32_bf16 v[4:7], a[176:179], a[132:135], v[4:7]
    ds_read_b64_tr_b16 a[162:163], v187 offset:3616
    v_mfma_f32_16x16x32_bf16 v[12:15], a[176:179], a[136:139], v[12:15]
    ds_read_b64_tr_b16 a[164:165], v187 offset:7200
    v_mfma_f32_16x16x32_bf16 v[20:23], a[176:179], a[140:143], v[20:23]
    ds_read_b64_tr_b16 a[166:167], v187 offset:10784
    v_mfma_f32_16x16x32_bf16 v[28:31], a[176:179], a[144:147], v[28:31]
    v_mfma_f32_16x16x32_bf16 v[8:11], a[180:183], a[132:135], v[8:11]
    v_mfma_f32_16x16x32_bf16 v[16:19], a[180:183], a[136:139], v[16:19]
    v_mfma_f32_16x16x32_bf16 v[24:27], a[180:183], a[140:143], v[24:27]
    buffer_load_dwordx4 v170, s[16:19], s30 offen offset:2048 sc1 lds
    v_mfma_f32_16x16x32_bf16 v[32:35], a[180:183], a[144:147], v[32:35]
    ds_read_b64_tr_b16 a[172:173], v187 offset:7232
    s_waitcnt lgkmcnt(11)
    v_mfma_f32_16x16x32_bf16 a[0:3], a[152:155], a[112:115], a[0:3]
    ds_read_b64_tr_b16 a[168:169], v187 offset:64
    s_waitcnt lgkmcnt(11)
    v_mfma_f32_16x16x32_bf16 a[4:7], a[152:155], a[116:119], a[4:7]
    ds_read_b64_tr_b16 a[174:175], v187 offset:10816
    s_waitcnt lgkmcnt(11)
    v_mfma_f32_16x16x32_bf16 a[8:11], a[152:155], a[120:123], a[8:11]
    ds_read_b64_tr_b16 a[170:171], v187 offset:3648
    s_waitcnt lgkmcnt(11)
    v_mfma_f32_16x16x32_bf16 a[12:15], a[152:155], a[124:127], a[12:15]
    s_waitcnt lgkmcnt(9)
    v_mfma_f32_16x16x32_bf16 v[104:107], a[156:159], a[112:115], v[104:107]
    ds_read_b64_tr_b16 a[176:177], v187 offset:96
    v_mfma_f32_16x16x32_bf16 v[108:111], a[156:159], a[116:119], v[108:111]
    buffer_load_dwordx4 v171, s[20:23], s30 offen offset:3072 sc1 lds
    v_mfma_f32_16x16x32_bf16 v[112:115], a[156:159], a[120:123], v[112:115]
    ds_read_b64_tr_b16 a[178:179], v187 offset:3680
    v_mfma_f32_16x16x32_bf16 v[116:119], a[156:159], a[124:127], v[116:119]
    s_waitcnt lgkmcnt(8)
    v_mfma_f32_16x16x32_bf16 a[16:19], a[160:163], a[112:115], a[16:19]
    ds_read_b64_tr_b16 a[180:181], v187 offset:7264
    v_mfma_f32_16x16x32_bf16 a[20:23], a[160:163], a[116:119], a[20:23]
    s_mov_b32 m0, 69632
    v_mfma_f32_16x16x32_bf16 a[24:27], a[160:163], a[120:123], a[24:27]
    ds_read_b64_tr_b16 a[182:183], v187 offset:10848
    v_mfma_f32_16x16x32_bf16 a[28:31], a[160:163], a[124:127], a[28:31]
    s_waitcnt lgkmcnt(8)
    v_mfma_f32_16x16x32_bf16 v[120:123], a[164:167], a[112:115], v[120:123]
    ds_read_b64_tr_b16 a[152:153], v187 offset:128
    v_mfma_f32_16x16x32_bf16 v[124:127], a[164:167], a[116:119], v[124:127]
    buffer_load_dwordx4 v172, s[20:23], s30 offen offset:0 sc1 lds
    v_mfma_f32_16x16x32_bf16 v[128:131], a[164:167], a[120:123], v[128:131]
    ds_read_b64_tr_b16 a[154:155], v187 offset:3712
    v_mfma_f32_16x16x32_bf16 v[132:135], a[164:167], a[124:127], v[132:135]
    s_waitcnt lgkmcnt(6)
    v_mfma_f32_16x16x32_bf16 a[32:35], a[168:171], a[112:115], a[32:35]
    ds_read_b64_tr_b16 a[156:157], v187 offset:7296
    v_mfma_f32_16x16x32_bf16 a[36:39], a[168:171], a[116:119], a[36:39]
    v_mfma_f32_16x16x32_bf16 a[40:43], a[168:171], a[120:123], a[40:43]
    ds_read_b64_tr_b16 a[158:159], v187 offset:10880
    v_mfma_f32_16x16x32_bf16 a[44:47], a[168:171], a[124:127], a[44:47]
    buffer_load_dwordx4 v173, s[20:23], s30 offen offset:1024 sc1 lds
    v_mfma_f32_16x16x32_bf16 v[136:139], a[172:175], a[112:115], v[136:139]
    ds_read_b64_tr_b16 a[160:161], v187 offset:160
    v_mfma_f32_16x16x32_bf16 v[140:143], a[172:175], a[116:119], v[140:143]
    v_mfma_f32_16x16x32_bf16 v[144:147], a[172:175], a[120:123], v[144:147]
    ds_read_b64_tr_b16 a[162:163], v187 offset:3744
    v_mfma_f32_16x16x32_bf16 v[148:151], a[172:175], a[124:127], v[148:151]
    s_waitcnt lgkmcnt(8)
    v_mfma_f32_16x16x32_bf16 a[48:51], a[176:179], a[112:115], a[48:51]
    ds_read_b64_tr_b16 a[164:165], v187 offset:7328
    v_mfma_f32_16x16x32_bf16 a[52:55], a[176:179], a[116:119], a[52:55]
    buffer_load_dwordx4 v174, s[20:23], s30 offen offset:2048 sc1 lds
    v_mfma_f32_16x16x32_bf16 a[56:59], a[176:179], a[120:123], a[56:59]
    ds_read_b64_tr_b16 a[166:167], v187 offset:10912
    v_mfma_f32_16x16x32_bf16 a[60:63], a[176:179], a[124:127], a[60:63]
    ds_read_b64_tr_b16 a[172:173], v187 offset:7360
    s_waitcnt lgkmcnt(9)
    v_mfma_f32_16x16x32_bf16 v[152:155], a[180:183], a[112:115], v[152:155]
    ds_read_b64_tr_b16 a[168:169], v187 offset:192
    v_mfma_f32_16x16x32_bf16 v[156:159], a[180:183], a[116:119], v[156:159]
    ds_read_b64_tr_b16 a[174:175], v187 offset:10944
    v_mfma_f32_16x16x32_bf16 v[160:163], a[180:183], a[120:123], v[160:163]
    ds_read_b64_tr_b16 a[170:171], v187 offset:3776
    v_mfma_f32_16x16x32_bf16 v[164:167], a[180:183], a[124:127], v[164:167]
    s_waitcnt lgkmcnt(10)
    v_mfma_f32_16x16x32_bf16 a[64:67], a[152:155], a[112:115], a[64:67]
    ds_read_b64_tr_b16 a[176:177], v183 offset:17472
    v_mfma_f32_16x16x32_bf16 a[68:71], a[152:155], a[116:119], a[68:71]
    buffer_load_dwordx4 v175, s[20:23], s30 offen offset:3072 sc1 lds
    v_mfma_f32_16x16x32_bf16 a[72:75], a[152:155], a[120:123], a[72:75]
    ds_read_b64_tr_b16 a[178:179], v183 offset:20544
    v_mfma_f32_16x16x32_bf16 a[76:79], a[152:155], a[124:127], a[76:79]
    s_waitcnt lgkmcnt(10)
    v_mfma_f32_16x16x32_bf16 a[184:187], a[156:159], a[112:115], a[184:187]
    ds_read_b64_tr_b16 a[180:181], v185 offset:17472
    v_mfma_f32_16x16x32_bf16 a[188:191], a[156:159], a[116:119], a[188:191]
    s_mov_b32 m0, 73728
    v_mfma_f32_16x16x32_bf16 a[192:195], a[156:159], a[120:123], a[192:195]
    ds_read_b64_tr_b16 a[182:183], v185 offset:20544
    v_mfma_f32_16x16x32_bf16 a[196:199], a[156:159], a[124:127], a[196:199]
    s_waitcnt lgkmcnt(10)
    v_mfma_f32_16x16x32_bf16 a[80:83], a[160:163], a[112:115], a[80:83]
    ds_read_b64_tr_b16 a[152:153], v183 offset:17536
    v_mfma_f32_16x16x32_bf16 a[84:87], a[160:163], a[116:119], a[84:87]
    buffer_load_dwordx4 v176, s[20:23], s30 offen offset:0 sc1 lds
    v_mfma_f32_16x16x32_bf16 a[88:91], a[160:163], a[120:123], a[88:91]
    ds_read_b64_tr_b16 a[154:155], v183 offset:20608
    v_mfma_f32_16x16x32_bf16 a[92:95], a[160:163], a[124:127], a[92:95]
    s_waitcnt lgkmcnt(10)
    v_mfma_f32_16x16x32_bf16 a[200:203], a[164:167], a[112:115], a[200:203]
    ds_read_b64_tr_b16 a[156:157], v185 offset:17536
    v_mfma_f32_16x16x32_bf16 a[204:207], a[164:167], a[116:119], a[204:207]
    buffer_load_dwordx4 v177, s[20:23], s30 offen offset:1024 sc1 lds
    v_mfma_f32_16x16x32_bf16 a[208:211], a[164:167], a[120:123], a[208:211]
    ds_read_b64_tr_b16 a[158:159], v185 offset:20608
    v_mfma_f32_16x16x32_bf16 a[212:215], a[164:167], a[124:127], a[212:215]
    s_waitcnt lgkmcnt(8)
    v_mfma_f32_16x16x32_bf16 a[96:99], a[168:171], a[112:115], a[96:99]
    ds_read_b64_tr_b16 a[160:161], v183 offset:17408
    v_mfma_f32_16x16x32_bf16 a[100:103], a[168:171], a[116:119], a[100:103]
    v_mfma_f32_16x16x32_bf16 a[104:107], a[168:171], a[120:123], a[104:107]
    ds_read_b64_tr_b16 a[162:163], v183 offset:20480
    v_mfma_f32_16x16x32_bf16 a[108:111], a[168:171], a[124:127], a[108:111]
    v_mfma_f32_16x16x32_bf16 a[216:219], a[172:175], a[112:115], a[216:219]
    ds_read_b64_tr_b16 a[164:165], v185 offset:17408
    v_mfma_f32_16x16x32_bf16 a[220:223], a[172:175], a[116:119], a[220:223]
    v_mfma_f32_16x16x32_bf16 a[224:227], a[172:175], a[120:123], a[224:227]
    ds_read_b64_tr_b16 a[166:167], v185 offset:20480
    v_mfma_f32_16x16x32_bf16 a[228:231], a[172:175], a[124:127], a[228:231]
    s_waitcnt lgkmcnt(10)
    v_mfma_f32_16x16x32_bf16 v[36:39], a[176:179], a[112:115], v[36:39]
    v_mfma_f32_16x16x32_bf16 v[44:47], a[176:179], a[116:119], v[44:47]
    v_mfma_f32_16x16x32_bf16 v[52:55], a[176:179], a[120:123], v[52:55]
    v_mfma_f32_16x16x32_bf16 v[60:63], a[176:179], a[124:127], v[60:63]
    s_waitcnt lgkmcnt(8)
    v_mfma_f32_16x16x32_bf16 v[40:43], a[180:183], a[112:115], v[40:43]
    v_mfma_f32_16x16x32_bf16 v[48:51], a[180:183], a[116:119], v[48:51]
    s_add_u32 s30, s30, 229376
    v_mfma_f32_16x16x32_bf16 v[56:59], a[180:183], a[120:123], v[56:59]
    v_mfma_f32_16x16x32_bf16 v[64:67], a[180:183], a[124:127], v[64:67]
    s_waitcnt vmcnt(21) lgkmcnt(0)
    s_barrier
    ds_read_b128 a[132:135], v179 offset:37888
    v_mfma_f32_16x16x32_bf16 v[68:71], a[112:115], a[152:155], v[68:71]
    ds_read_b64_tr_b16 a[168:169], v187 offset:37888
    s_mov_b32 m0, 103424
    v_mfma_f32_16x16x32_bf16 v[76:79], a[116:119], a[152:155], v[76:79]
    ds_read_b64_tr_b16 a[170:171], v187 offset:41472
    buffer_load_dwordx4 v168, s[16:19], s30 offen offset:0 sc1 lds
    v_mfma_f32_16x16x32_bf16 v[84:87], a[120:123], a[152:155], v[84:87]
    ds_read_b128 a[136:139], v179 offset:38912
    v_mfma_f32_16x16x32_bf16 v[92:95], a[124:127], a[152:155], v[92:95]
    ds_read_b128 a[140:143], v179 offset:39936
    v_mfma_f32_16x16x32_bf16 v[72:75], a[112:115], a[156:159], v[72:75]
    ds_read_b128 a[144:147], v179 offset:40960
    v_mfma_f32_16x16x32_bf16 v[80:83], a[116:119], a[156:159], v[80:83]
    ds_read_b64_tr_b16 a[172:173], v187 offset:45056
    v_mfma_f32_16x16x32_bf16 v[88:91], a[120:123], a[156:159], v[88:91]
    ds_read_b64_tr_b16 a[174:175], v187 offset:48640
    v_mfma_f32_16x16x32_bf16 v[96:99], a[124:127], a[156:159], v[96:99]
    ds_read_b128 a[148:151], v181 offset:37888
    v_mfma_f32_16x16x32_bf16 v[100:103], a[128:131], a[156:159], v[100:103]
    ds_read_b64_tr_b16 a[176:177], v187 offset:37920
    buffer_load_dwordx4 v169, s[16:19], s30 offen offset:1024 sc1 lds
    v_mfma_f32_16x16x32_bf16 v[4:7], a[160:163], a[112:115], v[4:7]
    ds_read_b64_tr_b16 a[178:179], v187 offset:41504
    v_mfma_f32_16x16x32_bf16 v[12:15], a[160:163], a[116:119], v[12:15]
    ds_read_b64_tr_b16 a[180:181], v187 offset:45088
    v_mfma_f32_16x16x32_bf16 v[20:23], a[160:163], a[120:123], v[20:23]
    ds_read_b64_tr_b16 a[182:183], v187 offset:48672
    v_mfma_f32_16x16x32_bf16 v[28:31], a[160:163], a[124:127], v[28:31]
    v_mfma_f32_16x16x32_bf16 v[8:11], a[164:167], a[112:115], v[8:11]
    v_mfma_f32_16x16x32_bf16 v[16:19], a[164:167], a[116:119], v[16:19]
    v_mfma_f32_16x16x32_bf16 v[24:27], a[164:167], a[120:123], v[24:27]
    buffer_load_dwordx4 v170, s[16:19], s30 offen offset:2048 sc1 lds
    v_mfma_f32_16x16x32_bf16 v[32:35], a[164:167], a[124:127], v[32:35]
    ds_read_b64_tr_b16 a[156:157], v187 offset:45120
    s_waitcnt lgkmcnt(11)
    v_mfma_f32_16x16x32_bf16 a[0:3], a[168:171], a[132:135], a[0:3]
    ds_read_b64_tr_b16 a[152:153], v187 offset:37952
    s_waitcnt lgkmcnt(11)
    v_mfma_f32_16x16x32_bf16 a[4:7], a[168:171], a[136:139], a[4:7]
    ds_read_b64_tr_b16 a[158:159], v187 offset:48704
    s_waitcnt lgkmcnt(11)
    v_mfma_f32_16x16x32_bf16 a[8:11], a[168:171], a[140:143], a[8:11]
    ds_read_b64_tr_b16 a[154:155], v187 offset:41536
    s_waitcnt lgkmcnt(11)
    v_mfma_f32_16x16x32_bf16 a[12:15], a[168:171], a[144:147], a[12:15]
    s_waitcnt lgkmcnt(9)
    v_mfma_f32_16x16x32_bf16 v[104:107], a[172:175], a[132:135], v[104:107]
    ds_read_b64_tr_b16 a[160:161], v187 offset:37984
    v_mfma_f32_16x16x32_bf16 v[108:111], a[172:175], a[136:139], v[108:111]
    buffer_load_dwordx4 v171, s[20:23], s30 offen offset:3072 sc1 lds
    v_mfma_f32_16x16x32_bf16 v[112:115], a[172:175], a[140:143], v[112:115]
    ds_read_b64_tr_b16 a[162:163], v187 offset:41568
    v_mfma_f32_16x16x32_bf16 v[116:119], a[172:175], a[144:147], v[116:119]
    s_waitcnt lgkmcnt(8)
    v_mfma_f32_16x16x32_bf16 a[16:19], a[176:179], a[132:135], a[16:19]
    ds_read_b64_tr_b16 a[164:165], v187 offset:45152
    v_mfma_f32_16x16x32_bf16 a[20:23], a[176:179], a[136:139], a[20:23]
    s_mov_b32 m0, 107520
    v_mfma_f32_16x16x32_bf16 a[24:27], a[176:179], a[140:143], a[24:27]
    ds_read_b64_tr_b16 a[166:167], v187 offset:48736
    v_mfma_f32_16x16x32_bf16 a[28:31], a[176:179], a[144:147], a[28:31]
    s_waitcnt lgkmcnt(8)
    v_mfma_f32_16x16x32_bf16 v[120:123], a[180:183], a[132:135], v[120:123]
    ds_read_b64_tr_b16 a[168:169], v187 offset:38016
    v_mfma_f32_16x16x32_bf16 v[124:127], a[180:183], a[136:139], v[124:127]
    buffer_load_dwordx4 v172, s[20:23], s30 offen offset:0 sc1 lds
    v_mfma_f32_16x16x32_bf16 v[128:131], a[180:183], a[140:143], v[128:131]
    ds_read_b64_tr_b16 a[170:171], v187 offset:41600
    v_mfma_f32_16x16x32_bf16 v[132:135], a[180:183], a[144:147], v[132:135]
    s_waitcnt lgkmcnt(6)
    v_mfma_f32_16x16x32_bf16 a[32:35], a[152:155], a[132:135], a[32:35]
    ds_read_b64_tr_b16 a[172:173], v187 offset:45184
    v_mfma_f32_16x16x32_bf16 a[36:39], a[152:155], a[136:139], a[36:39]
    v_mfma_f32_16x16x32_bf16 a[40:43], a[152:155], a[140:143], a[40:43]
    ds_read_b64_tr_b16 a[174:175], v187 offset:48768
    v_mfma_f32_16x16x32_bf16 a[44:47], a[152:155], a[144:147], a[44:47]
    buffer_load_dwordx4 v173, s[20:23], s30 offen offset:1024 sc1 lds
    v_mfma_f32_16x16x32_bf16 v[136:139], a[156:159], a[132:135], v[136:139]
    ds_read_b64_tr_b16 a[176:177], v187 offset:38048
    v_mfma_f32_16x16x32_bf16 v[140:143], a[156:159], a[136:139], v[140:143]
    v_mfma_f32_16x16x32_bf16 v[144:147], a[156:159], a[140:143], v[144:147]
    ds_read_b64_tr_b16 a[178:179], v187 offset:41632
    v_mfma_f32_16x16x32_bf16 v[148:151], a[156:159], a[144:147], v[148:151]
    s_waitcnt lgkmcnt(8)
    v_mfma_f32_16x16x32_bf16 a[48:51], a[160:163], a[132:135], a[48:51]
    ds_read_b64_tr_b16 a[180:181], v187 offset:45216
    v_mfma_f32_16x16x32_bf16 a[52:55], a[160:163], a[136:139], a[52:55]
    buffer_load_dwordx4 v174, s[20:23], s30 offen offset:2048 sc1 lds
    v_mfma_f32_16x16x32_bf16 a[56:59], a[160:163], a[140:143], a[56:59]
    ds_read_b64_tr_b16 a[182:183], v187 offset:48800
    v_mfma_f32_16x16x32_bf16 a[60:63], a[160:163], a[144:147], a[60:63]
    ds_read_b64_tr_b16 a[156:157], v187 offset:45248
    s_waitcnt lgkmcnt(9)
    v_mfma_f32_16x16x32_bf16 v[152:155], a[164:167], a[132:135], v[152:155]
    ds_read_b64_tr_b16 a[152:153], v187 offset:38080
    v_mfma_f32_16x16x32_bf16 v[156:159], a[164:167], a[136:139], v[156:159]
    ds_read_b64_tr_b16 a[158:159], v187 offset:48832
    v_mfma_f32_16x16x32_bf16 v[160:163], a[164:167], a[140:143], v[160:163]
    ds_read_b64_tr_b16 a[154:155], v187 offset:41664
    v_mfma_f32_16x16x32_bf16 v[164:167], a[164:167], a[144:147], v[164:167]
    s_waitcnt lgkmcnt(10)
    v_mfma_f32_16x16x32_bf16 a[64:67], a[168:171], a[132:135], a[64:67]
    ds_read_b64_tr_b16 a[160:161], v183 offset:55360
    v_mfma_f32_16x16x32_bf16 a[68:71], a[168:171], a[136:139], a[68:71]
    buffer_load_dwordx4 v175, s[20:23], s30 offen offset:3072 sc1 lds
    v_mfma_f32_16x16x32_bf16 a[72:75], a[168:171], a[140:143], a[72:75]
    ds_read_b64_tr_b16 a[162:163], v183 offset:58432
    v_mfma_f32_16x16x32_bf16 a[76:79], a[168:171], a[144:147], a[76:79]
    s_waitcnt lgkmcnt(10)
    v_mfma_f32_16x16x32_bf16 a[184:187], a[172:175], a[132:135], a[184:187]
    ds_read_b64_tr_b16 a[164:165], v185 offset:55360
    v_mfma_f32_16x16x32_bf16 a[188:191], a[172:175], a[136:139], a[188:191]
    s_mov_b32 m0, 111616
    v_mfma_f32_16x16x32_bf16 a[192:195], a[172:175], a[140:143], a[192:195]
    ds_read_b64_tr_b16 a[166:167], v185 offset:58432
    v_mfma_f32_16x16x32_bf16 a[196:199], a[172:175], a[144:147], a[196:199]
    s_waitcnt lgkmcnt(10)
    v_mfma_f32_16x16x32_bf16 a[80:83], a[176:179], a[132:135], a[80:83]
    ds_read_b64_tr_b16 a[168:169], v183 offset:55424
    v_mfma_f32_16x16x32_bf16 a[84:87], a[176:179], a[136:139], a[84:87]
    buffer_load_dwordx4 v176, s[20:23], s30 offen offset:0 sc1 lds
    v_mfma_f32_16x16x32_bf16 a[88:91], a[176:179], a[140:143], a[88:91]
    ds_read_b64_tr_b16 a[170:171], v183 offset:58496
    v_mfma_f32_16x16x32_bf16 a[92:95], a[176:179], a[144:147], a[92:95]
    s_waitcnt lgkmcnt(10)
    v_mfma_f32_16x16x32_bf16 a[200:203], a[180:183], a[132:135], a[200:203]
    ds_read_b64_tr_b16 a[172:173], v185 offset:55424
    v_mfma_f32_16x16x32_bf16 a[204:207], a[180:183], a[136:139], a[204:207]
    buffer_load_dwordx4 v177, s[20:23], s30 offen offset:1024 sc1 lds
    v_mfma_f32_16x16x32_bf16 a[208:211], a[180:183], a[140:143], a[208:211]
    ds_read_b64_tr_b16 a[174:175], v185 offset:58496
    v_mfma_f32_16x16x32_bf16 a[212:215], a[180:183], a[144:147], a[212:215]
    s_waitcnt lgkmcnt(8)
    v_mfma_f32_16x16x32_bf16 a[96:99], a[152:155], a[132:135], a[96:99]
    ds_read_b64_tr_b16 a[176:177], v183 offset:55296
    v_mfma_f32_16x16x32_bf16 a[100:103], a[152:155], a[136:139], a[100:103]
    v_mfma_f32_16x16x32_bf16 a[104:107], a[152:155], a[140:143], a[104:107]
    ds_read_b64_tr_b16 a[178:179], v183 offset:58368
    v_mfma_f32_16x16x32_bf16 a[108:111], a[152:155], a[144:147], a[108:111]
    v_mfma_f32_16x16x32_bf16 a[216:219], a[156:159], a[132:135], a[216:219]
    ds_read_b64_tr_b16 a[180:181], v185 offset:55296
    v_mfma_f32_16x16x32_bf16 a[220:223], a[156:159], a[136:139], a[220:223]
    v_mfma_f32_16x16x32_bf16 a[224:227], a[156:159], a[140:143], a[224:227]
    ds_read_b64_tr_b16 a[182:183], v185 offset:58368
    v_mfma_f32_16x16x32_bf16 a[228:231], a[156:159], a[144:147], a[228:231]
    s_waitcnt lgkmcnt(10)
    v_mfma_f32_16x16x32_bf16 v[36:39], a[160:163], a[132:135], v[36:39]
    v_mfma_f32_16x16x32_bf16 v[44:47], a[160:163], a[136:139], v[44:47]
    v_mfma_f32_16x16x32_bf16 v[52:55], a[160:163], a[140:143], v[52:55]
    v_mfma_f32_16x16x32_bf16 v[60:63], a[160:163], a[144:147], v[60:63]
    s_waitcnt lgkmcnt(8)
    v_mfma_f32_16x16x32_bf16 v[40:43], a[164:167], a[132:135], v[40:43]
    v_mfma_f32_16x16x32_bf16 v[48:51], a[164:167], a[136:139], v[48:51]
    s_add_u32 s30, s30, 229376
    v_mfma_f32_16x16x32_bf16 v[56:59], a[164:167], a[140:143], v[56:59]
    v_mfma_f32_16x16x32_bf16 v[64:67], a[164:167], a[144:147], v[64:67]
    s_waitcnt vmcnt(20) lgkmcnt(0)
    s_barrier
    s_sub_u32 s31, s31, 1
    s_branch L_g1_loop3
    .p2align 6
L_g1_fin:
    s_lshl_b32 s48, s33, 17
    s_mul_i32 s49, s33, 7
    s_add_u32 s49, s49, 1
    s_lshr_b32 s49, s49, 1
    s_add_u32 s49, s49, 32
    s_lshl_b32 s49, s49, 17
    s_add_u32 s50, s49, 0x20000
    s_add_u32 s51, s49, 0x40000
    s_lshr_b32 s52, s33, 1
    s_mul_i32 s52, s52, 7
    s_add_u32 s52, s52, 35
    s_lshl_b32 s52, s52, 17
    s_lshl_b32 s53, s34, 1
    s_lshr_b32 s47, s32, 1
    s_add_u32 s53, s53, s47
    s_and_b32 s4, s32, 1
    s_lshl_b32 s41, s53, 10
    s_lshl_b32 s47, s33, 1
    s_add_u32 s41, s41, s47
    s_add_u32 s41, s41, s4
    s_add_u32 s41, s41, 16384
    s_and_b32 s45, s96, 0xff
    s_mul_i32 s45, s45, 0x01010101
    v_lshlrev_b32 v192, 7, v1
    v_mov_b32 v193, s45
    s_lshl_b32 s53, s53, 8
    s_lshl_b32 s47, s33, 3
    s_add_u32 s53, s53, s47
    s_lshl_b32 s47, s4, 2
    s_add_u32 s53, s53, s47
    s_add_u32 s53, s53, 4096
    s_waitcnt vmcnt(0)
    s_barrier
    ds_read_b128 a[112:115], v179 offset:0
    v_mfma_f32_16x16x32_bf16 v[68:71], a[132:135], a[168:171], v[68:71]
    ds_read_b64_tr_b16 a[152:153], v187 offset:0
    v_mfma_f32_16x16x32_bf16 v[76:79], a[136:139], a[168:171], v[76:79]
    ds_read_b64_tr_b16 a[154:155], v187 offset:3584
    v_mfma_f32_16x16x32_bf16 v[84:87], a[140:143], a[168:171], v[84:87]
    ds_read_b128 a[116:119], v179 offset:1024
    v_mfma_f32_16x16x32_bf16 v[92:95], a[144:147], a[168:171], v[92:95]
    ds_read_b128 a[120:123], v179 offset:2048
    s_cmp_lg_u32 s32, 2
    s_cbranch_scc1 L_h3
    v_mfma_f32_16x16x32_bf16 v[100:103], a[148:151], a[168:171], v[100:103]
L_h3:
    ds_read_b128 a[124:127], v179 offset:3072
    v_mfma_f32_16x16x32_bf16 v[72:75], a[132:135], a[172:175], v[72:75]
    ds_read_b64_tr_b16 a[156:157], v187 offset:7168
    v_mfma_f32_16x16x32_bf16 v[80:83], a[136:139], a[172:175], v[80:83]
    ds_read_b64_tr_b16 a[158:159], v187 offset:10752
    v_mfma_f32_16x16x32_bf16 v[88:91], a[140:143], a[172:175], v[88:91]
    ds_read_b128 a[128:131], v181 offset:0
    v_mfma_f32_16x16x32_bf16 v[96:99], a[144:147], a[172:175], v[96:99]
    ds_read_b64_tr_b16 a[160:161], v187 offset:37888
    s_cmp_lg_u32 s32, 3
    s_cbranch_scc1 L_h4
    v_mfma_f32_16x16x32_bf16 v[100:103], a[148:151], a[172:175], v[100:103]
L_h4:
    ds_read_b64_tr_b16 a[162:163], v187 offset:41472
    v_mfma_f32_16x16x32_bf16 v[4:7], a[176:179], a[132:135], v[4:7]
    ds_read_b64_tr_b16 a[164:165], v187 offset:45056
    v_mfma_f32_16x16x32_bf16 v[12:15], a[176:179], a[136:139], v[12:15]
    ds_read_b64_tr_b16 a[166:167], v187 offset:48640
    v_mfma_f32_16x16x32_bf16 v[20:23], a[176:179], a[140:143], v[20:23]
    v_mfma_f32_16x16x32_bf16 v[28:31], a[176:179], a[144:147], v[28:31]
    v_mfma_f32_16x16x32_bf16 v[8:11], a[180:183], a[132:135], v[8:11]
    v_mfma_f32_16x16x32_bf16 v[16:19], a[180:183], a[136:139], v[16:19]
    v_mfma_f32_16x16x32_bf16 v[24:27], a[180:183], a[140:143], v[24:27]
    v_mfma_f32_16x16x32_bf16 v[32:35], a[180:183], a[144:147], v[32:35]
    ds_read_b128 a[132:135], v179 offset:37888
    ds_read_b128 a[136:139], v179 offset:38912
    s_waitcnt lgkmcnt(12)
    v_mfma_f32_16x16x32_bf16 a[0:3], a[152:155], a[112:115], a[0:3]
    ds_read_b128 a[140:143], v179 offset:39936
    ds_read_b128 a[144:147], v179 offset:40960
    s_waitcnt lgkmcnt(13)
    v_mfma_f32_16x16x32_bf16 a[4:7], a[152:155], a[116:119], a[4:7]
    ds_read_b128 a[148:151], v181 offset:37888
    s_waitcnt lgkmcnt(13)
    v_mfma_f32_16x16x32_bf16 a[8:11], a[152:155], a[120:123], a[8:11]
    ds_read_b64_tr_b16 a[168:169], v187 offset:32
    ds_read_b64_tr_b16 a[172:173], v187 offset:7200
    s_waitcnt lgkmcnt(14)
    v_mfma_f32_16x16x32_bf16 a[12:15], a[152:155], a[124:127], a[12:15]
    s_waitcnt lgkmcnt(12)
    v_mfma_f32_16x16x32_bf16 v[104:107], a[156:159], a[112:115], v[104:107]
    ds_read_b64_tr_b16 a[170:171], v187 offset:3616
    ds_read_b64_tr_b16 a[174:175], v187 offset:10784
    v_mfma_f32_16x16x32_bf16 v[108:111], a[156:159], a[116:119], v[108:111]
    ds_read_b64_tr_b16 a[176:177], v187 offset:37920
    v_mfma_f32_16x16x32_bf16 v[112:115], a[156:159], a[120:123], v[112:115]
    ds_read_b64_tr_b16 a[178:179], v187 offset:41504
    v_mfma_f32_16x16x32_bf16 v[116:119], a[156:159], a[124:127], v[116:119]
    s_waitcnt lgkmcnt(10)
    v_mfma_f32_16x16x32_bf16 a[0:3], a[160:163], a[132:135], a[0:3]
    ds_read_b64_tr_b16 a[180:181], v187 offset:45088
    s_waitcnt lgkmcnt(10)
    v_mfma_f32_16x16x32_bf16 a[4:7], a[160:163], a[136:139], a[4:7]
    s_waitcnt lgkmcnt(9)
    v_mfma_f32_16x16x32_bf16 a[8:11], a[160:163], a[140:143], a[8:11]
    ds_read_b64_tr_b16 a[182:183], v187 offset:48672
    s_waitcnt lgkmcnt(9)
    v_mfma_f32_16x16x32_bf16 a[12:15], a[160:163], a[144:147], a[12:15]
    v_mfma_f32_16x16x32_bf16 v[104:107], a[164:167], a[132:135], v[104:107]
    ds_read_b64_tr_b16 a[152:153], v187 offset:64
    v_mfma_f32_16x16x32_bf16 v[108:111], a[164:167], a[136:139], v[108:111]
    v_mfma_f32_16x16x32_bf16 v[112:115], a[164:167], a[140:143], v[112:115]
    ds_read_b64_tr_b16 a[154:155], v187 offset:3648
    v_mfma_f32_16x16x32_bf16 v[116:119], a[164:167], a[144:147], v[116:119]
    s_waitcnt lgkmcnt(7)
    v_mfma_f32_16x16x32_bf16 a[16:19], a[168:171], a[112:115], a[16:19]
    ds_read_b64_tr_b16 a[156:157], v187 offset:7232
    v_mfma_f32_16x16x32_bf16 a[20:23], a[168:171], a[116:119], a[20:23]
    v_mfma_f32_16x16x32_bf16 a[24:27], a[168:171], a[120:123], a[24:27]
    ds_read_b64_tr_b16 a[158:159], v187 offset:10816
    v_mfma_f32_16x16x32_bf16 a[28:31], a[168:171], a[124:127], a[28:31]
    s_waitcnt lgkmcnt(8)
    v_mfma_f32_16x16x32_bf16 v[120:123], a[172:175], a[112:115], v[120:123]
    ds_read_b64_tr_b16 a[160:161], v187 offset:37952
    v_mfma_f32_16x16x32_bf16 v[124:127], a[172:175], a[116:119], v[124:127]
    v_mfma_f32_16x16x32_bf16 v[128:131], a[172:175], a[120:123], v[128:131]
    ds_read_b64_tr_b16 a[162:163], v187 offset:41536
    v_mfma_f32_16x16x32_bf16 v[132:135], a[172:175], a[124:127], v[132:135]
    s_waitcnt lgkmcnt(8)
    v_mfma_f32_16x16x32_bf16 a[16:19], a[176:179], a[132:135], a[16:19]
    ds_read_b64_tr_b16 a[164:165], v187 offset:45120
    v_mfma_f32_16x16x32_bf16 a[20:23], a[176:179], a[136:139], a[20:23]
    v_mfma_f32_16x16x32_bf16 a[24:27], a[176:179], a[140:143], a[24:27]
    ds_read_b64_tr_b16 a[166:167], v187 offset:48704
    v_mfma_f32_16x16x32_bf16 a[28:31], a[176:179], a[144:147], a[28:31]
    s_waitcnt lgkmcnt(8)
    v_mfma_f32_16x16x32_bf16 v[120:123], a[180:183], a[132:135], v[120:123]
    ds_read_b64_tr_b16 a[168:169], v187 offset:96
    v_mfma_f32_16x16x32_bf16 v[124:127], a[180:183], a[136:139], v[124:127]
    v_mfma_f32_16x16x32_bf16 v[128:131], a[180:183], a[140:143], v[128:131]
    ds_read_b64_tr_b16 a[170:171], v187 offset:3680
    v_mfma_f32_16x16x32_bf16 v[132:135], a[180:183], a[144:147], v[132:135]
    s_waitcnt lgkmcnt(8)
    v_mfma_f32_16x16x32_bf16 a[32:35], a[152:155], a[112:115], a[32:35]
    ds_read_b64_tr_b16 a[172:173], v187 offset:7264
    v_mfma_f32_16x16x32_bf16 a[36:39], a[152:155], a[116:119], a[36:39]
    v_mfma_f32_16x16x32_bf16 a[40:43], a[152:155], a[120:123], a[40:43]
    ds_read_b64_tr_b16 a[174:175], v187 offset:10848
    v_mfma_f32_16x16x32_bf16 a[44:47], a[152:155], a[124:127], a[44:47]
    s_waitcnt lgkmcnt(8)
    v_mfma_f32_16x16x32_bf16 v[136:139], a[156:159], a[112:115], v[136:139]
    ds_read_b64_tr_b16 a[176:177], v187 offset:37984
    v_mfma_f32_16x16x32_bf16 v[140:143], a[156:159], a[116:119], v[140:143]
    v_accvgpr_read_b32 v202, a0
    v_accvgpr_read_b32 v203, a1
    v_accvgpr_read_b32 v204, a2
    v_mfma_f32_16x16x32_bf16 v[144:147], a[156:159], a[120:123], v[144:147]
    ds_read_b64_tr_b16 a[178:179], v187 offset:41568
    v_accvgpr_read_b32 v205, a3
    v_pk_mul_f32 v[202:203], v[202:203], v[104:105]
    v_mfma_f32_16x16x32_bf16 v[148:151], a[156:159], a[124:127], v[148:151]
    s_waitcnt lgkmcnt(8)
    v_pk_mul_f32 v[204:205], v[204:205], v[106:107]
    v_cvt_pk_bf16_f32 v210, v202, v203
    v_mfma_f32_16x16x32_bf16 a[32:35], a[160:163], a[132:135], a[32:35]
    ds_read_b64_tr_b16 a[180:181], v187 offset:45152
    v_cvt_pk_bf16_f32 v211, v204, v205
    v_accvgpr_read_b32 v202, a16
    v_mfma_f32_16x16x32_bf16 a[36:39], a[160:163], a[136:139], a[36:39]
    v_accvgpr_read_b32 v203, a17
    v_accvgpr_read_b32 v204, a18
    v_accvgpr_read_b32 v205, a19
    v_mfma_f32_16x16x32_bf16 a[40:43], a[160:163], a[140:143], a[40:43]
    ds_read_b64_tr_b16 a[182:183], v187 offset:48736
    v_pk_mul_f32 v[202:203], v[202:203], v[120:121]
    v_pk_mul_f32 v[204:205], v[204:205], v[122:123]
    v_mfma_f32_16x16x32_bf16 a[44:47], a[160:163], a[144:147], a[44:47]
    s_waitcnt lgkmcnt(8)
    v_cvt_pk_bf16_f32 v212, v202, v203
    v_cvt_pk_bf16_f32 v213, v204, v205
    v_mfma_f32_16x16x32_bf16 v[136:139], a[164:167], a[132:135], v[136:139]
    ds_read_b64_tr_b16 a[152:153], v187 offset:128
    buffer_store_dwordx4 v[210:213], v194, s[24:27], s49 offen offset:0 sc1
    v_accvgpr_read_b32 v202, a4
    v_mfma_f32_16x16x32_bf16 v[140:143], a[164:167], a[136:139], v[140:143]
    v_accvgpr_read_b32 v203, a5
    v_accvgpr_read_b32 v204, a6
    v_accvgpr_read_b32 v205, a7
    v_mfma_f32_16x16x32_bf16 v[144:147], a[164:167], a[140:143], v[144:147]
    ds_read_b64_tr_b16 a[154:155], v187 offset:3712
    v_pk_mul_f32 v[202:203], v[202:203], v[108:109]
    v_pk_mul_f32 v[204:205], v[204:205], v[110:111]
    v_mfma_f32_16x16x32_bf16 v[148:151], a[164:167], a[144:147], v[148:151]
    s_waitcnt lgkmcnt(8)
    v_cvt_pk_bf16_f32 v214, v202, v203
    v_cvt_pk_bf16_f32 v215, v204, v205
    v_mfma_f32_16x16x32_bf16 a[48:51], a[168:171], a[112:115], a[48:51]
    ds_read_b64_tr_b16 a[156:157], v187 offset:7296
    v_accvgpr_read_b32 v202, a20
    v_accvgpr_read_b32 v203, a21
    v_mfma_f32_16x16x32_bf16 a[52:55], a[168:171], a[116:119], a[52:55]
    v_accvgpr_read_b32 v204, a22
    v_accvgpr_read_b32 v205, a23
    v_pk_mul_f32 v[202:203], v[202:203], v[124:125]
    v_mfma_f32_16x16x32_bf16 a[56:59], a[168:171], a[120:123], a[56:59]
    ds_read_b64_tr_b16 a[158:159], v187 offset:10880
    v_pk_mul_f32 v[204:205], v[204:205], v[126:127]
    v_cvt_pk_bf16_f32 v216, v202, v203
    v_mfma_f32_16x16x32_bf16 a[60:63], a[168:171], a[124:127], a[60:63]
    s_waitcnt lgkmcnt(8)
    v_cvt_pk_bf16_f32 v217, v204, v205
    buffer_store_dwordx4 v[214:217], v194, s[24:27], s49 offen offset:1024 sc1
    v_mfma_f32_16x16x32_bf16 v[152:155], a[172:175], a[112:115], v[152:155]
    ds_read_b64_tr_b16 a[160:161], v187 offset:38016
    v_accvgpr_read_b32 v202, a8
    v_accvgpr_read_b32 v203, a9
    v_mfma_f32_16x16x32_bf16 v[156:159], a[172:175], a[116:119], v[156:159]
    v_accvgpr_read_b32 v204, a10
    v_accvgpr_read_b32 v205, a11
    v_pk_mul_f32 v[202:203], v[202:203], v[112:113]
    v_mfma_f32_16x16x32_bf16 v[160:163], a[172:175], a[120:123], v[160:163]
    ds_read_b64_tr_b16 a[162:163], v187 offset:41600
    v_pk_mul_f32 v[204:205], v[204:205], v[114:115]
    v_cvt_pk_bf16_f32 v210, v202, v203
    v_mfma_f32_16x16x32_bf16 v[164:167], a[172:175], a[124:127], v[164:167]
    s_waitcnt lgkmcnt(8)
    v_cvt_pk_bf16_f32 v211, v204, v205
    v_accvgpr_read_b32 v202, a24
    v_mfma_f32_16x16x32_bf16 a[48:51], a[176:179], a[132:135], a[48:51]
    ds_read_b64_tr_b16 a[164:165], v187 offset:45184
    v_accvgpr_read_b32 v203, a25
    v_accvgpr_read_b32 v204, a26
    v_mfma_f32_16x16x32_bf16 a[52:55], a[176:179], a[136:139], a[52:55]
    v_accvgpr_read_b32 v205, a27
    v_pk_mul_f32 v[202:203], v[202:203], v[128:129]
    v_pk_mul_f32 v[204:205], v[204:205], v[130:131]
    v_mfma_f32_16x16x32_bf16 a[56:59], a[176:179], a[140:143], a[56:59]
    ds_read_b64_tr_b16 a[166:167], v187 offset:48768
    v_cvt_pk_bf16_f32 v212, v202, v203
    v_cvt_pk_bf16_f32 v213, v204, v205
    v_mfma_f32_16x16x32_bf16 a[60:63], a[176:179], a[144:147], a[60:63]
    s_waitcnt lgkmcnt(8)
    buffer_store_dwordx4 v[210:213], v194, s[24:27], s49 offen offset:2048 sc1
    v_accvgpr_read_b32 v202, a12
    v_mfma_f32_16x16x32_bf16 v[152:155], a[180:183], a[132:135], v[152:155]
    ds_read_b64_tr_b16 a[168:169], v187 offset:160
    v_accvgpr_read_b32 v203, a13
    v_accvgpr_read_b32 v204, a14
    v_mfma_f32_16x16x32_bf16 v[156:159], a[180:183], a[136:139], v[156:159]
    v_accvgpr_read_b32 v205, a15
    v_pk_mul_f32 v[202:203], v[202:203], v[116:117]
    v_pk_mul_f32 v[204:205], v[204:205], v[118:119]
    v_mfma_f32_16x16x32_bf16 v[160:163], a[180:183], a[140:143], v[160:163]
    ds_read_b64_tr_b16 a[170:171], v187 offset:3744
    v_cvt_pk_bf16_f32 v214, v202, v203
    v_cvt_pk_bf16_f32 v215, v204, v205
    v_mfma_f32_16x16x32_bf16 v[164:167], a[180:183], a[144:147], v[164:167]
    s_waitcnt lgkmcnt(8)
    v_accvgpr_read_b32 v202, a28
    v_accvgpr_read_b32 v203, a29
    v_mfma_f32_16x16x32_bf16 a[64:67], a[152:155], a[112:115], a[64:67]
    ds_read_b64_tr_b16 a[172:173], v187 offset:7328
    v_accvgpr_read_b32 v204, a30
    v_accvgpr_read_b32 v205, a31
    v_mfma_f32_16x16x32_bf16 a[68:71], a[152:155], a[116:119], a[68:71]
    v_pk_mul_f32 v[202:203], v[202:203], v[132:133]
    v_pk_mul_f32 v[204:205], v[204:205], v[134:135]
    v_cvt_pk_bf16_f32 v216, v202, v203
    v_mfma_f32_16x16x32_bf16 a[72:75], a[152:155], a[120:123], a[72:75]
    ds_read_b64_tr_b16 a[174:175], v187 offset:10912
    v_cvt_pk_bf16_f32 v217, v204, v205
    buffer_store_dwordx4 v[214:217], v194, s[24:27], s49 offen offset:3072 sc1
    v_mfma_f32_16x16x32_bf16 a[76:79], a[152:155], a[124:127], a[76:79]
    s_waitcnt lgkmcnt(8)
    v_mfma_f32_16x16x32_bf16 a[184:187], a[156:159], a[112:115], a[184:187]
    ds_read_b64_tr_b16 a[176:177], v187 offset:38048
    v_mfma_f32_16x16x32_bf16 a[188:191], a[156:159], a[116:119], a[188:191]
    v_accvgpr_read_b32 v202, a32
    v_accvgpr_read_b32 v203, a33
    v_accvgpr_read_b32 v204, a34
    v_mfma_f32_16x16x32_bf16 a[192:195], a[156:159], a[120:123], a[192:195]
    ds_read_b64_tr_b16 a[178:179], v187 offset:41632
    v_accvgpr_read_b32 v205, a35
    v_pk_mul_f32 v[202:203], v[202:203], v[136:137]
    v_mfma_f32_16x16x32_bf16 a[196:199], a[156:159], a[124:127], a[196:199]
    s_waitcnt lgkmcnt(8)
    v_pk_mul_f32 v[204:205], v[204:205], v[138:139]
    v_cvt_pk_bf16_f32 v210, v202, v203
    v_mfma_f32_16x16x32_bf16 a[64:67], a[160:163], a[132:135], a[64:67]
    ds_read_b64_tr_b16 a[180:181], v187 offset:45216
    v_cvt_pk_bf16_f32 v211, v204, v205
    v_accvgpr_read_b32 v202, a48
    v_mfma_f32_16x16x32_bf16 a[68:71], a[160:163], a[136:139], a[68:71]
    v_accvgpr_read_b32 v203, a49
    v_accvgpr_read_b32 v204, a50
    v_accvgpr_read_b32 v205, a51
    v_mfma_f32_16x16x32_bf16 a[72:75], a[160:163], a[140:143], a[72:75]
    ds_read_b64_tr_b16 a[182:183], v187 offset:48800
    v_pk_mul_f32 v[202:203], v[202:203], v[152:153]
    v_pk_mul_f32 v[204:205], v[204:205], v[154:155]
    v_mfma_f32_16x16x32_bf16 a[76:79], a[160:163], a[144:147], a[76:79]
    s_waitcnt lgkmcnt(8)
    v_cvt_pk_bf16_f32 v212, v202, v203
    v_cvt_pk_bf16_f32 v213, v204, v205
    v_mfma_f32_16x16x32_bf16 a[184:187], a[164:167], a[132:135], a[184:187]
    ds_read_b64_tr_b16 a[152:153], v187 offset:192
    buffer_store_dwordx4 v[210:213], v194, s[24:27], s50 offen offset:0 sc1
    v_accvgpr_read_b32 v202, a36
    v_mfma_f32_16x16x32_bf16 a[188:191], a[164:167], a[136:139], a[188:191]
    v_accvgpr_read_b32 v203, a37
    v_accvgpr_read_b32 v204, a38
    v_accvgpr_read_b32 v205, a39
    v_mfma_f32_16x16x32_bf16 a[192:195], a[164:167], a[140:143], a[192:195]
    ds_read_b64_tr_b16 a[154:155], v187 offset:3776
    v_pk_mul_f32 v[202:203], v[202:203], v[140:141]
    v_pk_mul_f32 v[204:205], v[204:205], v[142:143]
    v_mfma_f32_16x16x32_bf16 a[196:199], a[164:167], a[144:147], a[196:199]
    s_waitcnt lgkmcnt(8)
    v_cvt_pk_bf16_f32 v214, v202, v203
    v_cvt_pk_bf16_f32 v215, v204, v205
    v_mfma_f32_16x16x32_bf16 a[80:83], a[168:171], a[112:115], a[80:83]
    ds_read_b64_tr_b16 a[156:157], v187 offset:7360
    v_accvgpr_read_b32 v202, a52
    v_accvgpr_read_b32 v203, a53
    v_mfma_f32_16x16x32_bf16 a[84:87], a[168:171], a[116:119], a[84:87]
    v_accvgpr_read_b32 v204, a54
    v_accvgpr_read_b32 v205, a55
    v_pk_mul_f32 v[202:203], v[202:203], v[156:157]
    v_mfma_f32_16x16x32_bf16 a[88:91], a[168:171], a[120:123], a[88:91]
    ds_read_b64_tr_b16 a[158:159], v187 offset:10944
    v_pk_mul_f32 v[204:205], v[204:205], v[158:159]
    v_cvt_pk_bf16_f32 v216, v202, v203
    v_mfma_f32_16x16x32_bf16 a[92:95], a[168:171], a[124:127], a[92:95]
    s_waitcnt lgkmcnt(8)
    v_cvt_pk_bf16_f32 v217, v204, v205
    buffer_store_dwordx4 v[214:217], v194, s[24:27], s50 offen offset:1024 sc1
    v_mfma_f32_16x16x32_bf16 a[200:203], a[172:175], a[112:115], a[200:203]
    ds_read_b64_tr_b16 a[160:161], v187 offset:38080
    v_accvgpr_read_b32 v202, a40
    v_accvgpr_read_b32 v203, a41
    v_mfma_f32_16x16x32_bf16 a[204:207], a[172:175], a[116:119], a[204:207]
    v_accvgpr_read_b32 v204, a42
    v_accvgpr_read_b32 v205, a43
    v_pk_mul_f32 v[202:203], v[202:203], v[144:145]
    v_mfma_f32_16x16x32_bf16 a[208:211], a[172:175], a[120:123], a[208:211]
    ds_read_b64_tr_b16 a[162:163], v187 offset:41664
    v_pk_mul_f32 v[204:205], v[204:205], v[146:147]
    v_cvt_pk_bf16_f32 v210, v202, v203
    v_mfma_f32_16x16x32_bf16 a[212:215], a[172:175], a[124:127], a[212:215]
    s_waitcnt lgkmcnt(8)
    v_cvt_pk_bf16_f32 v211, v204, v205
    v_accvgpr_read_b32 v202, a56
    v_mfma_f32_16x16x32_bf16 a[80:83], a[176:179], a[132:135], a[80:83]
    ds_read_b64_tr_b16 a[164:165], v187 offset:45248
    v_accvgpr_read_b32 v203, a57
    v_accvgpr_read_b32 v204, a58
    v_mfma_f32_16x16x32_bf16 a[84:87], a[176:179], a[136:139], a[84:87]
    v_accvgpr_read_b32 v205, a59
    v_pk_mul_f32 v[202:203], v[202:203], v[160:161]
    v_pk_mul_f32 v[204:205], v[204:205], v[162:163]
    v_mfma_f32_16x16x32_bf16 a[88:91], a[176:179], a[140:143], a[88:91]
    ds_read_b64_tr_b16 a[166:167], v187 offset:48832
    v_cvt_pk_bf16_f32 v212, v202, v203
    v_cvt_pk_bf16_f32 v213, v204, v205
    v_mfma_f32_16x16x32_bf16 a[92:95], a[176:179], a[144:147], a[92:95]
    s_waitcnt lgkmcnt(8)
    buffer_store_dwordx4 v[210:213], v194, s[24:27], s50 offen offset:2048 sc1
    v_accvgpr_read_b32 v202, a44
    v_mfma_f32_16x16x32_bf16 a[200:203], a[180:183], a[132:135], a[200:203]
    ds_read_b64_tr_b16 a[168:169], v183 offset:17472
    v_accvgpr_read_b32 v203, a45
    v_accvgpr_read_b32 v204, a46
    v_mfma_f32_16x16x32_bf16 a[204:207], a[180:183], a[136:139], a[204:207]
    v_accvgpr_read_b32 v205, a47
    v_pk_mul_f32 v[202:203], v[202:203], v[148:149]
    v_pk_mul_f32 v[204:205], v[204:205], v[150:151]
    v_mfma_f32_16x16x32_bf16 a[208:211], a[180:183], a[140:143], a[208:211]
    ds_read_b64_tr_b16 a[170:171], v183 offset:20544
    v_cvt_pk_bf16_f32 v214, v202, v203
    v_cvt_pk_bf16_f32 v215, v204, v205
    v_mfma_f32_16x16x32_bf16 a[212:215], a[180:183], a[144:147], a[212:215]
    s_waitcnt lgkmcnt(8)
    v_accvgpr_read_b32 v202, a60
    v_accvgpr_read_b32 v203, a61
    v_mfma_f32_16x16x32_bf16 a[96:99], a[152:155], a[112:115], a[96:99]
    ds_read_b64_tr_b16 a[172:173], v185 offset:17472
    v_accvgpr_read_b32 v204, a62
    v_accvgpr_read_b32 v205, a63
    v_mfma_f32_16x16x32_bf16 a[100:103], a[152:155], a[116:119], a[100:103]
    v_pk_mul_f32 v[202:203], v[202:203], v[164:165]
    v_pk_mul_f32 v[204:205], v[204:205], v[166:167]
    v_cvt_pk_bf16_f32 v216, v202, v203
    v_mfma_f32_16x16x32_bf16 a[104:107], a[152:155], a[120:123], a[104:107]
    ds_read_b64_tr_b16 a[174:175], v185 offset:20544
    v_cvt_pk_bf16_f32 v217, v204, v205
    buffer_store_dwordx4 v[214:217], v194, s[24:27], s50 offen offset:3072 sc1
    v_mfma_f32_16x16x32_bf16 a[108:111], a[152:155], a[124:127], a[108:111]
    s_waitcnt lgkmcnt(8)
    v_mfma_f32_16x16x32_bf16 a[216:219], a[156:159], a[112:115], a[216:219]
    ds_read_b64_tr_b16 a[176:177], v183 offset:55360
    v_mfma_f32_16x16x32_bf16 a[220:223], a[156:159], a[116:119], a[220:223]
    v_accvgpr_read_b32 v202, a64
    v_accvgpr_read_b32 v203, a65
    v_accvgpr_read_b32 v204, a66
    v_mfma_f32_16x16x32_bf16 a[224:227], a[156:159], a[120:123], a[224:227]
    ds_read_b64_tr_b16 a[178:179], v183 offset:58432
    v_accvgpr_read_b32 v205, a67
    v_accvgpr_read_b32 v206, a184
    v_mfma_f32_16x16x32_bf16 a[228:231], a[156:159], a[124:127], a[228:231]
    s_waitcnt lgkmcnt(8)
    v_accvgpr_read_b32 v207, a185
    v_accvgpr_read_b32 v208, a186
    v_mfma_f32_16x16x32_bf16 a[96:99], a[160:163], a[132:135], a[96:99]
    ds_read_b64_tr_b16 a[180:181], v185 offset:55360
    v_accvgpr_read_b32 v209, a187
    v_pk_mul_f32 v[202:203], v[202:203], v[206:207]
    v_mfma_f32_16x16x32_bf16 a[100:103], a[160:163], a[136:139], a[100:103]
    v_pk_mul_f32 v[204:205], v[204:205], v[208:209]
    v_cvt_pk_bf16_f32 v210, v202, v203
    v_cvt_pk_bf16_f32 v211, v204, v205
    v_mfma_f32_16x16x32_bf16 a[104:107], a[160:163], a[140:143], a[104:107]
    ds_read_b64_tr_b16 a[182:183], v185 offset:58432
    v_accvgpr_read_b32 v202, a80
    v_accvgpr_read_b32 v203, a81
    v_mfma_f32_16x16x32_bf16 a[108:111], a[160:163], a[144:147], a[108:111]
    s_waitcnt lgkmcnt(8)
    v_accvgpr_read_b32 v204, a82
    v_accvgpr_read_b32 v205, a83
    v_mfma_f32_16x16x32_bf16 a[216:219], a[164:167], a[132:135], a[216:219]
    ds_read_b64_tr_b16 a[152:153], v183 offset:17536
    v_accvgpr_read_b32 v206, a200
    v_accvgpr_read_b32 v207, a201
    v_mfma_f32_16x16x32_bf16 a[220:223], a[164:167], a[136:139], a[220:223]
    v_accvgpr_read_b32 v208, a202
    v_accvgpr_read_b32 v209, a203
    v_pk_mul_f32 v[202:203], v[202:203], v[206:207]
    v_mfma_f32_16x16x32_bf16 a[224:227], a[164:167], a[140:143], a[224:227]
    ds_read_b64_tr_b16 a[154:155], v183 offset:20608
    v_pk_mul_f32 v[204:205], v[204:205], v[208:209]
    v_cvt_pk_bf16_f32 v212, v202, v203
    v_mfma_f32_16x16x32_bf16 a[228:231], a[164:167], a[144:147], a[228:231]
    s_waitcnt lgkmcnt(8)
    v_cvt_pk_bf16_f32 v213, v204, v205
    buffer_store_dwordx4 v[210:213], v194, s[24:27], s51 offen offset:0 sc1
    v_mfma_f32_16x16x32_bf16 v[36:39], a[168:171], a[112:115], v[36:39]
    ds_read_b64_tr_b16 a[156:157], v185 offset:17536
    v_accvgpr_read_b32 v202, a68
    v_accvgpr_read_b32 v203, a69
    v_mfma_f32_16x16x32_bf16 v[44:47], a[168:171], a[116:119], v[44:47]
    v_accvgpr_read_b32 v204, a70
    v_accvgpr_read_b32 v205, a71
    v_accvgpr_read_b32 v206, a188
    v_mfma_f32_16x16x32_bf16 v[52:55], a[168:171], a[120:123], v[52:55]
    ds_read_b64_tr_b16 a[158:159], v185 offset:20608
    v_accvgpr_read_b32 v207, a189
    v_accvgpr_read_b32 v208, a190
    v_mfma_f32_16x16x32_bf16 v[60:63], a[168:171], a[124:127], v[60:63]
    v_accvgpr_read_b32 v209, a191
    v_pk_mul_f32 v[202:203], v[202:203], v[206:207]
    v_pk_mul_f32 v[204:205], v[204:205], v[208:209]
    s_cmp_lg_u32 s32, 0
    s_cbranch_scc1 L_h5
    v_mfma_f32_16x16x32_bf16 v[100:103], a[168:171], a[128:131], v[100:103]
L_h5:
    s_waitcnt lgkmcnt(8)
    v_cvt_pk_bf16_f32 v214, v202, v203
    v_cvt_pk_bf16_f32 v215, v204, v205
    v_mfma_f32_16x16x32_bf16 v[40:43], a[172:175], a[112:115], v[40:43]
    ds_read_b64_tr_b16 a[160:161], v183 offset:55424
    v_accvgpr_read_b32 v202, a84
    v_accvgpr_read_b32 v203, a85
    v_mfma_f32_16x16x32_bf16 v[48:51], a[172:175], a[116:119], v[48:51]
    v_accvgpr_read_b32 v204, a86
    v_accvgpr_read_b32 v205, a87
    v_accvgpr_read_b32 v206, a204
    v_mfma_f32_16x16x32_bf16 v[56:59], a[172:175], a[120:123], v[56:59]
    ds_read_b64_tr_b16 a[162:163], v183 offset:58496
    v_accvgpr_read_b32 v207, a205
    v_accvgpr_read_b32 v208, a206
    v_mfma_f32_16x16x32_bf16 v[64:67], a[172:175], a[124:127], v[64:67]
    v_accvgpr_read_b32 v209, a207
    v_pk_mul_f32 v[202:203], v[202:203], v[206:207]
    v_pk_mul_f32 v[204:205], v[204:205], v[208:209]
    s_cmp_lg_u32 s32, 1
    s_cbranch_scc1 L_h6
    v_mfma_f32_16x16x32_bf16 v[100:103], a[172:175], a[128:131], v[100:103]
L_h6:
    s_waitcnt lgkmcnt(8)
    v_cvt_pk_bf16_f32 v216, v202, v203
    v_cvt_pk_bf16_f32 v217, v204, v205
    v_mfma_f32_16x16x32_bf16 v[36:39], a[176:179], a[132:135], v[36:39]
    ds_read_b64_tr_b16 a[164:165], v185 offset:55424
    buffer_store_dwordx4 v[214:217], v194, s[24:27], s51 offen offset:1024 sc1
    v_accvgpr_read_b32 v202, a72
    v_mfma_f32_16x16x32_bf16 v[44:47], a[176:179], a[136:139], v[44:47]
    v_accvgpr_read_b32 v203, a73
    v_accvgpr_read_b32 v204, a74
    v_accvgpr_read_b32 v205, a75
    v_mfma_f32_16x16x32_bf16 v[52:55], a[176:179], a[140:143], v[52:55]
    ds_read_b64_tr_b16 a[166:167], v185 offset:58496
    v_accvgpr_read_b32 v206, a192
    v_accvgpr_read_b32 v207, a193
    v_mfma_f32_16x16x32_bf16 v[60:63], a[176:179], a[144:147], v[60:63]
    v_accvgpr_read_b32 v208, a194
    v_accvgpr_read_b32 v209, a195
    v_pk_mul_f32 v[202:203], v[202:203], v[206:207]
    s_cmp_lg_u32 s32, 0
    s_cbranch_scc1 L_h7
    v_mfma_f32_16x16x32_bf16 v[100:103], a[176:179], a[148:151], v[100:103]
L_h7:
    s_waitcnt lgkmcnt(8)
    v_pk_mul_f32 v[204:205], v[204:205], v[208:209]
    v_cvt_pk_bf16_f32 v210, v202, v203
    v_mfma_f32_16x16x32_bf16 v[40:43], a[180:183], a[132:135], v[40:43]
    ds_read_b64_tr_b16 a[168:169], v183 offset:17408
    v_cvt_pk_bf16_f32 v211, v204, v205
    v_accvgpr_read_b32 v202, a88
    v_mfma_f32_16x16x32_bf16 v[48:51], a[180:183], a[136:139], v[48:51]
    v_accvgpr_read_b32 v203, a89
    v_accvgpr_read_b32 v204, a90
    v_accvgpr_read_b32 v205, a91
    v_mfma_f32_16x16x32_bf16 v[56:59], a[180:183], a[140:143], v[56:59]
    ds_read_b64_tr_b16 a[170:171], v183 offset:20480
    v_accvgpr_read_b32 v206, a208
    v_accvgpr_read_b32 v207, a209
    v_mfma_f32_16x16x32_bf16 v[64:67], a[180:183], a[144:147], v[64:67]
    v_accvgpr_read_b32 v208, a210
    v_accvgpr_read_b32 v209, a211
    v_pk_mul_f32 v[202:203], v[202:203], v[206:207]
    s_cmp_lg_u32 s32, 1
    s_cbranch_scc1 L_h8
    v_mfma_f32_16x16x32_bf16 v[100:103], a[180:183], a[148:151], v[100:103]
L_h8:
    s_waitcnt lgkmcnt(8)
    v_pk_mul_f32 v[204:205], v[204:205], v[208:209]
    v_cvt_pk_bf16_f32 v212, v202, v203
    v_mfma_f32_16x16x32_bf16 v[68:71], a[112:115], a[152:155], v[68:71]
    ds_read_b64_tr_b16 a[172:173], v185 offset:17408
    v_cvt_pk_bf16_f32 v213, v204, v205
    buffer_store_dwordx4 v[210:213], v194, s[24:27], s51 offen offset:2048 sc1
    v_mfma_f32_16x16x32_bf16 v[76:79], a[116:119], a[152:155], v[76:79]
    s_waitcnt vmcnt(7)
    s_mov_b64 exec, 0xff
    buffer_store_byte v193, v192, s[84:87], s41 offen sc1
    s_mov_b64 exec, -1
    s_nop 3
    v_accvgpr_read_b32 v202, a76
    v_mfma_f32_16x16x32_bf16 v[84:87], a[120:123], a[152:155], v[84:87]
    ds_read_b64_tr_b16 a[174:175], v185 offset:20480
    v_accvgpr_read_b32 v203, a77
    v_accvgpr_read_b32 v204, a78
    v_mfma_f32_16x16x32_bf16 v[92:95], a[124:127], a[152:155], v[92:95]
    v_accvgpr_read_b32 v205, a79
    v_accvgpr_read_b32 v206, a196
    v_accvgpr_read_b32 v207, a197
    s_cmp_lg_u32 s32, 2
    s_cbranch_scc1 L_h9
    v_mfma_f32_16x16x32_bf16 v[100:103], a[128:131], a[152:155], v[100:103]
L_h9:
    s_waitcnt lgkmcnt(8)
    v_accvgpr_read_b32 v208, a198
    v_accvgpr_read_b32 v209, a199
    v_mfma_f32_16x16x32_bf16 v[72:75], a[112:115], a[156:159], v[72:75]
    ds_read_b64_tr_b16 a[176:177], v183 offset:55296
    v_pk_mul_f32 v[202:203], v[202:203], v[206:207]
    v_pk_mul_f32 v[204:205], v[204:205], v[208:209]
    v_mfma_f32_16x16x32_bf16 v[80:83], a[116:119], a[156:159], v[80:83]
    v_cvt_pk_bf16_f32 v214, v202, v203
    v_cvt_pk_bf16_f32 v215, v204, v205
    v_accvgpr_read_b32 v202, a92
    v_mfma_f32_16x16x32_bf16 v[88:91], a[120:123], a[156:159], v[88:91]
    ds_read_b64_tr_b16 a[178:179], v183 offset:58368
    v_accvgpr_read_b32 v203, a93
    v_accvgpr_read_b32 v204, a94
    v_mfma_f32_16x16x32_bf16 v[96:99], a[124:127], a[156:159], v[96:99]
    v_accvgpr_read_b32 v205, a95
    v_accvgpr_read_b32 v206, a212
    v_accvgpr_read_b32 v207, a213
    s_cmp_lg_u32 s32, 3
    s_cbranch_scc1 L_h10
    v_mfma_f32_16x16x32_bf16 v[100:103], a[128:131], a[156:159], v[100:103]
L_h10:
    s_waitcnt lgkmcnt(8)
    v_accvgpr_read_b32 v208, a214
    v_accvgpr_read_b32 v209, a215
    v_mfma_f32_16x16x32_bf16 v[68:71], a[132:135], a[160:163], v[68:71]
    ds_read_b64_tr_b16 a[180:181], v185 offset:55296
    v_pk_mul_f32 v[202:203], v[202:203], v[206:207]
    v_pk_mul_f32 v[204:205], v[204:205], v[208:209]
    v_mfma_f32_16x16x32_bf16 v[76:79], a[136:139], a[160:163], v[76:79]
    v_cvt_pk_bf16_f32 v216, v202, v203
    v_cvt_pk_bf16_f32 v217, v204, v205
    buffer_store_dwordx4 v[214:217], v194, s[24:27], s51 offen offset:3072 sc1
    v_mfma_f32_16x16x32_bf16 v[84:87], a[140:143], a[160:163], v[84:87]
    ds_read_b64_tr_b16 a[182:183], v185 offset:58368
    v_accvgpr_read_b32 v202, a96
    v_accvgpr_read_b32 v203, a97
    v_mfma_f32_16x16x32_bf16 v[92:95], a[144:147], a[160:163], v[92:95]
    v_accvgpr_read_b32 v204, a98
    v_accvgpr_read_b32 v205, a99
    v_accvgpr_read_b32 v206, a216
    s_cmp_lg_u32 s32, 2
    s_cbranch_scc1 L_h11
    v_mfma_f32_16x16x32_bf16 v[100:103], a[148:151], a[160:163], v[100:103]
L_h11:
    s_waitcnt lgkmcnt(8)
    v_accvgpr_read_b32 v207, a217
    v_accvgpr_read_b32 v208, a218
    v_mfma_f32_16x16x32_bf16 v[72:75], a[132:135], a[164:167], v[72:75]
    v_accvgpr_read_b32 v209, a219
    v_pk_mul_f32 v[202:203], v[202:203], v[206:207]
    v_pk_mul_f32 v[204:205], v[204:205], v[208:209]
    v_mfma_f32_16x16x32_bf16 v[80:83], a[136:139], a[164:167], v[80:83]
    v_cvt_pk_bf16_f32 v210, v202, v203
    v_cvt_pk_bf16_f32 v211, v204, v205
    buffer_store_dwordx2 v[210:211], v195, s[24:27], s52 offen offset:0 sc1
    v_mfma_f32_16x16x32_bf16 v[88:91], a[140:143], a[164:167], v[88:91]
    v_accvgpr_read_b32 v202, a100
    v_accvgpr_read_b32 v203, a101
    v_accvgpr_read_b32 v204, a102
    v_mfma_f32_16x16x32_bf16 v[96:99], a[144:147], a[164:167], v[96:99]
    v_accvgpr_read_b32 v205, a103
    v_accvgpr_read_b32 v206, a220
    v_accvgpr_read_b32 v207, a221
    s_cmp_lg_u32 s32, 3
    s_cbranch_scc1 L_h12
    v_mfma_f32_16x16x32_bf16 v[100:103], a[148:151], a[164:167], v[100:103]
L_h12:
    s_waitcnt lgkmcnt(6)
    v_accvgpr_read_b32 v208, a222
    v_accvgpr_read_b32 v209, a223
    v_mfma_f32_16x16x32_bf16 v[4:7], a[168:171], a[112:115], v[4:7]
    v_pk_mul_f32 v[202:203], v[202:203], v[206:207]
    v_pk_mul_f32 v[204:205], v[204:205], v[208:209]
    v_cvt_pk_bf16_f32 v214, v202, v203
    v_mfma_f32_16x16x32_bf16 v[12:15], a[168:171], a[116:119], v[12:15]
    v_cvt_pk_bf16_f32 v215, v204, v205
    buffer_store_dwordx2 v[214:215], v195, s[24:27], s52 offen offset:1024 sc1
    v_accvgpr_read_b32 v202, a104
    v_mfma_f32_16x16x32_bf16 v[20:23], a[168:171], a[120:123], v[20:23]
    v_accvgpr_read_b32 v203, a105
    v_accvgpr_read_b32 v204, a106
    v_accvgpr_read_b32 v205, a107
    v_mfma_f32_16x16x32_bf16 v[28:31], a[168:171], a[124:127], v[28:31]
    s_waitcnt lgkmcnt(4)
    v_accvgpr_read_b32 v206, a224
    v_accvgpr_read_b32 v207, a225
    v_mfma_f32_16x16x32_bf16 v[8:11], a[172:175], a[112:115], v[8:11]
    v_accvgpr_read_b32 v208, a226
    v_accvgpr_read_b32 v209, a227
    v_pk_mul_f32 v[202:203], v[202:203], v[206:207]
    v_mfma_f32_16x16x32_bf16 v[16:19], a[172:175], a[116:119], v[16:19]
    v_pk_mul_f32 v[204:205], v[204:205], v[208:209]
    v_cvt_pk_bf16_f32 v210, v202, v203
    v_cvt_pk_bf16_f32 v211, v204, v205
    v_mfma_f32_16x16x32_bf16 v[24:27], a[172:175], a[120:123], v[24:27]
    buffer_store_dwordx2 v[210:211], v195, s[24:27], s52 offen offset:2048 sc1
    v_accvgpr_read_b32 v202, a108
    v_accvgpr_read_b32 v203, a109
    v_mfma_f32_16x16x32_bf16 v[32:35], a[172:175], a[124:127], v[32:35]
    s_waitcnt lgkmcnt(2)
    v_accvgpr_read_b32 v204, a110
    v_accvgpr_read_b32 v205, a111
    v_mfma_f32_16x16x32_bf16 v[4:7], a[176:179], a[132:135], v[4:7]
    v_accvgpr_read_b32 v206, a228
    v_accvgpr_read_b32 v207, a229
    v_accvgpr_read_b32 v208, a230
    v_mfma_f32_16x16x32_bf16 v[12:15], a[176:179], a[136:139], v[12:15]
    v_accvgpr_read_b32 v209, a231
    v_pk_mul_f32 v[202:203], v[202:203], v[206:207]
    v_pk_mul_f32 v[204:205], v[204:205], v[208:209]
    v_mfma_f32_16x16x32_bf16 v[20:23], a[176:179], a[140:143], v[20:23]
    v_cvt_pk_bf16_f32 v214, v202, v203
    v_cvt_pk_bf16_f32 v215, v204, v205
    buffer_store_dwordx2 v[214:215], v195, s[24:27], s52 offen offset:3072 sc1
    v_mfma_f32_16x16x32_bf16 v[28:31], a[176:179], a[144:147], v[28:31]
    s_waitcnt lgkmcnt(0)
    v_mfma_f32_16x16x32_bf16 v[8:11], a[180:183], a[132:135], v[8:11]
    v_mfma_f32_16x16x32_bf16 v[16:19], a[180:183], a[136:139], v[16:19]
    v_mfma_f32_16x16x32_bf16 v[24:27], a[180:183], a[140:143], v[24:27]
    v_mfma_f32_16x16x32_bf16 v[32:35], a[180:183], a[144:147], v[32:35]
    v_cvt_pk_bf16_f32 v36, v36, v37
    v_cvt_pk_bf16_f32 v37, v38, v39
    v_cvt_pk_bf16_f32 v38, v40, v41
    v_cvt_pk_bf16_f32 v39, v42, v43
    v_cvt_pk_bf16_f32 v40, v44, v45
    v_cvt_pk_bf16_f32 v41, v46, v47
    v_cvt_pk_bf16_f32 v42, v48, v49
    v_cvt_pk_bf16_f32 v43, v50, v51
    v_cvt_pk_bf16_f32 v44, v52, v53
    v_cvt_pk_bf16_f32 v45, v54, v55
    v_cvt_pk_bf16_f32 v46, v56, v57
    v_cvt_pk_bf16_f32 v47, v58, v59
    v_cvt_pk_bf16_f32 v48, v60, v61
    v_cvt_pk_bf16_f32 v49, v62, v63
    v_cvt_pk_bf16_f32 v50, v64, v65
    v_cvt_pk_bf16_f32 v51, v66, v67
    v_cvt_pk_bf16_f32 v54, v68, v69
    v_cvt_pk_bf16_f32 v55, v70, v71
    v_cvt_pk_bf16_f32 v64, v72, v73
    v_cvt_pk_bf16_f32 v65, v74, v75
    v_cvt_pk_bf16_f32 v56, v76, v77
    v_cvt_pk_bf16_f32 v57, v78, v79
    v_cvt_pk_bf16_f32 v66, v80, v81
    v_cvt_pk_bf16_f32 v67, v82, v83
    v_cvt_pk_bf16_f32 v58, v84, v85
    v_cvt_pk_bf16_f32 v59, v86, v87
    v_cvt_pk_bf16_f32 v68, v88, v89
    v_cvt_pk_bf16_f32 v69, v90, v91
    v_cvt_pk_bf16_f32 v60, v92, v93
    v_cvt_pk_bf16_f32 v61, v94, v95
    v_cvt_pk_bf16_f32 v70, v96, v97
    v_cvt_pk_bf16_f32 v71, v98, v99
    s_lshl_b32 s47, s32, 11
    s_add_u32 s47, s47, 153600
    v_add_u32 v188, s47, v3
    v_lshrrev_b32 v189, 1, v3
    v_add_u32 v190, s47, v189
    ds_write_b128 v188, v[48:51]
    ds_write_b64 v190, v[60:61] offset:1024
    ds_write_b64 v190, v[70:71] offset:1536
    v_cvt_pk_bf16_f32 v4, v4, v5
    v_cvt_pk_bf16_f32 v5, v6, v7
    v_cvt_pk_bf16_f32 v6, v8, v9
    v_cvt_pk_bf16_f32 v7, v10, v11
    v_cvt_pk_bf16_f32 v8, v12, v13
    v_cvt_pk_bf16_f32 v9, v14, v15
    v_cvt_pk_bf16_f32 v10, v16, v17
    v_cvt_pk_bf16_f32 v11, v18, v19
    v_cvt_pk_bf16_f32 v12, v20, v21
    v_cvt_pk_bf16_f32 v13, v22, v23
    v_cvt_pk_bf16_f32 v14, v24, v25
    v_cvt_pk_bf16_f32 v15, v26, v27
    v_cvt_pk_bf16_f32 v16, v28, v29
    v_cvt_pk_bf16_f32 v17, v30, v31
    v_cvt_pk_bf16_f32 v18, v32, v33
    v_cvt_pk_bf16_f32 v19, v34, v35
    v_cvt_pk_bf16_f32 v20, v100, v101
    v_cvt_pk_bf16_f32 v21, v102, v103
    s_lshl_b32 s57, s32, 3
    s_lshl_b32 s58, s32, 9
    s_cmp_lt_u32 s32, 2
    s_cselect_b32 s56, 4, 3
    s_cselect_b32 s57, s57, s58
    s_add_u32 s57, s57, 151552
    v_lshlrev_b32 v191, s56, v1
    v_add_u32 v191, s57, v191
    ds_write_b64 v191, v[20:21]
    s_and_b32 s60, s2, 1
    s_bfe_u32 s61, s2, 0x20001
    s_lshl_b32 s61, s61, 2
    s_bfe_u32 s47, s2, 0x20003
    s_add_u32 s61, s61, s47
    s_lshr_b32 s62, s2, 5
    s_lshl_b32 s63, s62, 8
    s_lshl_b32 s41, s61, 13
    s_add_u32 s47, s41, 4194304
    s_add_u32 s8, s82, s47
    s_addc_u32 s9, s83, 0
    s_and_b32 s9, s9, 0xffff
    s_mov_b32 s10, 0
    s_mov_b32 s11, 0x00020000
    s_sub_u32 s10, 18874368, s41
    s_add_u32 s12, s76, s63
    s_addc_u32 s13, s77, 0
    s_and_b32 s13, s13, 0xffff
    s_mov_b32 s14, 0
    s_mov_b32 s15, 0x00020000
    s_sub_u32 s14, 7340032, s63
    s_add_u32 s98, s68, s63
    s_addc_u32 s39, s69, 0
    s_and_b32 s39, s39, 0xffff
    s_sub_u32 s99, 2097152, s63
    s_mov_b32 s92, s76
    s_and_b32 s93, s77, 0xffff
    s_mov_b32 s94, 7340032
    s_mov_b32 s95, 0x00020000
    s_and_b32 s4, s32, 1
    s_lshl_b32 s5, s4, 2
    s_mul_i32 s6, s4, 7
    s_add_u32 s6, s6, 3
    s_cmp_lt_u32 s32, 2
    s_cselect_b32 s7, 32, 0
    s_cselect_b32 s41, 17, 16
    s_add_u32 s5, s5, s7
    s_add_u32 s6, s6, s7
    s_add_u32 s28, s5, 56
    s_add_u32 s30, s5, 2
    s_cmp_eq_u32 s60, 1
    s_cselect_b32 s28, s5, s28
    s_cselect_b32 s38, s6, s4
    s_cselect_b32 s54, 14, 2
    s_cselect_b32 s31, 8, 10
    s_cselect_b32 s98, s12, s98
    s_cselect_b32 s39, s13, s39
    s_cselect_b32 s99, s14, s99
    s_cselect_b32 s59, 1, 2
    s_cselect_b32 s97, 3, 0
    s_sub_u32 s30, s30, s60
    s_lshl_b32 s28, s28, s41
    s_lshl_b32 s30, s30, s41
    s_lshl_b32 s38, s38, s41
    s_lshl_b32 s58, s54, 18
    s_lshl_b32 s54, s54, s41
    s_lshl_b32 s29, 7, s41
    s_lshl_b32 s59, s59, 16
    s_lshl_b32 s97, s97, 16
    s_mov_b32 s46, 1835008
    s_sub_u32 s55, s31, 1
    s_sub_u32 s40, s31, 5
    s_lshl_b32 s36, s32, 13
    s_lshl_b32 s44, s61, 3
    s_add_u32 s44, s44, s62
    s_lshl_b32 s44, s44, 7
    s_add_u32 s44, s44, 16416
    s_lshl_b32 s47, s60, 5
    s_sub_u32 s44, s44, s47
    s_waitcnt lgkmcnt(0)
    s_barrier
    v_subrev_u32 v188, 2048, v188
    v_subrev_u32 v190, 2048, v190
    ds_read_b128 v[32:35], v188
    ds_read_b64 v[52:53], v190 offset:1024
    ds_read_b64 v[62:63], v190 offset:1536
    v_and_b32 v188, 15, v1
    v_lshrrev_b32 v189, 4, v1
    v_and_b32 v190, 1, v1
    v_lshlrev_b32 v28, 4, v190
    v_lshl_add_u32 v189, v189, 2, v190
    v_add_u32 v191, 2, v189
    v_add_u32 v192, 2, v188
    v_mov_b32 v193, 0xf149f2ca
    v_cmp_eq_u32 s[56:57], 1, v190
    v_cmp_le_u32 s[4:5], v189, v188
    v_cmp_le_u32 s[6:7], v191, v188
    v_cmp_ge_u32 s[42:43], v189, v192
    v_cmp_ge_u32 s[0:1], v191, v192
    v_mov_b32 v72, 0x3f803f80
    v_mov_b32 v73, 0x3f803f80
    v_mov_b32 v74, 0x3f803f80
    v_mov_b32 v75, 0x3f803f80
    v_cndmask_b32 v22, v193, 0, s[4:5]
    v_cndmask_b32 v23, v193, 0, s[6:7]
    v_cndmask_b32 v24, v193, 0, s[42:43]
    v_cndmask_b32 v25, v193, 0, s[0:1]
    s_or_b32 s47, s34, s32
    s_cmp_eq_u32 s47, 0
    s_cselect_b64 vcc, -1, 0
    v_cndmask_b32 v26, v24, v193, vcc
    v_cndmask_b32 v27, v25, v193, vcc
    s_waitcnt lgkmcnt(0)
    s_mov_b32 s47, 0x3e8293ee
    v_mfma_f32_16x16x32_bf16 v[120:123], v[36:39], v[8:11], 0
    v_mfma_f32_16x16x32_bf16 v[124:127], v[40:43], v[8:11], 0
    v_mfma_f32_16x16x32_bf16 v[136:139], v[40:43], v[12:15], 0
    v_mfma_f32_16x16x32_bf16 v[140:143], v[44:47], v[12:15], 0
    v_mfma_f32_16x16x32_bf16 v[152:155], v[44:47], v[16:19], 0
    v_mfma_f32_16x16x32_bf16 v[156:159], v[48:51], v[16:19], 0
    v_mfma_f32_16x16x32_bf16 v[104:107], v[32:35], v[4:7], 0
    v_mfma_f32_16x16x32_bf16 v[108:111], v[36:39], v[4:7], 0
    s_nop 2
    v_cndmask_b32 v128, v120, v121, s[56:57]
    v_cndmask_b32 v129, v122, v123, s[56:57]
    v_cndmask_b32 v130, v124, v125, s[56:57]
    v_cndmask_b32 v131, v126, v127, s[56:57]
    v_fma_f32 v128, v128, s47, v24
    v_fma_f32 v129, v129, s47, v25
    v_fma_f32 v130, v130, s47, v22
    v_fma_f32 v131, v131, s47, v23
    v_max3_f32 v132, v128, v129, v130
    v_max_f32 v132, v132, v131
    v_mov_b32 v133, v132
    v_cndmask_b32 v144, v136, v137, s[56:57]
    v_cndmask_b32 v145, v138, v139, s[56:57]
    v_cndmask_b32 v146, v140, v141, s[56:57]
    v_cndmask_b32 v147, v142, v143, s[56:57]
    v_fma_f32 v144, v144, s47, v24
    v_fma_f32 v145, v145, s47, v25
    v_fma_f32 v146, v146, s47, v22
    v_fma_f32 v147, v147, s47, v23
    v_max3_f32 v148, v144, v145, v146
    v_max_f32 v148, v148, v147
    v_mov_b32 v149, v148
    v_cndmask_b32 v160, v152, v153, s[56:57]
    v_cndmask_b32 v161, v154, v155, s[56:57]
    v_cndmask_b32 v162, v156, v157, s[56:57]
    v_cndmask_b32 v163, v158, v159, s[56:57]
    v_fma_f32 v160, v160, s47, v24
    v_fma_f32 v161, v161, s47, v25
    v_fma_f32 v162, v162, s47, v22
    v_fma_f32 v163, v163, s47, v23
    v_max3_f32 v164, v160, v161, v162
    v_max_f32 v164, v164, v163
    v_mov_b32 v165, v164
    v_cndmask_b32 v112, v104, v105, s[56:57]
    v_cndmask_b32 v113, v106, v107, s[56:57]
    v_cndmask_b32 v114, v108, v109, s[56:57]
    v_cndmask_b32 v115, v110, v111, s[56:57]
    v_fma_f32 v112, v112, s47, v26
    v_fma_f32 v113, v113, s47, v27
    v_fma_f32 v114, v114, s47, v22
    v_fma_f32 v115, v115, s47, v23
    v_max3_f32 v116, v112, v113, v114
    v_max_f32 v116, v116, v115
    v_mov_b32 v117, v116
    s_nop 1
    v_permlane32_swap_b32 v132, v133
    v_permlane32_swap_b32 v148, v149
    v_permlane32_swap_b32 v164, v165
    v_permlane32_swap_b32 v116, v117
    v_max_f32 v132, v132, v133
    v_max_f32 v148, v148, v149
    v_max_f32 v164, v164, v165
    v_max_f32 v116, v116, v117
    v_mov_b32 v133, v132
    v_mov_b32 v149, v148
    v_mov_b32 v165, v164
    v_mov_b32 v117, v116
    s_nop 1
    v_permlane16_swap_b32 v132, v133
    v_permlane16_swap_b32 v148, v149
    v_permlane16_swap_b32 v164, v165
    v_permlane16_swap_b32 v116, v117
    v_max_f32 v132, v132, v133
    v_max_f32 v148, v148, v149
    v_max_f32 v164, v164, v165
    v_max_f32 v116, v116, v117
    s_buffer_load_dwordx8 s[16:23], s[84:87], s44 glc
    v_sub_f32 v128, v128, v132
    v_sub_f32 v129, v129, v132
    v_sub_f32 v130, v130, v132
    v_sub_f32 v131, v131, v132
    v_exp_f32 v128, v128
    v_exp_f32 v129, v129
    v_exp_f32 v130, v130
    v_exp_f32 v131, v131
    s_nop 0
    v_cvt_pk_bf16_f32 v128, v128, 0
    v_cvt_pk_bf16_f32 v129, v129, 0
    v_cvt_pk_bf16_f32 v130, v130, 0
    v_cvt_pk_bf16_f32 v131, v131, 0
    v_lshlrev_b32 v128, v28, v128
    v_lshlrev_b32 v129, v28, v129
    v_lshlrev_b32 v130, v28, v130
    v_lshlrev_b32 v131, v28, v131
    s_nop 1
    v_mfma_f32_16x16x32_bf16 v[132:135], v[72:75], v[128:131], 0
    v_mfma_f32_16x16x32_bf16 v[120:123], v[54:57], v[128:131], 0
    v_mfma_f32_16x16x32_bf16 v[124:127], v[64:67], v[128:131], 0
    v_sub_f32 v144, v144, v148
    v_sub_f32 v145, v145, v148
    v_sub_f32 v146, v146, v148
    v_sub_f32 v147, v147, v148
    v_exp_f32 v144, v144
    v_exp_f32 v145, v145
    v_exp_f32 v146, v146
    v_exp_f32 v147, v147
    s_nop 0
    v_cvt_pk_bf16_f32 v144, v144, 0
    v_cvt_pk_bf16_f32 v145, v145, 0
    v_cvt_pk_bf16_f32 v146, v146, 0
    v_cvt_pk_bf16_f32 v147, v147, 0
    v_lshlrev_b32 v144, v28, v144
    v_lshlrev_b32 v145, v28, v145
    v_lshlrev_b32 v146, v28, v146
    v_lshlrev_b32 v147, v28, v147
    s_nop 1
    v_mfma_f32_16x16x32_bf16 v[148:151], v[72:75], v[144:147], 0
    v_mfma_f32_16x16x32_bf16 v[136:139], v[56:59], v[144:147], 0
    v_mfma_f32_16x16x32_bf16 v[140:143], v[66:69], v[144:147], 0
    v_sub_f32 v160, v160, v164
    v_sub_f32 v161, v161, v164
    v_sub_f32 v162, v162, v164
    v_sub_f32 v163, v163, v164
    v_exp_f32 v160, v160
    v_exp_f32 v161, v161
    v_exp_f32 v162, v162
    v_exp_f32 v163, v163
    s_nop 0
    v_cvt_pk_bf16_f32 v160, v160, 0
    v_cvt_pk_bf16_f32 v161, v161, 0
    v_cvt_pk_bf16_f32 v162, v162, 0
    v_cvt_pk_bf16_f32 v163, v163, 0
    v_lshlrev_b32 v160, v28, v160
    v_lshlrev_b32 v161, v28, v161
    v_lshlrev_b32 v162, v28, v162
    v_lshlrev_b32 v163, v28, v163
    s_nop 1
    v_mfma_f32_16x16x32_bf16 v[164:167], v[72:75], v[160:163], 0
    v_mfma_f32_16x16x32_bf16 v[152:155], v[58:61], v[160:163], 0
    v_mfma_f32_16x16x32_bf16 v[156:159], v[68:71], v[160:163], 0
    v_sub_f32 v112, v112, v116
    v_sub_f32 v113, v113, v116
    v_sub_f32 v114, v114, v116
    v_sub_f32 v115, v115, v116
    v_exp_f32 v112, v112
    v_exp_f32 v113, v113
    v_exp_f32 v114, v114
    v_exp_f32 v115, v115
    s_nop 0
    v_cvt_pk_bf16_f32 v112, v112, 0
    v_cvt_pk_bf16_f32 v113, v113, 0
    v_cvt_pk_bf16_f32 v114, v114, 0
    v_cvt_pk_bf16_f32 v115, v115, 0
    v_lshlrev_b32 v112, v28, v112
    v_lshlrev_b32 v113, v28, v113
    v_lshlrev_b32 v114, v28, v114
    v_lshlrev_b32 v115, v28, v115
    s_nop 1
    v_mfma_f32_16x16x32_bf16 v[116:119], v[72:75], v[112:115], 0
    v_mfma_f32_16x16x32_bf16 v[104:107], v[52:55], v[112:115], 0
    v_mfma_f32_16x16x32_bf16 v[108:111], v[62:65], v[112:115], 0
    s_cmp_lt_u32 s32, 2
    s_cbranch_scc1 L_epi_nob
    s_add_u32 m0, s36, 0
    s_nop 0
    buffer_load_dwordx4 v220, s[12:15], s28 offen offset:0 sc1 lds
    buffer_load_dwordx4 v221, s[12:15], s28 offen offset:1024 sc1 lds
    buffer_load_dwordx4 v222, s[12:15], s28 offen offset:2048 sc1 lds
    buffer_load_dwordx4 v223, s[12:15], s28 offen offset:3072 sc1 lds
    s_add_u32 m0, s36, 4096
    s_nop 0
    buffer_load_dwordx4 v224, s[12:15], s28 offen offset:0 sc1 lds
    buffer_load_dwordx4 v225, s[12:15], s28 offen offset:1024 sc1 lds
    buffer_load_dwordx4 v226, s[12:15], s28 offen offset:2048 sc1 lds
    buffer_load_dwordx4 v227, s[12:15], s28 offen offset:3072 sc1 lds
    s_add_u32 s28, s28, s29
    s_add_u32 m0, s36, 32768
    s_nop 0
    buffer_load_dwordx4 v220, s[12:15], s28 offen offset:0 sc1 lds
    buffer_load_dwordx4 v221, s[12:15], s28 offen offset:1024 sc1 lds
    buffer_load_dwordx4 v222, s[12:15], s28 offen offset:2048 sc1 lds
    buffer_load_dwordx4 v223, s[12:15], s28 offen offset:3072 sc1 lds
    s_add_u32 m0, s36, 36864
    s_nop 0
    buffer_load_dwordx4 v224, s[12:15], s28 offen offset:0 sc1 lds
    buffer_load_dwordx4 v225, s[12:15], s28 offen offset:1024 sc1 lds
    buffer_load_dwordx4 v226, s[12:15], s28 offen offset:2048 sc1 lds
    buffer_load_dwordx4 v227, s[12:15], s28 offen offset:3072 sc1 lds
    s_add_u32 s28, s28, s29
    s_add_u32 m0, s36, 65536
    s_nop 0
    buffer_load_dwordx4 v220, s[12:15], s28 offen offset:0 sc1 lds
    buffer_load_dwordx4 v221, s[12:15], s28 offen offset:1024 sc1 lds
    buffer_load_dwordx4 v222, s[12:15], s28 offen offset:2048 sc1 lds
    buffer_load_dwordx4 v223, s[12:15], s28 offen offset:3072 sc1 lds
    s_add_u32 m0, s36, 69632
    s_nop 0
    buffer_load_dwordx4 v224, s[12:15], s28 offen offset:0 sc1 lds
    buffer_load_dwordx4 v225, s[12:15], s28 offen offset:1024 sc1 lds
    buffer_load_dwordx4 v226, s[12:15], s28 offen offset:2048 sc1 lds
    buffer_load_dwordx4 v227, s[12:15], s28 offen offset:3072 sc1 lds
    s_add_u32 s28, s28, s29
    s_mov_b32 s35, 1
    s_branch L_epi_go
L_epi_nob:
    s_waitcnt lgkmcnt(0)
    s_xor_b32 s17, s17, s45
    s_xor_b32 s18, s18, s45
    s_xor_b32 s19, s19, s45
    s_xor_b32 s20, s20, s45
    s_xor_b32 s21, s21, s45
    s_xor_b32 s22, s22, s45
    s_xor_b32 s23, s23, s45
    s_xor_b32 s16, s16, s45
    s_or_b32 s16, s16, s17
    s_or_b32 s16, s16, s18
    s_or_b32 s16, s16, s19
    s_or_b32 s16, s16, s20
    s_or_b32 s16, s16, s21
    s_or_b32 s16, s16, s22
    s_or_b32 s16, s16, s23
    s_cmp_eq_u32 s16, 0
    s_cselect_b32 s35, 1, 0
    s_cbranch_scc0 L_epi_go
    s_add_u32 m0, s36, 0
    s_nop 0
    buffer_load_dwordx4 v220, s[8:11], s28 offen offset:0 sc1 lds
    buffer_load_dwordx4 v220, s[8:11], s28 offen offset:1024 sc1 lds
    buffer_load_dwordx4 v220, s[8:11], s28 offen offset:2048 sc1 lds
    buffer_load_dwordx4 v220, s[8:11], s28 offen offset:3072 sc1 lds
    s_add_u32 m0, s36, 4096
    s_nop 0
    buffer_load_dwordx4 v221, s[8:11], s28 offen offset:0 sc1 lds
    buffer_load_dwordx4 v221, s[8:11], s28 offen offset:1024 sc1 lds
    buffer_load_dwordx4 v221, s[8:11], s28 offen offset:2048 sc1 lds
    buffer_load_dwordx4 v221, s[8:11], s28 offen offset:3072 sc1 lds
    s_add_u32 s28, s28, s29
    s_add_u32 m0, s36, 32768
    s_nop 0
    buffer_load_dwordx4 v220, s[8:11], s28 offen offset:0 sc1 lds
    buffer_load_dwordx4 v220, s[8:11], s28 offen offset:1024 sc1 lds
    buffer_load_dwordx4 v220, s[8:11], s28 offen offset:2048 sc1 lds
    buffer_load_dwordx4 v220, s[8:11], s28 offen offset:3072 sc1 lds
    s_add_u32 m0, s36, 36864
    s_nop 0
    buffer_load_dwordx4 v221, s[8:11], s28 offen offset:0 sc1 lds
    buffer_load_dwordx4 v221, s[8:11], s28 offen offset:1024 sc1 lds
    buffer_load_dwordx4 v221, s[8:11], s28 offen offset:2048 sc1 lds
    buffer_load_dwordx4 v221, s[8:11], s28 offen offset:3072 sc1 lds
    s_add_u32 s28, s28, s29
    s_add_u32 m0, s36, 65536
    s_nop 0
    buffer_load_dwordx4 v220, s[8:11], s28 offen offset:0 sc1 lds
    buffer_load_dwordx4 v220, s[8:11], s28 offen offset:1024 sc1 lds
    buffer_load_dwordx4 v220, s[8:11], s28 offen offset:2048 sc1 lds
    buffer_load_dwordx4 v220, s[8:11], s28 offen offset:3072 sc1 lds
    s_add_u32 m0, s36, 69632
    s_nop 0
    buffer_load_dwordx4 v221, s[8:11], s28 offen offset:0 sc1 lds
    buffer_load_dwordx4 v221, s[8:11], s28 offen offset:1024 sc1 lds
    buffer_load_dwordx4 v221, s[8:11], s28 offen offset:2048 sc1 lds
    buffer_load_dwordx4 v221, s[8:11], s28 offen offset:3072 sc1 lds
    s_add_u32 s28, s28, s29
L_epi_go:
    v_rcp_f32 v132, v132
    s_nop 0
    v_mov_b32 v133, v132
    v_pk_mul_f32 v[120:121], v[120:121], v[132:133]
    v_pk_mul_f32 v[122:123], v[122:123], v[132:133]
    v_pk_mul_f32 v[124:125], v[124:125], v[132:133]
    v_pk_mul_f32 v[126:127], v[126:127], v[132:133]
    v_cvt_pk_bf16_f32 v128, v120, v121
    v_cvt_pk_bf16_f32 v129, v122, v123
    v_cvt_pk_bf16_f32 v130, v124, v125
    v_cvt_pk_bf16_f32 v131, v126, v127
    buffer_store_dwordx4 v[128:131], v194, s[24:27], s48 offen offset:1024 sc1
    v_rcp_f32 v148, v148
    s_nop 0
    v_mov_b32 v149, v148
    v_pk_mul_f32 v[136:137], v[136:137], v[148:149]
    v_pk_mul_f32 v[138:139], v[138:139], v[148:149]
    v_pk_mul_f32 v[140:141], v[140:141], v[148:149]
    v_pk_mul_f32 v[142:143], v[142:143], v[148:149]
    v_cvt_pk_bf16_f32 v144, v136, v137
    v_cvt_pk_bf16_f32 v145, v138, v139
    v_cvt_pk_bf16_f32 v146, v140, v141
    v_cvt_pk_bf16_f32 v147, v142, v143
    buffer_store_dwordx4 v[144:147], v194, s[24:27], s48 offen offset:2048 sc1
    v_rcp_f32 v164, v164
    s_nop 0
    v_mov_b32 v165, v164
    v_pk_mul_f32 v[152:153], v[152:153], v[164:165]
    v_pk_mul_f32 v[154:155], v[154:155], v[164:165]
    v_pk_mul_f32 v[156:157], v[156:157], v[164:165]
    v_pk_mul_f32 v[158:159], v[158:159], v[164:165]
    v_cvt_pk_bf16_f32 v160, v152, v153
    v_cvt_pk_bf16_f32 v161, v154, v155
    v_cvt_pk_bf16_f32 v162, v156, v157
    v_cvt_pk_bf16_f32 v163, v158, v159
    buffer_store_dwordx4 v[160:163], v194, s[24:27], s48 offen offset:3072 sc1
    v_rcp_f32 v116, v116
    s_nop 0
    v_mov_b32 v117, v116
    v_pk_mul_f32 v[104:105], v[104:105], v[116:117]
    v_pk_mul_f32 v[106:107], v[106:107], v[116:117]
    v_pk_mul_f32 v[108:109], v[108:109], v[116:117]
    v_pk_mul_f32 v[110:111], v[110:111], v[116:117]
    v_cvt_pk_bf16_f32 v112, v104, v105
    v_cvt_pk_bf16_f32 v113, v106, v107
    v_cvt_pk_bf16_f32 v114, v108, v109
    v_cvt_pk_bf16_f32 v115, v110, v111
    buffer_store_dwordx4 v[112:115], v194, s[24:27], s48 offen offset:0 sc1
    s_lshl_b32 s37, s2, 2
    s_add_u32 s37, s37, s32
    s_lshl_b32 s37, s37, 7
    s_nop 1
    v_mov_b64 v[4:5], 0
    v_mov_b64 v[6:7], 0
    v_mov_b64 v[8:9], 0
    v_mov_b64 v[10:11], 0
    v_mov_b64 v[12:13], 0
    v_mov_b64 v[14:15], 0
    v_mov_b64 v[16:17], 0
    v_mov_b64 v[18:19], 0
    v_mov_b64 v[20:21], 0
    v_mov_b64 v[22:23], 0
    v_mov_b64 v[24:25], 0
    v_mov_b64 v[26:27], 0
    v_mov_b64 v[28:29], 0
    v_mov_b64 v[30:31], 0
    v_mov_b64 v[32:33], 0
    v_mov_b64 v[34:35], 0
    v_mov_b64 v[36:37], 0
    v_mov_b64 v[38:39], 0
    v_mov_b64 v[40:41], 0
    v_mov_b64 v[42:43], 0
    v_mov_b64 v[44:45], 0
    v_mov_b64 v[46:47], 0
    v_mov_b64 v[48:49], 0
    v_mov_b64 v[50:51], 0
    v_mov_b64 v[64:65], 0
    v_mov_b64 v[66:67], 0
    v_mov_b64 v[68:69], 0
    v_mov_b64 v[70:71], 0
    v_mov_b64 v[72:73], 0
    v_mov_b64 v[74:75], 0
    v_mov_b64 v[76:77], 0
    v_mov_b64 v[78:79], 0
    v_mov_b64 v[80:81], 0
    v_mov_b64 v[82:83], 0
    v_mov_b64 v[84:85], 0
    v_mov_b64 v[86:87], 0
    v_mov_b64 v[88:89], 0
    v_mov_b64 v[90:91], 0
    v_mov_b64 v[92:93], 0
    v_mov_b64 v[94:95], 0
    v_mov_b64 v[96:97], 0
    v_mov_b64 v[98:99], 0
    v_mov_b64 v[100:101], 0
    v_mov_b64 v[102:103], 0
    v_mov_b64 v[104:105], 0
    v_mov_b64 v[106:107], 0
    v_mov_b64 v[108:109], 0
    v_mov_b64 v[110:111], 0
    v_mov_b64 v[116:117], 0
    v_mov_b64 v[118:119], 0
    v_mov_b64 v[120:121], 0
    v_mov_b64 v[122:123], 0
    v_mov_b64 v[124:125], 0
    v_mov_b64 v[126:127], 0
    v_mov_b64 v[132:133], 0
    v_mov_b64 v[134:135], 0
    v_mov_b64 v[136:137], 0
    v_mov_b64 v[138:139], 0
    v_mov_b64 v[140:141], 0
    v_mov_b64 v[142:143], 0
    s_cmp_eq_u32 s35, 1
    s_cbranch_scc1 L_fg2
    s_waitcnt vmcnt(4)
L_fg2:
    s_waitcnt vmcnt(28)
    v_mov_b32 v240, 0
    v_mov_b32 v241, s96
    s_mov_b64 exec, 1
    buffer_store_dword v241, v240, s[84:87], s53 offen sc1
    s_mov_b64 exec, -1
    s_add_u32 s53, s53, 0x1000
    s_lshl_b32 s47, s2, 2
    s_add_u32 s47, s47, s32
    s_cmp_lg_u32 s47, 3
    s_cbranch_scc1 L_noep
    v_lshlrev_b32 v244, 2, v1
    v_add_u32 v244, 32768, v244
    s_mov_b32 exec_lo, -1
    s_mov_b32 exec_hi, 0xffffffff
    s_mov_b32 s47, 0x20000
    buffer_load_dword v250, v244, s[84:87], 0 offen sc1
L_poll12:
    s_waitcnt vmcnt(0)
    v_cmp_ne_u32 vcc, s96, v250
    s_nop 4
    s_cbranch_vccz L_pollok12
    buffer_load_dword v250, v244, s[84:87], 0 offen sc1
    s_sub_u32 s47, s47, 1
    s_cmp_lg_u32 s47, 0
    s_cbranch_scc1 L_poll12
    s_branch L_end
L_pollok12:
    s_mov_b64 exec, -1
    v_lshlrev_b32 v244, 2, v1
    v_add_u32 v244, 33024, v244
    s_mov_b32 exec_lo, -1
    s_mov_b32 exec_hi, 0xffffffff
    s_mov_b32 s47, 0x20000
    buffer_load_dword v250, v244, s[84:87], 0 offen sc1
L_poll13:
    s_waitcnt vmcnt(0)
    v_cmp_ne_u32 vcc, s96, v250
    s_nop 4
    s_cbranch_vccz L_pollok13
    buffer_load_dword v250, v244, s[84:87], 0 offen sc1
    s_sub_u32 s47, s47, 1
    s_cmp_lg_u32 s47, 0
    s_cbranch_scc1 L_poll13
    s_branch L_end
L_pollok13:
    s_mov_b64 exec, -1
    v_lshlrev_b32 v244, 2, v1
    v_add_u32 v244, 33280, v244
    s_mov_b32 exec_lo, -1
    s_mov_b32 exec_hi, 0xffffffff
    s_mov_b32 s47, 0x20000
    buffer_load_dword v250, v244, s[84:87], 0 offen sc1
L_poll14:
    s_waitcnt vmcnt(0)
    v_cmp_ne_u32 vcc, s96, v250
    s_nop 4
    s_cbranch_vccz L_pollok14
    buffer_load_dword v250, v244, s[84:87], 0 offen sc1
    s_sub_u32 s47, s47, 1
    s_cmp_lg_u32 s47, 0
    s_cbranch_scc1 L_poll14
    s_branch L_end
L_pollok14:
    s_mov_b64 exec, -1
    v_lshlrev_b32 v244, 2, v1
    v_add_u32 v244, 33536, v244
    s_mov_b32 exec_lo, -1
    s_mov_b32 exec_hi, 0xffffffff
    s_mov_b32 s47, 0x20000
    buffer_load_dword v250, v244, s[84:87], 0 offen sc1
L_poll15:
    s_waitcnt vmcnt(0)
    v_cmp_ne_u32 vcc, s96, v250
    s_nop 4
    s_cbranch_vccz L_pollok15
    buffer_load_dword v250, v244, s[84:87], 0 offen sc1
    s_sub_u32 s47, s47, 1
    s_cmp_lg_u32 s47, 0
    s_cbranch_scc1 L_poll15
    s_branch L_end
L_pollok15:
    s_mov_b64 exec, -1
    s_mov_b32 s47, 196608
    v_mov_b32 v240, 0
    v_mov_b32 v241, s96
    s_mov_b64 exec, 1
    buffer_store_dword v241, v240, s[84:87], s47 offen sc1
    s_mov_b64 exec, -1
L_noep:
    s_cmp_eq_u32 s35, 1
    s_cbranch_scc1 L_g2_early
    v_lshl_add_u32 v244, v1, 2, s44
    s_mov_b64 exec, 0xff
    s_mov_b32 s47, 0x20000
    buffer_load_dword v250, v244, s[84:87], 0 offen sc1
L_poll16:
    s_waitcnt vmcnt(0)
    v_cmp_ne_u32 vcc, s45, v250
    s_nop 4
    s_cbranch_vccz L_pollok16
    buffer_load_dword v250, v244, s[84:87], 0 offen sc1
    s_sub_u32 s47, s47, 1
    s_cmp_lg_u32 s47, 0
    s_cbranch_scc1 L_poll16
    s_branch L_end
L_pollok16:
    s_mov_b64 exec, -1
    s_add_u32 m0, s36, 0
    s_nop 0
    buffer_load_dwordx4 v220, s[8:11], s28 offen offset:0 sc1 lds
    buffer_load_dwordx4 v220, s[8:11], s28 offen offset:1024 sc1 lds
    buffer_load_dwordx4 v220, s[8:11], s28 offen offset:2048 sc1 lds
    buffer_load_dwordx4 v220, s[8:11], s28 offen offset:3072 sc1 lds
    s_add_u32 m0, s36, 4096
    s_nop 0
    buffer_load_dwordx4 v221, s[8:11], s28 offen offset:0 sc1 lds
    buffer_load_dwordx4 v221, s[8:11], s28 offen offset:1024 sc1 lds
    buffer_load_dwordx4 v221, s[8:11], s28 offen offset:2048 sc1 lds
    buffer_load_dwordx4 v221, s[8:11], s28 offen offset:3072 sc1 lds
    s_add_u32 s28, s28, s29
    s_add_u32 m0, s36, 32768
    s_nop 0
    buffer_load_dwordx4 v220, s[8:11], s28 offen offset:0 sc1 lds
    buffer_load_dwordx4 v220, s[8:11], s28 offen offset:1024 sc1 lds
    buffer_load_dwordx4 v220, s[8:11], s28 offen offset:2048 sc1 lds
    buffer_load_dwordx4 v220, s[8:11], s28 offen offset:3072 sc1 lds
    s_add_u32 m0, s36, 36864
    s_nop 0
    buffer_load_dwordx4 v221, s[8:11], s28 offen offset:0 sc1 lds
    buffer_load_dwordx4 v221, s[8:11], s28 offen offset:1024 sc1 lds
    buffer_load_dwordx4 v221, s[8:11], s28 offen offset:2048 sc1 lds
    buffer_load_dwordx4 v221, s[8:11], s28 offen offset:3072 sc1 lds
    s_add_u32 s28, s28, s29
    s_add_u32 m0, s36, 65536
    s_nop 0
    buffer_load_dwordx4 v220, s[8:11], s28 offen offset:0 sc1 lds
    buffer_load_dwordx4 v220, s[8:11], s28 offen offset:1024 sc1 lds
    buffer_load_dwordx4 v220, s[8:11], s28 offen offset:2048 sc1 lds
    buffer_load_dwordx4 v220, s[8:11], s28 offen offset:3072 sc1 lds
    s_add_u32 m0, s36, 69632
    s_nop 0
    buffer_load_dwordx4 v221, s[8:11], s28 offen offset:0 sc1 lds
    buffer_load_dwordx4 v221, s[8:11], s28 offen offset:1024 sc1 lds
    buffer_load_dwordx4 v221, s[8:11], s28 offen offset:2048 sc1 lds
    buffer_load_dwordx4 v221, s[8:11], s28 offen offset:3072 sc1 lds
    s_add_u32 s28, s28, s29
    s_waitcnt vmcnt(16)
L_g2_early:
    s_waitcnt vmcnt(21)
    v_mov_b64 v[112:113], 0
    v_mov_b64 v[114:115], 0
    v_mov_b64 v[128:129], 0
    v_mov_b64 v[130:131], 0
    s_barrier
    s_cmp_ge_u32 s32, 2
    s_cbranch_scc1 L_g2_loop2
    .p2align 6
L_g2_loop0:
    s_cmp_eq_u32 s31, s55
    s_cselect_b32 s3, 1, 0
    s_cmp_eq_u32 s31, s40
    s_cselect_b32 s3, 1, s3
    s_cmp_eq_u32 s3, 0
    s_cbranch_scc1 L_g2_c1
    buffer_load_dword v244, v245, s[84:87], 0 offen sc1
L_g2_c1:
    ds_read_b128 v[4:7], v228 offset:0
    v_mfma_f32_16x16x32_bf16 v[64:67], v[128:131], v[20:23], v[64:67]
    ds_read_b64_tr_b16 v[36:37], v232 offset:0
    s_add_u32 m0, s36, 98304
    v_mfma_f32_16x16x32_bf16 v[80:83], v[128:131], v[24:27], v[80:83]
    ds_read_b64_tr_b16 v[38:39], v232 offset:4096
    buffer_load_dwordx4 v220, s[8:11], s28 offen offset:0 sc1 lds
    v_mfma_f32_16x16x32_bf16 v[96:99], v[128:131], v[28:31], v[96:99]
    ds_read_b128 v[8:11], v228 offset:1024
    v_mfma_f32_16x16x32_bf16 v[112:115], v[128:131], v[32:35], v[112:115]
    ds_read_b128 v[12:15], v230 offset:0
    v_mfma_f32_16x16x32_bf16 v[68:71], v[132:135], v[20:23], v[68:71]
    ds_read_b128 v[16:19], v230 offset:1024
    buffer_load_dwordx4 v220, s[8:11], s28 offen offset:1024 sc1 lds
    v_mfma_f32_16x16x32_bf16 v[84:87], v[132:135], v[24:27], v[84:87]
    ds_read_b64_tr_b16 v[40:41], v234 offset:0
    v_mfma_f32_16x16x32_bf16 v[100:103], v[132:135], v[28:31], v[100:103]
    ds_read_b64_tr_b16 v[42:43], v234 offset:4096
    v_mfma_f32_16x16x32_bf16 v[116:119], v[132:135], v[32:35], v[116:119]
    ds_read_b64_tr_b16 v[44:45], v236 offset:0
    v_mfma_f32_16x16x32_bf16 v[72:75], v[136:139], v[20:23], v[72:75]
    ds_read_b64_tr_b16 v[46:47], v236 offset:4096
    buffer_load_dwordx4 v220, s[8:11], s28 offen offset:2048 sc1 lds
    v_mfma_f32_16x16x32_bf16 v[88:91], v[136:139], v[24:27], v[88:91]
    ds_read_b64_tr_b16 v[48:49], v238 offset:0
    v_mfma_f32_16x16x32_bf16 v[104:107], v[136:139], v[28:31], v[104:107]
    ds_read_b64_tr_b16 v[50:51], v238 offset:4096
    v_mfma_f32_16x16x32_bf16 v[120:123], v[136:139], v[32:35], v[120:123]
    buffer_load_dwordx4 v220, s[8:11], s28 offen offset:3072 sc1 lds
    v_mfma_f32_16x16x32_bf16 v[76:79], v[140:143], v[20:23], v[76:79]
    v_mfma_f32_16x16x32_bf16 v[92:95], v[140:143], v[24:27], v[92:95]
    v_mfma_f32_16x16x32_bf16 v[108:111], v[140:143], v[28:31], v[108:111]
    s_add_u32 m0, s36, 102400
    v_mfma_f32_16x16x32_bf16 v[124:127], v[140:143], v[32:35], v[124:127]
    ds_read_b128 v[20:23], v228 offset:8192
    buffer_load_dwordx4 v221, s[8:11], s28 offen offset:0 sc1 lds
    s_waitcnt lgkmcnt(10)
    v_mfma_f32_16x16x32_bf16 v[64:67], v[36:39], v[4:7], v[64:67]
    ds_read_b64_tr_b16 v[128:129], v232 offset:8192
    s_waitcnt lgkmcnt(10)
    v_mfma_f32_16x16x32_bf16 v[80:83], v[36:39], v[8:11], v[80:83]
    ds_read_b64_tr_b16 v[130:131], v232 offset:12288
    s_waitcnt lgkmcnt(10)
    v_mfma_f32_16x16x32_bf16 v[96:99], v[36:39], v[12:15], v[96:99]
    ds_read_b128 v[24:27], v228 offset:9216
    buffer_load_dwordx4 v221, s[8:11], s28 offen offset:1024 sc1 lds
    s_waitcnt lgkmcnt(10)
    v_mfma_f32_16x16x32_bf16 v[112:115], v[36:39], v[16:19], v[112:115]
    ds_read_b128 v[28:31], v230 offset:8192
    s_waitcnt lgkmcnt(9)
    v_mfma_f32_16x16x32_bf16 v[68:71], v[40:43], v[4:7], v[68:71]
    ds_read_b128 v[32:35], v230 offset:9216
    v_mfma_f32_16x16x32_bf16 v[84:87], v[40:43], v[8:11], v[84:87]
    ds_read_b64_tr_b16 v[132:133], v234 offset:8192
    v_mfma_f32_16x16x32_bf16 v[100:103], v[40:43], v[12:15], v[100:103]
    ds_read_b64_tr_b16 v[134:135], v234 offset:12288
    buffer_load_dwordx4 v221, s[8:11], s28 offen offset:2048 sc1 lds
    v_mfma_f32_16x16x32_bf16 v[116:119], v[40:43], v[16:19], v[116:119]
    ds_read_b64_tr_b16 v[136:137], v236 offset:8192
    s_waitcnt lgkmcnt(11)
    v_mfma_f32_16x16x32_bf16 v[72:75], v[44:47], v[4:7], v[72:75]
    ds_read_b64_tr_b16 v[138:139], v236 offset:12288
    v_mfma_f32_16x16x32_bf16 v[88:91], v[44:47], v[8:11], v[88:91]
    ds_read_b64_tr_b16 v[140:141], v238 offset:8192
    buffer_load_dwordx4 v221, s[8:11], s28 offen offset:3072 sc1 lds
    v_mfma_f32_16x16x32_bf16 v[104:107], v[44:47], v[12:15], v[104:107]
    ds_read_b64_tr_b16 v[142:143], v238 offset:12288
    v_mfma_f32_16x16x32_bf16 v[120:123], v[44:47], v[16:19], v[120:123]
    s_waitcnt lgkmcnt(12)
    v_mfma_f32_16x16x32_bf16 v[76:79], v[48:51], v[4:7], v[76:79]
    v_mfma_f32_16x16x32_bf16 v[92:95], v[48:51], v[8:11], v[92:95]
    v_mfma_f32_16x16x32_bf16 v[108:111], v[48:51], v[12:15], v[108:111]
    v_mfma_f32_16x16x32_bf16 v[124:127], v[48:51], v[16:19], v[124:127]
    s_add_u32 s28, s28, s29
    s_waitcnt vmcnt(16) lgkmcnt(0)
    s_barrier
    s_cmp_eq_u32 s31, 1
    s_cbranch_scc1 L_g2_fin
    s_cmp_eq_u32 s3, 0
    s_cbranch_scc1 L_g2_c2
    s_waitcnt vmcnt(8)
    v_cmp_ne_u32 vcc, s96, v244
    s_nop 4
    s_cbranch_vccz L_g2_c2b
    s_mov_b32 exec_lo, -1
    s_mov_b32 exec_hi, 0xffffffff
    s_mov_b32 s47, 0x20000
    buffer_load_dword v250, v245, s[84:87], 0 offen sc1
L_poll17:
    s_waitcnt vmcnt(0)
    v_cmp_ne_u32 vcc, s96, v250
    s_nop 4
    s_cbranch_vccz L_pollok17
    buffer_load_dword v250, v245, s[84:87], 0 offen sc1
    s_sub_u32 s47, s47, 1
    s_cmp_lg_u32 s47, 0
    s_cbranch_scc1 L_poll17
    s_branch L_end
L_pollok17:
    s_mov_b64 exec, -1
L_g2_c2b:
    v_add_u32 v245, 0x1000, v245
L_g2_c2:
    ds_read_b128 v[4:7], v228 offset:32768
    s_cmp_eq_u32 s31, s55
    s_cselect_b32 s28, s30, s28
    s_cmp_eq_u32 s31, s40
    s_cselect_b32 s28, s38, s28
    s_cselect_b32 s29, s54, s29
    v_mfma_f32_16x16x32_bf16 v[64:67], v[128:131], v[20:23], v[64:67]
    ds_read_b64_tr_b16 v[36:37], v232 offset:32768
    s_add_u32 m0, s36, 0
    v_mfma_f32_16x16x32_bf16 v[80:83], v[128:131], v[24:27], v[80:83]
    ds_read_b64_tr_b16 v[38:39], v232 offset:36864
    buffer_load_dwordx4 v220, s[8:11], s28 offen offset:0 sc1 lds
    v_mfma_f32_16x16x32_bf16 v[96:99], v[128:131], v[28:31], v[96:99]
    ds_read_b128 v[8:11], v228 offset:33792
    v_mfma_f32_16x16x32_bf16 v[112:115], v[128:131], v[32:35], v[112:115]
    ds_read_b128 v[12:15], v230 offset:32768
    v_mfma_f32_16x16x32_bf16 v[68:71], v[132:135], v[20:23], v[68:71]
    ds_read_b128 v[16:19], v230 offset:33792
    buffer_load_dwordx4 v220, s[8:11], s28 offen offset:1024 sc1 lds
    v_mfma_f32_16x16x32_bf16 v[84:87], v[132:135], v[24:27], v[84:87]
    ds_read_b64_tr_b16 v[40:41], v234 offset:32768
    v_mfma_f32_16x16x32_bf16 v[100:103], v[132:135], v[28:31], v[100:103]
    ds_read_b64_tr_b16 v[42:43], v234 offset:36864
    v_mfma_f32_16x16x32_bf16 v[116:119], v[132:135], v[32:35], v[116:119]
    ds_read_b64_tr_b16 v[44:45], v236 offset:32768
    v_mfma_f32_16x16x32_bf16 v[72:75], v[136:139], v[20:23], v[72:75]
    ds_read_b64_tr_b16 v[46:47], v236 offset:36864
    buffer_load_dwordx4 v220, s[8:11], s28 offen offset:2048 sc1 lds
    v_mfma_f32_16x16x32_bf16 v[88:91], v[136:139], v[24:27], v[88:91]
    ds_read_b64_tr_b16 v[48:49], v238 offset:32768
    v_mfma_f32_16x16x32_bf16 v[104:107], v[136:139], v[28:31], v[104:107]
    ds_read_b64_tr_b16 v[50:51], v238 offset:36864
    v_mfma_f32_16x16x32_bf16 v[120:123], v[136:139], v[32:35], v[120:123]
    buffer_load_dwordx4 v220, s[8:11], s28 offen offset:3072 sc1 lds
    v_mfma_f32_16x16x32_bf16 v[76:79], v[140:143], v[20:23], v[76:79]
    v_mfma_f32_16x16x32_bf16 v[92:95], v[140:143], v[24:27], v[92:95]
    v_mfma_f32_16x16x32_bf16 v[108:111], v[140:143], v[28:31], v[108:111]
    s_add_u32 m0, s36, 4096
    v_mfma_f32_16x16x32_bf16 v[124:127], v[140:143], v[32:35], v[124:127]
    ds_read_b128 v[20:23], v228 offset:40960
    buffer_load_dwordx4 v221, s[8:11], s28 offen offset:0 sc1 lds
    s_waitcnt lgkmcnt(10)
    v_mfma_f32_16x16x32_bf16 v[64:67], v[36:39], v[4:7], v[64:67]
    ds_read_b64_tr_b16 v[128:129], v232 offset:40960
    s_waitcnt lgkmcnt(10)
    v_mfma_f32_16x16x32_bf16 v[80:83], v[36:39], v[8:11], v[80:83]
    ds_read_b64_tr_b16 v[130:131], v232 offset:45056
    s_waitcnt lgkmcnt(10)
    v_mfma_f32_16x16x32_bf16 v[96:99], v[36:39], v[12:15], v[96:99]
    ds_read_b128 v[24:27], v228 offset:41984
    buffer_load_dwordx4 v221, s[8:11], s28 offen offset:1024 sc1 lds
    s_waitcnt lgkmcnt(10)
    v_mfma_f32_16x16x32_bf16 v[112:115], v[36:39], v[16:19], v[112:115]
    ds_read_b128 v[28:31], v230 offset:40960
    s_waitcnt lgkmcnt(9)
    v_mfma_f32_16x16x32_bf16 v[68:71], v[40:43], v[4:7], v[68:71]
    ds_read_b128 v[32:35], v230 offset:41984
    v_mfma_f32_16x16x32_bf16 v[84:87], v[40:43], v[8:11], v[84:87]
    ds_read_b64_tr_b16 v[132:133], v234 offset:40960
    v_mfma_f32_16x16x32_bf16 v[100:103], v[40:43], v[12:15], v[100:103]
    ds_read_b64_tr_b16 v[134:135], v234 offset:45056
    buffer_load_dwordx4 v221, s[8:11], s28 offen offset:2048 sc1 lds
    v_mfma_f32_16x16x32_bf16 v[116:119], v[40:43], v[16:19], v[116:119]
    ds_read_b64_tr_b16 v[136:137], v236 offset:40960
    s_waitcnt lgkmcnt(11)
    v_mfma_f32_16x16x32_bf16 v[72:75], v[44:47], v[4:7], v[72:75]
    ds_read_b64_tr_b16 v[138:139], v236 offset:45056
    v_mfma_f32_16x16x32_bf16 v[88:91], v[44:47], v[8:11], v[88:91]
    ds_read_b64_tr_b16 v[140:141], v238 offset:40960
    buffer_load_dwordx4 v221, s[8:11], s28 offen offset:3072 sc1 lds
    v_mfma_f32_16x16x32_bf16 v[104:107], v[44:47], v[12:15], v[104:107]
    ds_read_b64_tr_b16 v[142:143], v238 offset:45056
    v_mfma_f32_16x16x32_bf16 v[120:123], v[44:47], v[16:19], v[120:123]
    s_waitcnt lgkmcnt(12)
    v_mfma_f32_16x16x32_bf16 v[76:79], v[48:51], v[4:7], v[76:79]
    v_mfma_f32_16x16x32_bf16 v[92:95], v[48:51], v[8:11], v[92:95]
    v_mfma_f32_16x16x32_bf16 v[108:111], v[48:51], v[12:15], v[108:111]
    v_mfma_f32_16x16x32_bf16 v[124:127], v[48:51], v[16:19], v[124:127]
    s_add_u32 s28, s28, s29
    s_waitcnt vmcnt(16) lgkmcnt(0)
    s_barrier
    s_add_u32 s47, s55, 1
    s_cmp_lg_u32 s31, s47
    s_cbranch_scc1 L_g2_c3_0
    v_mov_b32 v240, 0
    v_mov_b32 v241, s96
    s_mov_b64 exec, 1
    buffer_store_dword v241, v240, s[84:87], s53 offen sc1
    s_mov_b64 exec, -1
L_g2_c3_0:
    ds_read_b128 v[4:7], v229 offset:0
    v_mfma_f32_16x16x32_bf16 v[64:67], v[128:131], v[20:23], v[64:67]
    ds_read_b64_tr_b16 v[36:37], v233 offset:0
    s_add_u32 m0, s36, 32768
    v_mfma_f32_16x16x32_bf16 v[80:83], v[128:131], v[24:27], v[80:83]
    ds_read_b64_tr_b16 v[38:39], v233 offset:4096
    buffer_load_dwordx4 v220, s[8:11], s28 offen offset:0 sc1 lds
    v_mfma_f32_16x16x32_bf16 v[96:99], v[128:131], v[28:31], v[96:99]
    ds_read_b128 v[8:11], v229 offset:1024
    v_mfma_f32_16x16x32_bf16 v[112:115], v[128:131], v[32:35], v[112:115]
    ds_read_b128 v[12:15], v231 offset:0
    v_mfma_f32_16x16x32_bf16 v[68:71], v[132:135], v[20:23], v[68:71]
    ds_read_b128 v[16:19], v231 offset:1024
    buffer_load_dwordx4 v220, s[8:11], s28 offen offset:1024 sc1 lds
    v_mfma_f32_16x16x32_bf16 v[84:87], v[132:135], v[24:27], v[84:87]
    ds_read_b64_tr_b16 v[40:41], v235 offset:0
    v_mfma_f32_16x16x32_bf16 v[100:103], v[132:135], v[28:31], v[100:103]
    ds_read_b64_tr_b16 v[42:43], v235 offset:4096
    v_mfma_f32_16x16x32_bf16 v[116:119], v[132:135], v[32:35], v[116:119]
    ds_read_b64_tr_b16 v[44:45], v237 offset:0
    v_mfma_f32_16x16x32_bf16 v[72:75], v[136:139], v[20:23], v[72:75]
    ds_read_b64_tr_b16 v[46:47], v237 offset:4096
    buffer_load_dwordx4 v220, s[8:11], s28 offen offset:2048 sc1 lds
    v_mfma_f32_16x16x32_bf16 v[88:91], v[136:139], v[24:27], v[88:91]
    ds_read_b64_tr_b16 v[48:49], v239 offset:0
    v_mfma_f32_16x16x32_bf16 v[104:107], v[136:139], v[28:31], v[104:107]
    ds_read_b64_tr_b16 v[50:51], v239 offset:4096
    v_mfma_f32_16x16x32_bf16 v[120:123], v[136:139], v[32:35], v[120:123]
    buffer_load_dwordx4 v220, s[8:11], s28 offen offset:3072 sc1 lds
    v_mfma_f32_16x16x32_bf16 v[76:79], v[140:143], v[20:23], v[76:79]
    v_mfma_f32_16x16x32_bf16 v[92:95], v[140:143], v[24:27], v[92:95]
    v_mfma_f32_16x16x32_bf16 v[108:111], v[140:143], v[28:31], v[108:111]
    s_add_u32 m0, s36, 36864
    v_mfma_f32_16x16x32_bf16 v[124:127], v[140:143], v[32:35], v[124:127]
    ds_read_b128 v[20:23], v229 offset:8192
    buffer_load_dwordx4 v221, s[8:11], s28 offen offset:0 sc1 lds
    s_waitcnt lgkmcnt(10)
    v_mfma_f32_16x16x32_bf16 v[64:67], v[36:39], v[4:7], v[64:67]
    ds_read_b64_tr_b16 v[128:129], v233 offset:8192
    s_waitcnt lgkmcnt(10)
    v_mfma_f32_16x16x32_bf16 v[80:83], v[36:39], v[8:11], v[80:83]
    ds_read_b64_tr_b16 v[130:131], v233 offset:12288
    s_waitcnt lgkmcnt(10)
    v_mfma_f32_16x16x32_bf16 v[96:99], v[36:39], v[12:15], v[96:99]
    ds_read_b128 v[24:27], v229 offset:9216
    buffer_load_dwordx4 v221, s[8:11], s28 offen offset:1024 sc1 lds
    s_waitcnt lgkmcnt(10)
    v_mfma_f32_16x16x32_bf16 v[112:115], v[36:39], v[16:19], v[112:115]
    ds_read_b128 v[28:31], v231 offset:8192
    s_waitcnt lgkmcnt(9)
    v_mfma_f32_16x16x32_bf16 v[68:71], v[40:43], v[4:7], v[68:71]
    ds_read_b128 v[32:35], v231 offset:9216
    v_mfma_f32_16x16x32_bf16 v[84:87], v[40:43], v[8:11], v[84:87]
    ds_read_b64_tr_b16 v[132:133], v235 offset:8192
    v_mfma_f32_16x16x32_bf16 v[100:103], v[40:43], v[12:15], v[100:103]
    ds_read_b64_tr_b16 v[134:135], v235 offset:12288
    buffer_load_dwordx4 v221, s[8:11], s28 offen offset:2048 sc1 lds
    v_mfma_f32_16x16x32_bf16 v[116:119], v[40:43], v[16:19], v[116:119]
    ds_read_b64_tr_b16 v[136:137], v237 offset:8192
    s_waitcnt lgkmcnt(11)
    v_mfma_f32_16x16x32_bf16 v[72:75], v[44:47], v[4:7], v[72:75]
    ds_read_b64_tr_b16 v[138:139], v237 offset:12288
    v_mfma_f32_16x16x32_bf16 v[88:91], v[44:47], v[8:11], v[88:91]
    ds_read_b64_tr_b16 v[140:141], v239 offset:8192
    buffer_load_dwordx4 v221, s[8:11], s28 offen offset:3072 sc1 lds
    v_mfma_f32_16x16x32_bf16 v[104:107], v[44:47], v[12:15], v[104:107]
    ds_read_b64_tr_b16 v[142:143], v239 offset:12288
    v_mfma_f32_16x16x32_bf16 v[120:123], v[44:47], v[16:19], v[120:123]
    s_waitcnt lgkmcnt(12)
    v_mfma_f32_16x16x32_bf16 v[76:79], v[48:51], v[4:7], v[76:79]
    v_mfma_f32_16x16x32_bf16 v[92:95], v[48:51], v[8:11], v[92:95]
    v_mfma_f32_16x16x32_bf16 v[108:111], v[48:51], v[12:15], v[108:111]
    v_mfma_f32_16x16x32_bf16 v[124:127], v[48:51], v[16:19], v[124:127]
    s_add_u32 s28, s28, s29
    s_waitcnt vmcnt(16) lgkmcnt(0)
    s_barrier
    ds_read_b128 v[4:7], v229 offset:32768
    v_mfma_f32_16x16x32_bf16 v[64:67], v[128:131], v[20:23], v[64:67]
    ds_read_b64_tr_b16 v[36:37], v233 offset:32768
    s_add_u32 m0, s36, 65536
    v_mfma_f32_16x16x32_bf16 v[80:83], v[128:131], v[24:27], v[80:83]
    ds_read_b64_tr_b16 v[38:39], v233 offset:36864
    buffer_load_dwordx4 v220, s[8:11], s28 offen offset:0 sc1 lds
    v_mfma_f32_16x16x32_bf16 v[96:99], v[128:131], v[28:31], v[96:99]
    ds_read_b128 v[8:11], v229 offset:33792
    v_mfma_f32_16x16x32_bf16 v[112:115], v[128:131], v[32:35], v[112:115]
    ds_read_b128 v[12:15], v231 offset:32768
    v_mfma_f32_16x16x32_bf16 v[68:71], v[132:135], v[20:23], v[68:71]
    ds_read_b128 v[16:19], v231 offset:33792
    buffer_load_dwordx4 v220, s[8:11], s28 offen offset:1024 sc1 lds
    v_mfma_f32_16x16x32_bf16 v[84:87], v[132:135], v[24:27], v[84:87]
    ds_read_b64_tr_b16 v[40:41], v235 offset:32768
    v_mfma_f32_16x16x32_bf16 v[100:103], v[132:135], v[28:31], v[100:103]
    ds_read_b64_tr_b16 v[42:43], v235 offset:36864
    v_mfma_f32_16x16x32_bf16 v[116:119], v[132:135], v[32:35], v[116:119]
    ds_read_b64_tr_b16 v[44:45], v237 offset:32768
    v_mfma_f32_16x16x32_bf16 v[72:75], v[136:139], v[20:23], v[72:75]
    ds_read_b64_tr_b16 v[46:47], v237 offset:36864
    buffer_load_dwordx4 v220, s[8:11], s28 offen offset:2048 sc1 lds
    v_mfma_f32_16x16x32_bf16 v[88:91], v[136:139], v[24:27], v[88:91]
    ds_read_b64_tr_b16 v[48:49], v239 offset:32768
    v_mfma_f32_16x16x32_bf16 v[104:107], v[136:139], v[28:31], v[104:107]
    ds_read_b64_tr_b16 v[50:51], v239 offset:36864
    v_mfma_f32_16x16x32_bf16 v[120:123], v[136:139], v[32:35], v[120:123]
    buffer_load_dwordx4 v220, s[8:11], s28 offen offset:3072 sc1 lds
    v_mfma_f32_16x16x32_bf16 v[76:79], v[140:143], v[20:23], v[76:79]
    v_mfma_f32_16x16x32_bf16 v[92:95], v[140:143], v[24:27], v[92:95]
    v_mfma_f32_16x16x32_bf16 v[108:111], v[140:143], v[28:31], v[108:111]
    s_add_u32 m0, s36, 69632
    v_mfma_f32_16x16x32_bf16 v[124:127], v[140:143], v[32:35], v[124:127]
    ds_read_b128 v[20:23], v229 offset:40960
    buffer_load_dwordx4 v221, s[8:11], s28 offen offset:0 sc1 lds
    s_waitcnt lgkmcnt(10)
    v_mfma_f32_16x16x32_bf16 v[64:67], v[36:39], v[4:7], v[64:67]
    ds_read_b64_tr_b16 v[128:129], v233 offset:40960
    s_waitcnt lgkmcnt(10)
    v_mfma_f32_16x16x32_bf16 v[80:83], v[36:39], v[8:11], v[80:83]
    ds_read_b64_tr_b16 v[130:131], v233 offset:45056
    s_waitcnt lgkmcnt(10)
    v_mfma_f32_16x16x32_bf16 v[96:99], v[36:39], v[12:15], v[96:99]
    ds_read_b128 v[24:27], v229 offset:41984
    buffer_load_dwordx4 v221, s[8:11], s28 offen offset:1024 sc1 lds
    s_waitcnt lgkmcnt(10)
    v_mfma_f32_16x16x32_bf16 v[112:115], v[36:39], v[16:19], v[112:115]
    ds_read_b128 v[28:31], v231 offset:40960
    s_waitcnt lgkmcnt(9)
    v_mfma_f32_16x16x32_bf16 v[68:71], v[40:43], v[4:7], v[68:71]
    ds_read_b128 v[32:35], v231 offset:41984
    v_mfma_f32_16x16x32_bf16 v[84:87], v[40:43], v[8:11], v[84:87]
    ds_read_b64_tr_b16 v[132:133], v235 offset:40960
    v_mfma_f32_16x16x32_bf16 v[100:103], v[40:43], v[12:15], v[100:103]
    ds_read_b64_tr_b16 v[134:135], v235 offset:45056
    buffer_load_dwordx4 v221, s[8:11], s28 offen offset:2048 sc1 lds
    v_mfma_f32_16x16x32_bf16 v[116:119], v[40:43], v[16:19], v[116:119]
    ds_read_b64_tr_b16 v[136:137], v237 offset:40960
    s_waitcnt lgkmcnt(11)
    v_mfma_f32_16x16x32_bf16 v[72:75], v[44:47], v[4:7], v[72:75]
    ds_read_b64_tr_b16 v[138:139], v237 offset:45056
    v_mfma_f32_16x16x32_bf16 v[88:91], v[44:47], v[8:11], v[88:91]
    ds_read_b64_tr_b16 v[140:141], v239 offset:40960
    buffer_load_dwordx4 v221, s[8:11], s28 offen offset:3072 sc1 lds
    v_mfma_f32_16x16x32_bf16 v[104:107], v[44:47], v[12:15], v[104:107]
    ds_read_b64_tr_b16 v[142:143], v239 offset:45056
    v_mfma_f32_16x16x32_bf16 v[120:123], v[44:47], v[16:19], v[120:123]
    s_waitcnt lgkmcnt(12)
    v_mfma_f32_16x16x32_bf16 v[76:79], v[48:51], v[4:7], v[76:79]
    v_mfma_f32_16x16x32_bf16 v[92:95], v[48:51], v[8:11], v[92:95]
    v_mfma_f32_16x16x32_bf16 v[108:111], v[48:51], v[12:15], v[108:111]
    v_mfma_f32_16x16x32_bf16 v[124:127], v[48:51], v[16:19], v[124:127]
    s_add_u32 s28, s28, s29
    s_waitcnt vmcnt(16) lgkmcnt(0)
    s_barrier
    s_sub_u32 s31, s31, 1
    s_branch L_g2_loop0
    .p2align 6
L_g2_loop2:
    s_cmp_lg_u32 s32, 2
    s_cbranch_scc1 L_g2_nopfb
    s_add_u32 s47, s40, 1
    s_cmp_lg_u32 s31, s47
    s_cbranch_scc1 L_g2_pf1
    v_mov_b32 v247, v246
    s_sub_u32 s92, s98, s63
    s_mov_b32 s93, s39
    s_add_u32 s94, s99, s63
    s_mov_b32 s59, s97
    s_mov_b32 s46, s58
L_g2_pf1:
    buffer_load_dword v248, v247, s[92:95], s59 offen
    s_add_u32 s59, s59, s46
L_g2_nopfb:
    ds_read_b128 v[4:7], v228 offset:0
    v_mfma_f32_16x16x32_bf16 v[64:67], v[128:131], v[20:23], v[64:67]
    ds_read_b64_tr_b16 v[36:37], v232 offset:0
    s_add_u32 m0, s36, 98304
    v_mfma_f32_16x16x32_bf16 v[80:83], v[128:131], v[24:27], v[80:83]
    ds_read_b64_tr_b16 v[38:39], v232 offset:4096
    buffer_load_dwordx4 v220, s[12:15], s28 offen offset:0 sc1 lds
    v_mfma_f32_16x16x32_bf16 v[96:99], v[128:131], v[28:31], v[96:99]
    ds_read_b128 v[8:11], v228 offset:1024
    v_mfma_f32_16x16x32_bf16 v[112:115], v[128:131], v[32:35], v[112:115]
    ds_read_b128 v[12:15], v230 offset:0
    v_mfma_f32_16x16x32_bf16 v[68:71], v[132:135], v[20:23], v[68:71]
    ds_read_b128 v[16:19], v230 offset:1024
    buffer_load_dwordx4 v221, s[12:15], s28 offen offset:1024 sc1 lds
    v_mfma_f32_16x16x32_bf16 v[84:87], v[132:135], v[24:27], v[84:87]
    ds_read_b64_tr_b16 v[40:41], v234 offset:0
    v_mfma_f32_16x16x32_bf16 v[100:103], v[132:135], v[28:31], v[100:103]
    ds_read_b64_tr_b16 v[42:43], v234 offset:4096
    v_mfma_f32_16x16x32_bf16 v[116:119], v[132:135], v[32:35], v[116:119]
    ds_read_b64_tr_b16 v[44:45], v236 offset:0
    v_mfma_f32_16x16x32_bf16 v[72:75], v[136:139], v[20:23], v[72:75]
    ds_read_b64_tr_b16 v[46:47], v236 offset:4096
    buffer_load_dwordx4 v222, s[12:15], s28 offen offset:2048 sc1 lds
    v_mfma_f32_16x16x32_bf16 v[88:91], v[136:139], v[24:27], v[88:91]
    ds_read_b64_tr_b16 v[48:49], v238 offset:0
    v_mfma_f32_16x16x32_bf16 v[104:107], v[136:139], v[28:31], v[104:107]
    ds_read_b64_tr_b16 v[50:51], v238 offset:4096
    v_mfma_f32_16x16x32_bf16 v[120:123], v[136:139], v[32:35], v[120:123]
    buffer_load_dwordx4 v223, s[12:15], s28 offen offset:3072 sc1 lds
    v_mfma_f32_16x16x32_bf16 v[76:79], v[140:143], v[20:23], v[76:79]
    v_mfma_f32_16x16x32_bf16 v[92:95], v[140:143], v[24:27], v[92:95]
    v_mfma_f32_16x16x32_bf16 v[108:111], v[140:143], v[28:31], v[108:111]
    s_add_u32 m0, s36, 102400
    v_mfma_f32_16x16x32_bf16 v[124:127], v[140:143], v[32:35], v[124:127]
    ds_read_b128 v[20:23], v228 offset:8192
    buffer_load_dwordx4 v224, s[12:15], s28 offen offset:0 sc1 lds
    s_waitcnt lgkmcnt(10)
    v_mfma_f32_16x16x32_bf16 v[64:67], v[36:39], v[4:7], v[64:67]
    ds_read_b64_tr_b16 v[128:129], v232 offset:8192
    s_waitcnt lgkmcnt(10)
    v_mfma_f32_16x16x32_bf16 v[80:83], v[36:39], v[8:11], v[80:83]
    ds_read_b64_tr_b16 v[130:131], v232 offset:12288
    s_waitcnt lgkmcnt(10)
    v_mfma_f32_16x16x32_bf16 v[96:99], v[36:39], v[12:15], v[96:99]
    ds_read_b128 v[24:27], v228 offset:9216
    buffer_load_dwordx4 v225, s[12:15], s28 offen offset:1024 sc1 lds
    s_waitcnt lgkmcnt(10)
    v_mfma_f32_16x16x32_bf16 v[112:115], v[36:39], v[16:19], v[112:115]
    ds_read_b128 v[28:31], v230 offset:8192
    s_waitcnt lgkmcnt(9)
    v_mfma_f32_16x16x32_bf16 v[68:71], v[40:43], v[4:7], v[68:71]
    ds_read_b128 v[32:35], v230 offset:9216
    v_mfma_f32_16x16x32_bf16 v[84:87], v[40:43], v[8:11], v[84:87]
    ds_read_b64_tr_b16 v[132:133], v234 offset:8192
    v_mfma_f32_16x16x32_bf16 v[100:103], v[40:43], v[12:15], v[100:103]
    ds_read_b64_tr_b16 v[134:135], v234 offset:12288
    buffer_load_dwordx4 v226, s[12:15], s28 offen offset:2048 sc1 lds
    v_mfma_f32_16x16x32_bf16 v[116:119], v[40:43], v[16:19], v[116:119]
    ds_read_b64_tr_b16 v[136:137], v236 offset:8192
    s_waitcnt lgkmcnt(11)
    v_mfma_f32_16x16x32_bf16 v[72:75], v[44:47], v[4:7], v[72:75]
    ds_read_b64_tr_b16 v[138:139], v236 offset:12288
    v_mfma_f32_16x16x32_bf16 v[88:91], v[44:47], v[8:11], v[88:91]
    ds_read_b64_tr_b16 v[140:141], v238 offset:8192
    buffer_load_dwordx4 v227, s[12:15], s28 offen offset:3072 sc1 lds
    v_mfma_f32_16x16x32_bf16 v[104:107], v[44:47], v[12:15], v[104:107]
    ds_read_b64_tr_b16 v[142:143], v238 offset:12288
    v_mfma_f32_16x16x32_bf16 v[120:123], v[44:47], v[16:19], v[120:123]
    s_waitcnt lgkmcnt(12)
    v_mfma_f32_16x16x32_bf16 v[76:79], v[48:51], v[4:7], v[76:79]
    v_mfma_f32_16x16x32_bf16 v[92:95], v[48:51], v[8:11], v[92:95]
    v_mfma_f32_16x16x32_bf16 v[108:111], v[48:51], v[12:15], v[108:111]
    v_mfma_f32_16x16x32_bf16 v[124:127], v[48:51], v[16:19], v[124:127]
    s_add_u32 s28, s28, s29
    s_waitcnt vmcnt(16) lgkmcnt(0)
    s_barrier
    s_cmp_eq_u32 s31, 1
    s_cbranch_scc1 L_g2_fin
    ds_read_b128 v[4:7], v228 offset:32768
    s_cmp_eq_u32 s31, s55
    s_cselect_b32 s28, s30, s28
    s_cmp_eq_u32 s31, s40
    s_cselect_b32 s28, s38, s28
    s_cselect_b32 s29, s54, s29
    s_cselect_b32 s12, s98, s12
    s_cselect_b32 s13, s39, s13
    s_cselect_b32 s14, s99, s14
    v_mfma_f32_16x16x32_bf16 v[64:67], v[128:131], v[20:23], v[64:67]
    ds_read_b64_tr_b16 v[36:37], v232 offset:32768
    s_add_u32 m0, s36, 0
    v_mfma_f32_16x16x32_bf16 v[80:83], v[128:131], v[24:27], v[80:83]
    ds_read_b64_tr_b16 v[38:39], v232 offset:36864
    buffer_load_dwordx4 v220, s[12:15], s28 offen offset:0 sc1 lds
    v_mfma_f32_16x16x32_bf16 v[96:99], v[128:131], v[28:31], v[96:99]
    ds_read_b128 v[8:11], v228 offset:33792
    v_mfma_f32_16x16x32_bf16 v[112:115], v[128:131], v[32:35], v[112:115]
    ds_read_b128 v[12:15], v230 offset:32768
    v_mfma_f32_16x16x32_bf16 v[68:71], v[132:135], v[20:23], v[68:71]
    ds_read_b128 v[16:19], v230 offset:33792
    buffer_load_dwordx4 v221, s[12:15], s28 offen offset:1024 sc1 lds
    v_mfma_f32_16x16x32_bf16 v[84:87], v[132:135], v[24:27], v[84:87]
    ds_read_b64_tr_b16 v[40:41], v234 offset:32768
    v_mfma_f32_16x16x32_bf16 v[100:103], v[132:135], v[28:31], v[100:103]
    ds_read_b64_tr_b16 v[42:43], v234 offset:36864
    v_mfma_f32_16x16x32_bf16 v[116:119], v[132:135], v[32:35], v[116:119]
    ds_read_b64_tr_b16 v[44:45], v236 offset:32768
    v_mfma_f32_16x16x32_bf16 v[72:75], v[136:139], v[20:23], v[72:75]
    ds_read_b64_tr_b16 v[46:47], v236 offset:36864
    buffer_load_dwordx4 v222, s[12:15], s28 offen offset:2048 sc1 lds
    v_mfma_f32_16x16x32_bf16 v[88:91], v[136:139], v[24:27], v[88:91]
    ds_read_b64_tr_b16 v[48:49], v238 offset:32768
    v_mfma_f32_16x16x32_bf16 v[104:107], v[136:139], v[28:31], v[104:107]
    ds_read_b64_tr_b16 v[50:51], v238 offset:36864
    v_mfma_f32_16x16x32_bf16 v[120:123], v[136:139], v[32:35], v[120:123]
    buffer_load_dwordx4 v223, s[12:15], s28 offen offset:3072 sc1 lds
    v_mfma_f32_16x16x32_bf16 v[76:79], v[140:143], v[20:23], v[76:79]
    v_mfma_f32_16x16x32_bf16 v[92:95], v[140:143], v[24:27], v[92:95]
    v_mfma_f32_16x16x32_bf16 v[108:111], v[140:143], v[28:31], v[108:111]
    s_add_u32 m0, s36, 4096
    v_mfma_f32_16x16x32_bf16 v[124:127], v[140:143], v[32:35], v[124:127]
    ds_read_b128 v[20:23], v228 offset:40960
    buffer_load_dwordx4 v224, s[12:15], s28 offen offset:0 sc1 lds
    s_waitcnt lgkmcnt(10)
    v_mfma_f32_16x16x32_bf16 v[64:67], v[36:39], v[4:7], v[64:67]
    ds_read_b64_tr_b16 v[128:129], v232 offset:40960
    s_waitcnt lgkmcnt(10)
    v_mfma_f32_16x16x32_bf16 v[80:83], v[36:39], v[8:11], v[80:83]
    ds_read_b64_tr_b16 v[130:131], v232 offset:45056
    s_waitcnt lgkmcnt(10)
    v_mfma_f32_16x16x32_bf16 v[96:99], v[36:39], v[12:15], v[96:99]
    ds_read_b128 v[24:27], v228 offset:41984
    buffer_load_dwordx4 v225, s[12:15], s28 offen offset:1024 sc1 lds
    s_waitcnt lgkmcnt(10)
    v_mfma_f32_16x16x32_bf16 v[112:115], v[36:39], v[16:19], v[112:115]
    ds_read_b128 v[28:31], v230 offset:40960
    s_waitcnt lgkmcnt(9)
    v_mfma_f32_16x16x32_bf16 v[68:71], v[40:43], v[4:7], v[68:71]
    ds_read_b128 v[32:35], v230 offset:41984
    v_mfma_f32_16x16x32_bf16 v[84:87], v[40:43], v[8:11], v[84:87]
    ds_read_b64_tr_b16 v[132:133], v234 offset:40960
    v_mfma_f32_16x16x32_bf16 v[100:103], v[40:43], v[12:15], v[100:103]
    ds_read_b64_tr_b16 v[134:135], v234 offset:45056
    buffer_load_dwordx4 v226, s[12:15], s28 offen offset:2048 sc1 lds
    v_mfma_f32_16x16x32_bf16 v[116:119], v[40:43], v[16:19], v[116:119]
    ds_read_b64_tr_b16 v[136:137], v236 offset:40960
    s_waitcnt lgkmcnt(11)
    v_mfma_f32_16x16x32_bf16 v[72:75], v[44:47], v[4:7], v[72:75]
    ds_read_b64_tr_b16 v[138:139], v236 offset:45056
    v_mfma_f32_16x16x32_bf16 v[88:91], v[44:47], v[8:11], v[88:91]
    ds_read_b64_tr_b16 v[140:141], v238 offset:40960
    buffer_load_dwordx4 v227, s[12:15], s28 offen offset:3072 sc1 lds
    v_mfma_f32_16x16x32_bf16 v[104:107], v[44:47], v[12:15], v[104:107]
    ds_read_b64_tr_b16 v[142:143], v238 offset:45056
    v_mfma_f32_16x16x32_bf16 v[120:123], v[44:47], v[16:19], v[120:123]
    s_waitcnt lgkmcnt(12)
    v_mfma_f32_16x16x32_bf16 v[76:79], v[48:51], v[4:7], v[76:79]
    v_mfma_f32_16x16x32_bf16 v[92:95], v[48:51], v[8:11], v[92:95]
    v_mfma_f32_16x16x32_bf16 v[108:111], v[48:51], v[12:15], v[108:111]
    v_mfma_f32_16x16x32_bf16 v[124:127], v[48:51], v[16:19], v[124:127]
    s_add_u32 s28, s28, s29
    s_waitcnt vmcnt(16) lgkmcnt(0)
    s_barrier
    s_add_u32 s47, s55, 1
    s_cmp_lg_u32 s31, s47
    s_cbranch_scc1 L_g2_c3_2
    v_mov_b32 v240, 0
    v_mov_b32 v241, s96
    s_mov_b64 exec, 1
    buffer_store_dword v241, v240, s[84:87], s53 offen sc1
    s_mov_b64 exec, -1
L_g2_c3_2:
    ds_read_b128 v[4:7], v229 offset:0
    v_mfma_f32_16x16x32_bf16 v[64:67], v[128:131], v[20:23], v[64:67]
    ds_read_b64_tr_b16 v[36:37], v233 offset:0
    s_add_u32 m0, s36, 32768
    v_mfma_f32_16x16x32_bf16 v[80:83], v[128:131], v[24:27], v[80:83]
    ds_read_b64_tr_b16 v[38:39], v233 offset:4096
    buffer_load_dwordx4 v220, s[12:15], s28 offen offset:0 sc1 lds
    v_mfma_f32_16x16x32_bf16 v[96:99], v[128:131], v[28:31], v[96:99]
    ds_read_b128 v[8:11], v229 offset:1024
    v_mfma_f32_16x16x32_bf16 v[112:115], v[128:131], v[32:35], v[112:115]
    ds_read_b128 v[12:15], v231 offset:0
    v_mfma_f32_16x16x32_bf16 v[68:71], v[132:135], v[20:23], v[68:71]
    ds_read_b128 v[16:19], v231 offset:1024
    buffer_load_dwordx4 v221, s[12:15], s28 offen offset:1024 sc1 lds
    v_mfma_f32_16x16x32_bf16 v[84:87], v[132:135], v[24:27], v[84:87]
    ds_read_b64_tr_b16 v[40:41], v235 offset:0
    v_mfma_f32_16x16x32_bf16 v[100:103], v[132:135], v[28:31], v[100:103]
    ds_read_b64_tr_b16 v[42:43], v235 offset:4096
    v_mfma_f32_16x16x32_bf16 v[116:119], v[132:135], v[32:35], v[116:119]
    ds_read_b64_tr_b16 v[44:45], v237 offset:0
    v_mfma_f32_16x16x32_bf16 v[72:75], v[136:139], v[20:23], v[72:75]
    ds_read_b64_tr_b16 v[46:47], v237 offset:4096
    buffer_load_dwordx4 v222, s[12:15], s28 offen offset:2048 sc1 lds
    v_mfma_f32_16x16x32_bf16 v[88:91], v[136:139], v[24:27], v[88:91]
    ds_read_b64_tr_b16 v[48:49], v239 offset:0
    v_mfma_f32_16x16x32_bf16 v[104:107], v[136:139], v[28:31], v[104:107]
    ds_read_b64_tr_b16 v[50:51], v239 offset:4096
    v_mfma_f32_16x16x32_bf16 v[120:123], v[136:139], v[32:35], v[120:123]
    buffer_load_dwordx4 v223, s[12:15], s28 offen offset:3072 sc1 lds
    v_mfma_f32_16x16x32_bf16 v[76:79], v[140:143], v[20:23], v[76:79]
    v_mfma_f32_16x16x32_bf16 v[92:95], v[140:143], v[24:27], v[92:95]
    v_mfma_f32_16x16x32_bf16 v[108:111], v[140:143], v[28:31], v[108:111]
    s_add_u32 m0, s36, 36864
    v_mfma_f32_16x16x32_bf16 v[124:127], v[140:143], v[32:35], v[124:127]
    ds_read_b128 v[20:23], v229 offset:8192
    buffer_load_dwordx4 v224, s[12:15], s28 offen offset:0 sc1 lds
    s_waitcnt lgkmcnt(10)
    v_mfma_f32_16x16x32_bf16 v[64:67], v[36:39], v[4:7], v[64:67]
    ds_read_b64_tr_b16 v[128:129], v233 offset:8192
    s_waitcnt lgkmcnt(10)
    v_mfma_f32_16x16x32_bf16 v[80:83], v[36:39], v[8:11], v[80:83]
    ds_read_b64_tr_b16 v[130:131], v233 offset:12288
    s_waitcnt lgkmcnt(10)
    v_mfma_f32_16x16x32_bf16 v[96:99], v[36:39], v[12:15], v[96:99]
    ds_read_b128 v[24:27], v229 offset:9216
    buffer_load_dwordx4 v225, s[12:15], s28 offen offset:1024 sc1 lds
    s_waitcnt lgkmcnt(10)
    v_mfma_f32_16x16x32_bf16 v[112:115], v[36:39], v[16:19], v[112:115]
    ds_read_b128 v[28:31], v231 offset:8192
    s_waitcnt lgkmcnt(9)
    v_mfma_f32_16x16x32_bf16 v[68:71], v[40:43], v[4:7], v[68:71]
    ds_read_b128 v[32:35], v231 offset:9216
    v_mfma_f32_16x16x32_bf16 v[84:87], v[40:43], v[8:11], v[84:87]
    ds_read_b64_tr_b16 v[132:133], v235 offset:8192
    v_mfma_f32_16x16x32_bf16 v[100:103], v[40:43], v[12:15], v[100:103]
    ds_read_b64_tr_b16 v[134:135], v235 offset:12288
    buffer_load_dwordx4 v226, s[12:15], s28 offen offset:2048 sc1 lds
    v_mfma_f32_16x16x32_bf16 v[116:119], v[40:43], v[16:19], v[116:119]
    ds_read_b64_tr_b16 v[136:137], v237 offset:8192
    s_waitcnt lgkmcnt(11)
    v_mfma_f32_16x16x32_bf16 v[72:75], v[44:47], v[4:7], v[72:75]
    ds_read_b64_tr_b16 v[138:139], v237 offset:12288
    v_mfma_f32_16x16x32_bf16 v[88:91], v[44:47], v[8:11], v[88:91]
    ds_read_b64_tr_b16 v[140:141], v239 offset:8192
    buffer_load_dwordx4 v227, s[12:15], s28 offen offset:3072 sc1 lds
    v_mfma_f32_16x16x32_bf16 v[104:107], v[44:47], v[12:15], v[104:107]
    ds_read_b64_tr_b16 v[142:143], v239 offset:12288
    v_mfma_f32_16x16x32_bf16 v[120:123], v[44:47], v[16:19], v[120:123]
    s_waitcnt lgkmcnt(12)
    v_mfma_f32_16x16x32_bf16 v[76:79], v[48:51], v[4:7], v[76:79]
    v_mfma_f32_16x16x32_bf16 v[92:95], v[48:51], v[8:11], v[92:95]
    v_mfma_f32_16x16x32_bf16 v[108:111], v[48:51], v[12:15], v[108:111]
    v_mfma_f32_16x16x32_bf16 v[124:127], v[48:51], v[16:19], v[124:127]
    s_add_u32 s28, s28, s29
    s_waitcnt vmcnt(16) lgkmcnt(0)
    s_barrier
    ds_read_b128 v[4:7], v229 offset:32768
    v_mfma_f32_16x16x32_bf16 v[64:67], v[128:131], v[20:23], v[64:67]
    ds_read_b64_tr_b16 v[36:37], v233 offset:32768
    s_add_u32 m0, s36, 65536
    v_mfma_f32_16x16x32_bf16 v[80:83], v[128:131], v[24:27], v[80:83]
    ds_read_b64_tr_b16 v[38:39], v233 offset:36864
    buffer_load_dwordx4 v220, s[12:15], s28 offen offset:0 sc1 lds
    v_mfma_f32_16x16x32_bf16 v[96:99], v[128:131], v[28:31], v[96:99]
    ds_read_b128 v[8:11], v229 offset:33792
    v_mfma_f32_16x16x32_bf16 v[112:115], v[128:131], v[32:35], v[112:115]
    ds_read_b128 v[12:15], v231 offset:32768
    v_mfma_f32_16x16x32_bf16 v[68:71], v[132:135], v[20:23], v[68:71]
    ds_read_b128 v[16:19], v231 offset:33792
    buffer_load_dwordx4 v221, s[12:15], s28 offen offset:1024 sc1 lds
    v_mfma_f32_16x16x32_bf16 v[84:87], v[132:135], v[24:27], v[84:87]
    ds_read_b64_tr_b16 v[40:41], v235 offset:32768
    v_mfma_f32_16x16x32_bf16 v[100:103], v[132:135], v[28:31], v[100:103]
    ds_read_b64_tr_b16 v[42:43], v235 offset:36864
    v_mfma_f32_16x16x32_bf16 v[116:119], v[132:135], v[32:35], v[116:119]
    ds_read_b64_tr_b16 v[44:45], v237 offset:32768
    v_mfma_f32_16x16x32_bf16 v[72:75], v[136:139], v[20:23], v[72:75]
    ds_read_b64_tr_b16 v[46:47], v237 offset:36864
    buffer_load_dwordx4 v222, s[12:15], s28 offen offset:2048 sc1 lds
    v_mfma_f32_16x16x32_bf16 v[88:91], v[136:139], v[24:27], v[88:91]
    ds_read_b64_tr_b16 v[48:49], v239 offset:32768
    v_mfma_f32_16x16x32_bf16 v[104:107], v[136:139], v[28:31], v[104:107]
    ds_read_b64_tr_b16 v[50:51], v239 offset:36864
    v_mfma_f32_16x16x32_bf16 v[120:123], v[136:139], v[32:35], v[120:123]
    buffer_load_dwordx4 v223, s[12:15], s28 offen offset:3072 sc1 lds
    v_mfma_f32_16x16x32_bf16 v[76:79], v[140:143], v[20:23], v[76:79]
    v_mfma_f32_16x16x32_bf16 v[92:95], v[140:143], v[24:27], v[92:95]
    v_mfma_f32_16x16x32_bf16 v[108:111], v[140:143], v[28:31], v[108:111]
    s_add_u32 m0, s36, 69632
    v_mfma_f32_16x16x32_bf16 v[124:127], v[140:143], v[32:35], v[124:127]
    ds_read_b128 v[20:23], v229 offset:40960
    buffer_load_dwordx4 v224, s[12:15], s28 offen offset:0 sc1 lds
    s_waitcnt lgkmcnt(10)
    v_mfma_f32_16x16x32_bf16 v[64:67], v[36:39], v[4:7], v[64:67]
    ds_read_b64_tr_b16 v[128:129], v233 offset:40960
    s_waitcnt lgkmcnt(10)
    v_mfma_f32_16x16x32_bf16 v[80:83], v[36:39], v[8:11], v[80:83]
    ds_read_b64_tr_b16 v[130:131], v233 offset:45056
    s_waitcnt lgkmcnt(10)
    v_mfma_f32_16x16x32_bf16 v[96:99], v[36:39], v[12:15], v[96:99]
    ds_read_b128 v[24:27], v229 offset:41984
    buffer_load_dwordx4 v225, s[12:15], s28 offen offset:1024 sc1 lds
    s_waitcnt lgkmcnt(10)
    v_mfma_f32_16x16x32_bf16 v[112:115], v[36:39], v[16:19], v[112:115]
    ds_read_b128 v[28:31], v231 offset:40960
    s_waitcnt lgkmcnt(9)
    v_mfma_f32_16x16x32_bf16 v[68:71], v[40:43], v[4:7], v[68:71]
    ds_read_b128 v[32:35], v231 offset:41984
    v_mfma_f32_16x16x32_bf16 v[84:87], v[40:43], v[8:11], v[84:87]
    ds_read_b64_tr_b16 v[132:133], v235 offset:40960
    v_mfma_f32_16x16x32_bf16 v[100:103], v[40:43], v[12:15], v[100:103]
    ds_read_b64_tr_b16 v[134:135], v235 offset:45056
    buffer_load_dwordx4 v226, s[12:15], s28 offen offset:2048 sc1 lds
    v_mfma_f32_16x16x32_bf16 v[116:119], v[40:43], v[16:19], v[116:119]
    ds_read_b64_tr_b16 v[136:137], v237 offset:40960
    s_waitcnt lgkmcnt(11)
    v_mfma_f32_16x16x32_bf16 v[72:75], v[44:47], v[4:7], v[72:75]
    ds_read_b64_tr_b16 v[138:139], v237 offset:45056
    v_mfma_f32_16x16x32_bf16 v[88:91], v[44:47], v[8:11], v[88:91]
    ds_read_b64_tr_b16 v[140:141], v239 offset:40960
    buffer_load_dwordx4 v227, s[12:15], s28 offen offset:3072 sc1 lds
    v_mfma_f32_16x16x32_bf16 v[104:107], v[44:47], v[12:15], v[104:107]
    ds_read_b64_tr_b16 v[142:143], v239 offset:45056
    v_mfma_f32_16x16x32_bf16 v[120:123], v[44:47], v[16:19], v[120:123]
    s_waitcnt lgkmcnt(12)
    v_mfma_f32_16x16x32_bf16 v[76:79], v[48:51], v[4:7], v[76:79]
    v_mfma_f32_16x16x32_bf16 v[92:95], v[48:51], v[8:11], v[92:95]
    v_mfma_f32_16x16x32_bf16 v[108:111], v[48:51], v[12:15], v[108:111]
    v_mfma_f32_16x16x32_bf16 v[124:127], v[48:51], v[16:19], v[124:127]
    s_add_u32 s28, s28, s29
    s_waitcnt vmcnt(16) lgkmcnt(0)
    s_barrier
    s_sub_u32 s31, s31, 1
    s_branch L_g2_loop2
    .p2align 6
L_g2_fin:
    s_add_u32 s16, s82, 25165824
    s_addc_u32 s17, s83, 0
    s_and_b32 s17, s17, 0xffff
    s_mov_b32 s18, 4194304
    s_mov_b32 s19, 0x00020000
    s_mov_b32 s24, s64
    s_and_b32 s25, s65, 0xffff
    s_mov_b32 s26, 4194304
    s_mov_b32 s27, 0x00020000
    s_mov_b32 s20, s78
    s_and_b32 s21, s79, 0xffff
    s_mov_b32 s22, 4194304
    s_mov_b32 s23, 0x00020000
    s_lshl_b32 s55, s61, 3
    s_add_u32 s55, s55, s62
    s_lshl_b32 s55, s55, 15
    s_lshl_b32 s56, s32, 13
    s_add_u32 s55, s55, s56
    s_add_u32 s57, s55, 4096
    s_mov_b32 s49, 32768
    s_mov_b32 s50, 65536
    s_mov_b32 s51, 98304
    s_or_b32 s53, s37, 512
    s_add_u32 s53, s53, 65536
    v_mov_b32 v245, s53
    ds_read_b128 v[4:7], v228 offset:32768
    v_mfma_f32_16x16x32_bf16 v[64:67], v[128:131], v[20:23], v[64:67]
    ds_read_b64_tr_b16 v[36:37], v232 offset:32768
    v_mfma_f32_16x16x32_bf16 v[80:83], v[128:131], v[24:27], v[80:83]
    ds_read_b64_tr_b16 v[38:39], v232 offset:36864
    v_mfma_f32_16x16x32_bf16 v[96:99], v[128:131], v[28:31], v[96:99]
    ds_read_b128 v[8:11], v228 offset:33792
    v_mfma_f32_16x16x32_bf16 v[112:115], v[128:131], v[32:35], v[112:115]
    ds_read_b128 v[12:15], v230 offset:32768
    v_mfma_f32_16x16x32_bf16 v[68:71], v[132:135], v[20:23], v[68:71]
    ds_read_b128 v[16:19], v230 offset:33792
    v_mfma_f32_16x16x32_bf16 v[84:87], v[132:135], v[24:27], v[84:87]
    ds_read_b64_tr_b16 v[40:41], v234 offset:32768
    v_mfma_f32_16x16x32_bf16 v[100:103], v[132:135], v[28:31], v[100:103]
    ds_read_b64_tr_b16 v[42:43], v234 offset:36864
    v_mfma_f32_16x16x32_bf16 v[116:119], v[132:135], v[32:35], v[116:119]
    ds_read_b64_tr_b16 v[44:45], v236 offset:32768
    v_mfma_f32_16x16x32_bf16 v[72:75], v[136:139], v[20:23], v[72:75]
    ds_read_b64_tr_b16 v[46:47], v236 offset:36864
    v_mfma_f32_16x16x32_bf16 v[88:91], v[136:139], v[24:27], v[88:91]
    ds_read_b64_tr_b16 v[48:49], v238 offset:32768
    v_mfma_f32_16x16x32_bf16 v[104:107], v[136:139], v[28:31], v[104:107]
    ds_read_b64_tr_b16 v[50:51], v238 offset:36864
    v_mfma_f32_16x16x32_bf16 v[120:123], v[136:139], v[32:35], v[120:123]
    v_mfma_f32_16x16x32_bf16 v[76:79], v[140:143], v[20:23], v[76:79]
    v_mfma_f32_16x16x32_bf16 v[92:95], v[140:143], v[24:27], v[92:95]
    v_mfma_f32_16x16x32_bf16 v[108:111], v[140:143], v[28:31], v[108:111]
    v_mfma_f32_16x16x32_bf16 v[124:127], v[140:143], v[32:35], v[124:127]
    ds_read_b128 v[20:23], v228 offset:40960
    s_waitcnt lgkmcnt(10)
    v_mfma_f32_16x16x32_bf16 v[64:67], v[36:39], v[4:7], v[64:67]
    ds_read_b64_tr_b16 v[128:129], v232 offset:40960
    s_waitcnt lgkmcnt(10)
    v_mfma_f32_16x16x32_bf16 v[80:83], v[36:39], v[8:11], v[80:83]
    ds_read_b64_tr_b16 v[130:131], v232 offset:45056
    s_waitcnt lgkmcnt(10)
    v_mfma_f32_16x16x32_bf16 v[96:99], v[36:39], v[12:15], v[96:99]
    ds_read_b128 v[24:27], v228 offset:41984
    s_waitcnt lgkmcnt(10)
    v_mfma_f32_16x16x32_bf16 v[112:115], v[36:39], v[16:19], v[112:115]
    ds_read_b128 v[28:31], v230 offset:40960
    s_waitcnt lgkmcnt(9)
    v_mfma_f32_16x16x32_bf16 v[68:71], v[40:43], v[4:7], v[68:71]
    ds_read_b128 v[32:35], v230 offset:41984
    v_mfma_f32_16x16x32_bf16 v[84:87], v[40:43], v[8:11], v[84:87]
    ds_read_b64_tr_b16 v[132:133], v234 offset:40960
    v_mfma_f32_16x16x32_bf16 v[100:103], v[40:43], v[12:15], v[100:103]
    ds_read_b64_tr_b16 v[134:135], v234 offset:45056
    v_mfma_f32_16x16x32_bf16 v[116:119], v[40:43], v[16:19], v[116:119]
    ds_read_b64_tr_b16 v[136:137], v236 offset:40960
    s_waitcnt lgkmcnt(11)
    v_mfma_f32_16x16x32_bf16 v[72:75], v[44:47], v[4:7], v[72:75]
    ds_read_b64_tr_b16 v[138:139], v236 offset:45056
    v_mfma_f32_16x16x32_bf16 v[88:91], v[44:47], v[8:11], v[88:91]
    ds_read_b64_tr_b16 v[140:141], v238 offset:40960
    v_mfma_f32_16x16x32_bf16 v[104:107], v[44:47], v[12:15], v[104:107]
    ds_read_b64_tr_b16 v[142:143], v238 offset:45056
    v_mfma_f32_16x16x32_bf16 v[120:123], v[44:47], v[16:19], v[120:123]
    s_waitcnt lgkmcnt(12)
    v_mfma_f32_16x16x32_bf16 v[76:79], v[48:51], v[4:7], v[76:79]
    v_mfma_f32_16x16x32_bf16 v[92:95], v[48:51], v[8:11], v[92:95]
    v_mfma_f32_16x16x32_bf16 v[108:111], v[48:51], v[12:15], v[108:111]
    v_mfma_f32_16x16x32_bf16 v[124:127], v[48:51], v[16:19], v[124:127]
    s_waitcnt vmcnt(8) lgkmcnt(0)
    s_barrier
    s_cmp_eq_u32 s60, 1
    s_cbranch_scc1 L_fin_e1
    s_mov_b64 exec, 1
    buffer_load_dword v250, v245, s[84:87], 0 offen sc1
    s_mov_b64 exec, -1
    s_branch L_fin_2
L_fin_e1:
    buffer_load_dwordx4 v[144:147], v249, s[24:27], 0 offen offset:0
    buffer_load_dwordx4 v[148:151], v249, s[24:27], 0 offen offset:64
    buffer_load_dwordx4 v[152:155], v249, s[24:27], s49 offen offset:0
    buffer_load_dwordx4 v[156:159], v249, s[24:27], s49 offen offset:64
    buffer_load_dwordx4 v[160:163], v249, s[24:27], s50 offen offset:0
    buffer_load_dwordx4 v[164:167], v249, s[24:27], s50 offen offset:64
    buffer_load_dwordx4 v[168:171], v249, s[24:27], s51 offen offset:0
    buffer_load_dwordx4 v[172:175], v249, s[24:27], s51 offen offset:64
L_fin_2:
    ds_read_b128 v[4:7], v229 offset:0
    v_mfma_f32_16x16x32_bf16 v[64:67], v[128:131], v[20:23], v[64:67]
    ds_read_b64_tr_b16 v[36:37], v233 offset:0
    v_mfma_f32_16x16x32_bf16 v[80:83], v[128:131], v[24:27], v[80:83]
    ds_read_b64_tr_b16 v[38:39], v233 offset:4096
    v_mfma_f32_16x16x32_bf16 v[96:99], v[128:131], v[28:31], v[96:99]
    ds_read_b128 v[8:11], v229 offset:1024
    v_mfma_f32_16x16x32_bf16 v[112:115], v[128:131], v[32:35], v[112:115]
    ds_read_b128 v[12:15], v231 offset:0
    v_mfma_f32_16x16x32_bf16 v[68:71], v[132:135], v[20:23], v[68:71]
    ds_read_b128 v[16:19], v231 offset:1024
    v_mfma_f32_16x16x32_bf16 v[84:87], v[132:135], v[24:27], v[84:87]
    ds_read_b64_tr_b16 v[40:41], v235 offset:0
    v_mfma_f32_16x16x32_bf16 v[100:103], v[132:135], v[28:31], v[100:103]
    ds_read_b64_tr_b16 v[42:43], v235 offset:4096
    v_mfma_f32_16x16x32_bf16 v[116:119], v[132:135], v[32:35], v[116:119]
    ds_read_b64_tr_b16 v[44:45], v237 offset:0
    v_mfma_f32_16x16x32_bf16 v[72:75], v[136:139], v[20:23], v[72:75]
    ds_read_b64_tr_b16 v[46:47], v237 offset:4096
    v_mfma_f32_16x16x32_bf16 v[88:91], v[136:139], v[24:27], v[88:91]
    ds_read_b64_tr_b16 v[48:49], v239 offset:0
    v_mfma_f32_16x16x32_bf16 v[104:107], v[136:139], v[28:31], v[104:107]
    ds_read_b64_tr_b16 v[50:51], v239 offset:4096
    v_mfma_f32_16x16x32_bf16 v[120:123], v[136:139], v[32:35], v[120:123]
    v_mfma_f32_16x16x32_bf16 v[76:79], v[140:143], v[20:23], v[76:79]
    v_mfma_f32_16x16x32_bf16 v[92:95], v[140:143], v[24:27], v[92:95]
    v_mfma_f32_16x16x32_bf16 v[108:111], v[140:143], v[28:31], v[108:111]
    v_mfma_f32_16x16x32_bf16 v[124:127], v[140:143], v[32:35], v[124:127]
    ds_read_b128 v[20:23], v229 offset:8192
    s_waitcnt lgkmcnt(10)
    v_mfma_f32_16x16x32_bf16 v[64:67], v[36:39], v[4:7], v[64:67]
    ds_read_b64_tr_b16 v[128:129], v233 offset:8192
    s_waitcnt lgkmcnt(10)
    v_mfma_f32_16x16x32_bf16 v[80:83], v[36:39], v[8:11], v[80:83]
    ds_read_b64_tr_b16 v[130:131], v233 offset:12288
    s_waitcnt lgkmcnt(10)
    v_mfma_f32_16x16x32_bf16 v[96:99], v[36:39], v[12:15], v[96:99]
    ds_read_b128 v[24:27], v229 offset:9216
    s_waitcnt lgkmcnt(10)
    v_mfma_f32_16x16x32_bf16 v[112:115], v[36:39], v[16:19], v[112:115]
    ds_read_b128 v[28:31], v231 offset:8192
    s_waitcnt lgkmcnt(9)
    v_mfma_f32_16x16x32_bf16 v[68:71], v[40:43], v[4:7], v[68:71]
    ds_read_b128 v[32:35], v231 offset:9216
    v_mfma_f32_16x16x32_bf16 v[84:87], v[40:43], v[8:11], v[84:87]
    ds_read_b64_tr_b16 v[132:133], v235 offset:8192
    v_mfma_f32_16x16x32_bf16 v[100:103], v[40:43], v[12:15], v[100:103]
    ds_read_b64_tr_b16 v[134:135], v235 offset:12288
    v_mfma_f32_16x16x32_bf16 v[116:119], v[40:43], v[16:19], v[116:119]
    ds_read_b64_tr_b16 v[136:137], v237 offset:8192
    s_waitcnt lgkmcnt(11)
    v_mfma_f32_16x16x32_bf16 v[72:75], v[44:47], v[4:7], v[72:75]
    ds_read_b64_tr_b16 v[138:139], v237 offset:12288
    v_mfma_f32_16x16x32_bf16 v[88:91], v[44:47], v[8:11], v[88:91]
    ds_read_b64_tr_b16 v[140:141], v239 offset:8192
    v_mfma_f32_16x16x32_bf16 v[104:107], v[44:47], v[12:15], v[104:107]
    ds_read_b64_tr_b16 v[142:143], v239 offset:12288
    v_mfma_f32_16x16x32_bf16 v[120:123], v[44:47], v[16:19], v[120:123]
    s_waitcnt lgkmcnt(12)
    v_mfma_f32_16x16x32_bf16 v[76:79], v[48:51], v[4:7], v[76:79]
    v_mfma_f32_16x16x32_bf16 v[92:95], v[48:51], v[8:11], v[92:95]
    v_mfma_f32_16x16x32_bf16 v[108:111], v[48:51], v[12:15], v[108:111]
    v_mfma_f32_16x16x32_bf16 v[124:127], v[48:51], v[16:19], v[124:127]
    s_waitcnt vmcnt(8) lgkmcnt(0)
    s_mov_b32 s58, 1
    s_cmp_eq_u32 s60, 1
    s_cbranch_scc1 L_fin_3
    s_waitcnt vmcnt(0)
    v_readfirstlane_b32 s47, v250
    s_cmp_eq_u32 s47, s96
    s_cselect_b32 s58, 1, 0
    s_cbranch_scc0 L_fin_3
    buffer_load_dwordx4 v[144:147], v3, s[16:19], s55 offen offset:0 sc1
    buffer_load_dwordx4 v[148:151], v3, s[16:19], s55 offen offset:1024 sc1
    buffer_load_dwordx4 v[152:155], v3, s[16:19], s55 offen offset:2048 sc1
    buffer_load_dwordx4 v[156:159], v3, s[16:19], s55 offen offset:3072 sc1
    buffer_load_dwordx4 v[160:163], v3, s[16:19], s57 offen offset:0 sc1
    buffer_load_dwordx4 v[164:167], v3, s[16:19], s57 offen offset:1024 sc1
    buffer_load_dwordx4 v[168:171], v3, s[16:19], s57 offen offset:2048 sc1
    buffer_load_dwordx4 v[172:175], v3, s[16:19], s57 offen offset:3072 sc1
L_fin_3:
    s_barrier
    ds_read_b128 v[4:7], v229 offset:32768
    v_mfma_f32_16x16x32_bf16 v[64:67], v[128:131], v[20:23], v[64:67]
    ds_read_b64_tr_b16 v[36:37], v233 offset:32768
    v_mfma_f32_16x16x32_bf16 v[80:83], v[128:131], v[24:27], v[80:83]
    ds_read_b64_tr_b16 v[38:39], v233 offset:36864
    v_mfma_f32_16x16x32_bf16 v[96:99], v[128:131], v[28:31], v[96:99]
    ds_read_b128 v[8:11], v229 offset:33792
    v_mfma_f32_16x16x32_bf16 v[112:115], v[128:131], v[32:35], v[112:115]
    ds_read_b128 v[12:15], v231 offset:32768
    v_mfma_f32_16x16x32_bf16 v[68:71], v[132:135], v[20:23], v[68:71]
    ds_read_b128 v[16:19], v231 offset:33792
    v_mfma_f32_16x16x32_bf16 v[84:87], v[132:135], v[24:27], v[84:87]
    ds_read_b64_tr_b16 v[40:41], v235 offset:32768
    v_mfma_f32_16x16x32_bf16 v[100:103], v[132:135], v[28:31], v[100:103]
    ds_read_b64_tr_b16 v[42:43], v235 offset:36864
    v_mfma_f32_16x16x32_bf16 v[116:119], v[132:135], v[32:35], v[116:119]
    ds_read_b64_tr_b16 v[44:45], v237 offset:32768
    v_mfma_f32_16x16x32_bf16 v[72:75], v[136:139], v[20:23], v[72:75]
    ds_read_b64_tr_b16 v[46:47], v237 offset:36864
    v_mfma_f32_16x16x32_bf16 v[88:91], v[136:139], v[24:27], v[88:91]
    ds_read_b64_tr_b16 v[48:49], v239 offset:32768
    v_mfma_f32_16x16x32_bf16 v[104:107], v[136:139], v[28:31], v[104:107]
    ds_read_b64_tr_b16 v[50:51], v239 offset:36864
    v_mfma_f32_16x16x32_bf16 v[120:123], v[136:139], v[32:35], v[120:123]
    v_mfma_f32_16x16x32_bf16 v[76:79], v[140:143], v[20:23], v[76:79]
    v_mfma_f32_16x16x32_bf16 v[92:95], v[140:143], v[24:27], v[92:95]
    v_mfma_f32_16x16x32_bf16 v[108:111], v[140:143], v[28:31], v[108:111]
    v_mfma_f32_16x16x32_bf16 v[124:127], v[140:143], v[32:35], v[124:127]
    ds_read_b128 v[20:23], v229 offset:40960
    s_waitcnt lgkmcnt(10)
    v_mfma_f32_16x16x32_bf16 v[64:67], v[36:39], v[4:7], v[64:67]
    ds_read_b64_tr_b16 v[128:129], v233 offset:40960
    s_waitcnt lgkmcnt(10)
    v_mfma_f32_16x16x32_bf16 v[80:83], v[36:39], v[8:11], v[80:83]
    ds_read_b64_tr_b16 v[130:131], v233 offset:45056
    s_waitcnt lgkmcnt(10)
    v_mfma_f32_16x16x32_bf16 v[96:99], v[36:39], v[12:15], v[96:99]
    ds_read_b128 v[24:27], v229 offset:41984
    s_waitcnt lgkmcnt(10)
    v_mfma_f32_16x16x32_bf16 v[112:115], v[36:39], v[16:19], v[112:115]
    ds_read_b128 v[28:31], v231 offset:40960
    s_waitcnt lgkmcnt(9)
    v_mfma_f32_16x16x32_bf16 v[68:71], v[40:43], v[4:7], v[68:71]
    ds_read_b128 v[32:35], v231 offset:41984
    v_mfma_f32_16x16x32_bf16 v[84:87], v[40:43], v[8:11], v[84:87]
    ds_read_b64_tr_b16 v[132:133], v235 offset:40960
    v_mfma_f32_16x16x32_bf16 v[100:103], v[40:43], v[12:15], v[100:103]
    ds_read_b64_tr_b16 v[134:135], v235 offset:45056
    v_mfma_f32_16x16x32_bf16 v[116:119], v[40:43], v[16:19], v[116:119]
    ds_read_b64_tr_b16 v[136:137], v237 offset:40960
    s_waitcnt lgkmcnt(11)
    v_mfma_f32_16x16x32_bf16 v[72:75], v[44:47], v[4:7], v[72:75]
    ds_read_b64_tr_b16 v[138:139], v237 offset:45056
    v_mfma_f32_16x16x32_bf16 v[88:91], v[44:47], v[8:11], v[88:91]
    ds_read_b64_tr_b16 v[140:141], v239 offset:40960
    v_mfma_f32_16x16x32_bf16 v[104:107], v[44:47], v[12:15], v[104:107]
    ds_read_b64_tr_b16 v[142:143], v239 offset:45056
    v_mfma_f32_16x16x32_bf16 v[120:123], v[44:47], v[16:19], v[120:123]
    s_waitcnt lgkmcnt(12)
    v_mfma_f32_16x16x32_bf16 v[76:79], v[48:51], v[4:7], v[76:79]
    v_mfma_f32_16x16x32_bf16 v[92:95], v[48:51], v[8:11], v[92:95]
    v_mfma_f32_16x16x32_bf16 v[108:111], v[48:51], v[12:15], v[108:111]
    v_mfma_f32_16x16x32_bf16 v[124:127], v[48:51], v[16:19], v[124:127]
    s_waitcnt lgkmcnt(0)
    v_mfma_f32_16x16x32_bf16 v[64:67], v[128:131], v[20:23], v[64:67]
    v_mfma_f32_16x16x32_bf16 v[68:71], v[132:135], v[20:23], v[68:71]
    v_mfma_f32_16x16x32_bf16 v[72:75], v[136:139], v[20:23], v[72:75]
    v_mfma_f32_16x16x32_bf16 v[76:79], v[140:143], v[20:23], v[76:79]
    v_mfma_f32_16x16x32_bf16 v[80:83], v[128:131], v[24:27], v[80:83]
    v_mfma_f32_16x16x32_bf16 v[84:87], v[132:135], v[24:27], v[84:87]
    v_mfma_f32_16x16x32_bf16 v[88:91], v[136:139], v[24:27], v[88:91]
    v_mfma_f32_16x16x32_bf16 v[92:95], v[140:143], v[24:27], v[92:95]
    v_mfma_f32_16x16x32_bf16 v[96:99], v[128:131], v[28:31], v[96:99]
    v_mfma_f32_16x16x32_bf16 v[100:103], v[132:135], v[28:31], v[100:103]
    v_mfma_f32_16x16x32_bf16 v[104:107], v[136:139], v[28:31], v[104:107]
    v_mfma_f32_16x16x32_bf16 v[108:111], v[140:143], v[28:31], v[108:111]
    v_mfma_f32_16x16x32_bf16 v[112:115], v[128:131], v[32:35], v[112:115]
    v_mfma_f32_16x16x32_bf16 v[116:119], v[132:135], v[32:35], v[116:119]
    v_mfma_f32_16x16x32_bf16 v[120:123], v[136:139], v[32:35], v[120:123]
    v_mfma_f32_16x16x32_bf16 v[124:127], v[140:143], v[32:35], v[124:127]
    s_cmp_eq_u32 s58, 1
    s_cbranch_scc1 L_fin_4
    s_mov_b64 exec, 0x1
    s_mov_b32 s47, 0x20000
    buffer_load_dword v250, v245, s[84:87], 0 offen sc1
L_poll18:
    s_waitcnt vmcnt(0)
    v_cmp_ne_u32 vcc, s96, v250
    s_nop 4
    s_cbranch_vccz L_pollok18
    buffer_load_dword v250, v245, s[84:87], 0 offen sc1
    s_sub_u32 s47, s47, 1
    s_cmp_lg_u32 s47, 0
    s_cbranch_scc1 L_poll18
    s_branch L_end
L_pollok18:
    s_mov_b64 exec, -1
    buffer_load_dwordx4 v[144:147], v3, s[16:19], s55 offen offset:0 sc1
    buffer_load_dwordx4 v[148:151], v3, s[16:19], s55 offen offset:1024 sc1
    buffer_load_dwordx4 v[152:155], v3, s[16:19], s55 offen offset:2048 sc1
    buffer_load_dwordx4 v[156:159], v3, s[16:19], s55 offen offset:3072 sc1
    buffer_load_dwordx4 v[160:163], v3, s[16:19], s57 offen offset:0 sc1
    buffer_load_dwordx4 v[164:167], v3, s[16:19], s57 offen offset:1024 sc1
    buffer_load_dwordx4 v[168:171], v3, s[16:19], s57 offen offset:2048 sc1
    buffer_load_dwordx4 v[172:175], v3, s[16:19], s57 offen offset:3072 sc1
L_fin_4:
    s_cmp_eq_u32 s60, 1
    s_cbranch_scc1 L_fin_e2
    v_permlane16_swap_b32 v64, v68
    v_permlane16_swap_b32 v65, v69
    v_permlane16_swap_b32 v66, v70
    v_permlane16_swap_b32 v67, v71
    s_waitcnt vmcnt(7)
    v_lshlrev_b32 v242, 16, v144
    v_and_b32 v243, 0xffff0000, v144
    v_pk_add_f32 v[64:65], v[64:65], v[242:243]
    v_cvt_pk_bf16_f32 v144, v64, v65
    v_lshlrev_b32 v242, 16, v145
    v_and_b32 v243, 0xffff0000, v145
    v_pk_add_f32 v[66:67], v[66:67], v[242:243]
    v_cvt_pk_bf16_f32 v145, v66, v67
    v_lshlrev_b32 v242, 16, v146
    v_and_b32 v243, 0xffff0000, v146
    v_pk_add_f32 v[68:69], v[68:69], v[242:243]
    v_cvt_pk_bf16_f32 v146, v68, v69
    v_lshlrev_b32 v242, 16, v147
    v_and_b32 v243, 0xffff0000, v147
    v_pk_add_f32 v[70:71], v[70:71], v[242:243]
    v_cvt_pk_bf16_f32 v147, v70, v71
    buffer_store_dwordx4 v[144:147], v249, s[20:23], 0 offen offset:0
    v_permlane16_swap_b32 v72, v76
    v_permlane16_swap_b32 v73, v77
    v_permlane16_swap_b32 v74, v78
    v_permlane16_swap_b32 v75, v79
    s_waitcnt vmcnt(7)
    v_lshlrev_b32 v242, 16, v148
    v_and_b32 v243, 0xffff0000, v148
    v_pk_add_f32 v[72:73], v[72:73], v[242:243]
    v_cvt_pk_bf16_f32 v148, v72, v73
    v_lshlrev_b32 v242, 16, v149
    v_and_b32 v243, 0xffff0000, v149
    v_pk_add_f32 v[74:75], v[74:75], v[242:243]
    v_cvt_pk_bf16_f32 v149, v74, v75
    v_lshlrev_b32 v242, 16, v150
    v_and_b32 v243, 0xffff0000, v150
    v_pk_add_f32 v[76:77], v[76:77], v[242:243]
    v_cvt_pk_bf16_f32 v150, v76, v77
    v_lshlrev_b32 v242, 16, v151
    v_and_b32 v243, 0xffff0000, v151
    v_pk_add_f32 v[78:79], v[78:79], v[242:243]
    v_cvt_pk_bf16_f32 v151, v78, v79
    buffer_store_dwordx4 v[148:151], v249, s[20:23], 0 offen offset:64
    v_permlane16_swap_b32 v80, v84
    v_permlane16_swap_b32 v81, v85
    v_permlane16_swap_b32 v82, v86
    v_permlane16_swap_b32 v83, v87
    s_waitcnt vmcnt(7)
    v_lshlrev_b32 v242, 16, v152
    v_and_b32 v243, 0xffff0000, v152
    v_pk_add_f32 v[80:81], v[80:81], v[242:243]
    v_cvt_pk_bf16_f32 v152, v80, v81
    v_lshlrev_b32 v242, 16, v153
    v_and_b32 v243, 0xffff0000, v153
    v_pk_add_f32 v[82:83], v[82:83], v[242:243]
    v_cvt_pk_bf16_f32 v153, v82, v83
    v_lshlrev_b32 v242, 16, v154
    v_and_b32 v243, 0xffff0000, v154
    v_pk_add_f32 v[84:85], v[84:85], v[242:243]
    v_cvt_pk_bf16_f32 v154, v84, v85
    v_lshlrev_b32 v242, 16, v155
    v_and_b32 v243, 0xffff0000, v155
    v_pk_add_f32 v[86:87], v[86:87], v[242:243]
    v_cvt_pk_bf16_f32 v155, v86, v87
    buffer_store_dwordx4 v[152:155], v249, s[20:23], s49 offen offset:0
    v_permlane16_swap_b32 v88, v92
    v_permlane16_swap_b32 v89, v93
    v_permlane16_swap_b32 v90, v94
    v_permlane16_swap_b32 v91, v95
    s_waitcnt vmcnt(7)
    v_lshlrev_b32 v242, 16, v156
    v_and_b32 v243, 0xffff0000, v156
    v_pk_add_f32 v[88:89], v[88:89], v[242:243]
    v_cvt_pk_bf16_f32 v156, v88, v89
    v_lshlrev_b32 v242, 16, v157
    v_and_b32 v243, 0xffff0000, v157
    v_pk_add_f32 v[90:91], v[90:91], v[242:243]
    v_cvt_pk_bf16_f32 v157, v90, v91
    v_lshlrev_b32 v242, 16, v158
    v_and_b32 v243, 0xffff0000, v158
    v_pk_add_f32 v[92:93], v[92:93], v[242:243]
    v_cvt_pk_bf16_f32 v158, v92, v93
    v_lshlrev_b32 v242, 16, v159
    v_and_b32 v243, 0xffff0000, v159
    v_pk_add_f32 v[94:95], v[94:95], v[242:243]
    v_cvt_pk_bf16_f32 v159, v94, v95
    buffer_store_dwordx4 v[156:159], v249, s[20:23], s49 offen offset:64
    v_permlane16_swap_b32 v96, v100
    v_permlane16_swap_b32 v97, v101
    v_permlane16_swap_b32 v98, v102
    v_permlane16_swap_b32 v99, v103
    s_waitcnt vmcnt(7)
    v_lshlrev_b32 v242, 16, v160
    v_and_b32 v243, 0xffff0000, v160
    v_pk_add_f32 v[96:97], v[96:97], v[242:243]
    v_cvt_pk_bf16_f32 v160, v96, v97
    v_lshlrev_b32 v242, 16, v161
    v_and_b32 v243, 0xffff0000, v161
    v_pk_add_f32 v[98:99], v[98:99], v[242:243]
    v_cvt_pk_bf16_f32 v161, v98, v99
    v_lshlrev_b32 v242, 16, v162
    v_and_b32 v243, 0xffff0000, v162
    v_pk_add_f32 v[100:101], v[100:101], v[242:243]
    v_cvt_pk_bf16_f32 v162, v100, v101
    v_lshlrev_b32 v242, 16, v163
    v_and_b32 v243, 0xffff0000, v163
    v_pk_add_f32 v[102:103], v[102:103], v[242:243]
    v_cvt_pk_bf16_f32 v163, v102, v103
    buffer_store_dwordx4 v[160:163], v249, s[20:23], s50 offen offset:0
    v_permlane16_swap_b32 v104, v108
    v_permlane16_swap_b32 v105, v109
    v_permlane16_swap_b32 v106, v110
    v_permlane16_swap_b32 v107, v111
    s_waitcnt vmcnt(7)
    v_lshlrev_b32 v242, 16, v164
    v_and_b32 v243, 0xffff0000, v164
    v_pk_add_f32 v[104:105], v[104:105], v[242:243]
    v_cvt_pk_bf16_f32 v164, v104, v105
    v_lshlrev_b32 v242, 16, v165
    v_and_b32 v243, 0xffff0000, v165
    v_pk_add_f32 v[106:107], v[106:107], v[242:243]
    v_cvt_pk_bf16_f32 v165, v106, v107
    v_lshlrev_b32 v242, 16, v166
    v_and_b32 v243, 0xffff0000, v166
    v_pk_add_f32 v[108:109], v[108:109], v[242:243]
    v_cvt_pk_bf16_f32 v166, v108, v109
    v_lshlrev_b32 v242, 16, v167
    v_and_b32 v243, 0xffff0000, v167
    v_pk_add_f32 v[110:111], v[110:111], v[242:243]
    v_cvt_pk_bf16_f32 v167, v110, v111
    buffer_store_dwordx4 v[164:167], v249, s[20:23], s50 offen offset:64
    v_permlane16_swap_b32 v112, v116
    v_permlane16_swap_b32 v113, v117
    v_permlane16_swap_b32 v114, v118
    v_permlane16_swap_b32 v115, v119
    s_waitcnt vmcnt(7)
    v_lshlrev_b32 v242, 16, v168
    v_and_b32 v243, 0xffff0000, v168
    v_pk_add_f32 v[112:113], v[112:113], v[242:243]
    v_cvt_pk_bf16_f32 v168, v112, v113
    v_lshlrev_b32 v242, 16, v169
    v_and_b32 v243, 0xffff0000, v169
    v_pk_add_f32 v[114:115], v[114:115], v[242:243]
    v_cvt_pk_bf16_f32 v169, v114, v115
    v_lshlrev_b32 v242, 16, v170
    v_and_b32 v243, 0xffff0000, v170
    v_pk_add_f32 v[116:117], v[116:117], v[242:243]
    v_cvt_pk_bf16_f32 v170, v116, v117
    v_lshlrev_b32 v242, 16, v171
    v_and_b32 v243, 0xffff0000, v171
    v_pk_add_f32 v[118:119], v[118:119], v[242:243]
    v_cvt_pk_bf16_f32 v171, v118, v119
    buffer_store_dwordx4 v[168:171], v249, s[20:23], s51 offen offset:0
    v_permlane16_swap_b32 v120, v124
    v_permlane16_swap_b32 v121, v125
    v_permlane16_swap_b32 v122, v126
    v_permlane16_swap_b32 v123, v127
    s_waitcnt vmcnt(7)
    v_lshlrev_b32 v242, 16, v172
    v_and_b32 v243, 0xffff0000, v172
    v_pk_add_f32 v[120:121], v[120:121], v[242:243]
    v_cvt_pk_bf16_f32 v172, v120, v121
    v_lshlrev_b32 v242, 16, v173
    v_and_b32 v243, 0xffff0000, v173
    v_pk_add_f32 v[122:123], v[122:123], v[242:243]
    v_cvt_pk_bf16_f32 v173, v122, v123
    v_lshlrev_b32 v242, 16, v174
    v_and_b32 v243, 0xffff0000, v174
    v_pk_add_f32 v[124:125], v[124:125], v[242:243]
    v_cvt_pk_bf16_f32 v174, v124, v125
    v_lshlrev_b32 v242, 16, v175
    v_and_b32 v243, 0xffff0000, v175
    v_pk_add_f32 v[126:127], v[126:127], v[242:243]
    v_cvt_pk_bf16_f32 v175, v126, v127
    buffer_store_dwordx4 v[172:175], v249, s[20:23], s51 offen offset:64
    s_branch L_fin_5
L_fin_e2:
    v_permlane16_swap_b32 v64, v68
    v_permlane16_swap_b32 v65, v69
    v_permlane16_swap_b32 v66, v70
    v_permlane16_swap_b32 v67, v71
    s_waitcnt vmcnt(7)
    v_lshlrev_b32 v242, 16, v144
    v_and_b32 v243, 0xffff0000, v144
    v_pk_add_f32 v[64:65], v[64:65], v[242:243]
    v_cvt_pk_bf16_f32 v144, v64, v65
    v_lshlrev_b32 v242, 16, v145
    v_and_b32 v243, 0xffff0000, v145
    v_pk_add_f32 v[66:67], v[66:67], v[242:243]
    v_cvt_pk_bf16_f32 v145, v66, v67
    v_lshlrev_b32 v242, 16, v146
    v_and_b32 v243, 0xffff0000, v146
    v_pk_add_f32 v[68:69], v[68:69], v[242:243]
    v_cvt_pk_bf16_f32 v146, v68, v69
    v_lshlrev_b32 v242, 16, v147
    v_and_b32 v243, 0xffff0000, v147
    v_pk_add_f32 v[70:71], v[70:71], v[242:243]
    v_cvt_pk_bf16_f32 v147, v70, v71
    buffer_store_dwordx4 v[144:147], v3, s[16:19], s55 offen offset:0 sc1
    v_permlane16_swap_b32 v72, v76
    v_permlane16_swap_b32 v73, v77
    v_permlane16_swap_b32 v74, v78
    v_permlane16_swap_b32 v75, v79
    s_waitcnt vmcnt(7)
    v_lshlrev_b32 v242, 16, v148
    v_and_b32 v243, 0xffff0000, v148
    v_pk_add_f32 v[72:73], v[72:73], v[242:243]
    v_cvt_pk_bf16_f32 v148, v72, v73
    v_lshlrev_b32 v242, 16, v149
    v_and_b32 v243, 0xffff0000, v149
    v_pk_add_f32 v[74:75], v[74:75], v[242:243]
    v_cvt_pk_bf16_f32 v149, v74, v75
    v_lshlrev_b32 v242, 16, v150
    v_and_b32 v243, 0xffff0000, v150
    v_pk_add_f32 v[76:77], v[76:77], v[242:243]
    v_cvt_pk_bf16_f32 v150, v76, v77
    v_lshlrev_b32 v242, 16, v151
    v_and_b32 v243, 0xffff0000, v151
    v_pk_add_f32 v[78:79], v[78:79], v[242:243]
    v_cvt_pk_bf16_f32 v151, v78, v79
    buffer_store_dwordx4 v[148:151], v3, s[16:19], s55 offen offset:1024 sc1
    v_permlane16_swap_b32 v80, v84
    v_permlane16_swap_b32 v81, v85
    v_permlane16_swap_b32 v82, v86
    v_permlane16_swap_b32 v83, v87
    s_waitcnt vmcnt(7)
    v_lshlrev_b32 v242, 16, v152
    v_and_b32 v243, 0xffff0000, v152
    v_pk_add_f32 v[80:81], v[80:81], v[242:243]
    v_cvt_pk_bf16_f32 v152, v80, v81
    v_lshlrev_b32 v242, 16, v153
    v_and_b32 v243, 0xffff0000, v153
    v_pk_add_f32 v[82:83], v[82:83], v[242:243]
    v_cvt_pk_bf16_f32 v153, v82, v83
    v_lshlrev_b32 v242, 16, v154
    v_and_b32 v243, 0xffff0000, v154
    v_pk_add_f32 v[84:85], v[84:85], v[242:243]
    v_cvt_pk_bf16_f32 v154, v84, v85
    v_lshlrev_b32 v242, 16, v155
    v_and_b32 v243, 0xffff0000, v155
    v_pk_add_f32 v[86:87], v[86:87], v[242:243]
    v_cvt_pk_bf16_f32 v155, v86, v87
    buffer_store_dwordx4 v[152:155], v3, s[16:19], s55 offen offset:2048 sc1
    v_permlane16_swap_b32 v88, v92
    v_permlane16_swap_b32 v89, v93
    v_permlane16_swap_b32 v90, v94
    v_permlane16_swap_b32 v91, v95
    s_waitcnt vmcnt(7)
    v_lshlrev_b32 v242, 16, v156
    v_and_b32 v243, 0xffff0000, v156
    v_pk_add_f32 v[88:89], v[88:89], v[242:243]
    v_cvt_pk_bf16_f32 v156, v88, v89
    v_lshlrev_b32 v242, 16, v157
    v_and_b32 v243, 0xffff0000, v157
    v_pk_add_f32 v[90:91], v[90:91], v[242:243]
    v_cvt_pk_bf16_f32 v157, v90, v91
    v_lshlrev_b32 v242, 16, v158
    v_and_b32 v243, 0xffff0000, v158
    v_pk_add_f32 v[92:93], v[92:93], v[242:243]
    v_cvt_pk_bf16_f32 v158, v92, v93
    v_lshlrev_b32 v242, 16, v159
    v_and_b32 v243, 0xffff0000, v159
    v_pk_add_f32 v[94:95], v[94:95], v[242:243]
    v_cvt_pk_bf16_f32 v159, v94, v95
    buffer_store_dwordx4 v[156:159], v3, s[16:19], s55 offen offset:3072 sc1
    v_permlane16_swap_b32 v96, v100
    v_permlane16_swap_b32 v97, v101
    v_permlane16_swap_b32 v98, v102
    v_permlane16_swap_b32 v99, v103
    s_waitcnt vmcnt(7)
    v_lshlrev_b32 v242, 16, v160
    v_and_b32 v243, 0xffff0000, v160
    v_pk_add_f32 v[96:97], v[96:97], v[242:243]
    v_cvt_pk_bf16_f32 v160, v96, v97
    v_lshlrev_b32 v242, 16, v161
    v_and_b32 v243, 0xffff0000, v161
    v_pk_add_f32 v[98:99], v[98:99], v[242:243]
    v_cvt_pk_bf16_f32 v161, v98, v99
    v_lshlrev_b32 v242, 16, v162
    v_and_b32 v243, 0xffff0000, v162
    v_pk_add_f32 v[100:101], v[100:101], v[242:243]
    v_cvt_pk_bf16_f32 v162, v100, v101
    v_lshlrev_b32 v242, 16, v163
    v_and_b32 v243, 0xffff0000, v163
    v_pk_add_f32 v[102:103], v[102:103], v[242:243]
    v_cvt_pk_bf16_f32 v163, v102, v103
    buffer_store_dwordx4 v[160:163], v3, s[16:19], s57 offen offset:0 sc1
    v_permlane16_swap_b32 v104, v108
    v_permlane16_swap_b32 v105, v109
    v_permlane16_swap_b32 v106, v110
    v_permlane16_swap_b32 v107, v111
    s_waitcnt vmcnt(7)
    v_lshlrev_b32 v242, 16, v164
    v_and_b32 v243, 0xffff0000, v164
    v_pk_add_f32 v[104:105], v[104:105], v[242:243]
    v_cvt_pk_bf16_f32 v164, v104, v105
    v_lshlrev_b32 v242, 16, v165
    v_and_b32 v243, 0xffff0000, v165
    v_pk_add_f32 v[106:107], v[106:107], v[242:243]
    v_cvt_pk_bf16_f32 v165, v106, v107
    v_lshlrev_b32 v242, 16, v166
    v_and_b32 v243, 0xffff0000, v166
    v_pk_add_f32 v[108:109], v[108:109], v[242:243]
    v_cvt_pk_bf16_f32 v166, v108, v109
    v_lshlrev_b32 v242, 16, v167
    v_and_b32 v243, 0xffff0000, v167
    v_pk_add_f32 v[110:111], v[110:111], v[242:243]
    v_cvt_pk_bf16_f32 v167, v110, v111
    buffer_store_dwordx4 v[164:167], v3, s[16:19], s57 offen offset:1024 sc1
    v_permlane16_swap_b32 v112, v116
    v_permlane16_swap_b32 v113, v117
    v_permlane16_swap_b32 v114, v118
    v_permlane16_swap_b32 v115, v119
    s_waitcnt vmcnt(7)
    v_lshlrev_b32 v242, 16, v168
    v_and_b32 v243, 0xffff0000, v168
    v_pk_add_f32 v[112:113], v[112:113], v[242:243]
    v_cvt_pk_bf16_f32 v168, v112, v113
    v_lshlrev_b32 v242, 16, v169
    v_and_b32 v243, 0xffff0000, v169
    v_pk_add_f32 v[114:115], v[114:115], v[242:243]
    v_cvt_pk_bf16_f32 v169, v114, v115
    v_lshlrev_b32 v242, 16, v170
    v_and_b32 v243, 0xffff0000, v170
    v_pk_add_f32 v[116:117], v[116:117], v[242:243]
    v_cvt_pk_bf16_f32 v170, v116, v117
    v_lshlrev_b32 v242, 16, v171
    v_and_b32 v243, 0xffff0000, v171
    v_pk_add_f32 v[118:119], v[118:119], v[242:243]
    v_cvt_pk_bf16_f32 v171, v118, v119
    buffer_store_dwordx4 v[168:171], v3, s[16:19], s57 offen offset:2048 sc1
    v_permlane16_swap_b32 v120, v124
    v_permlane16_swap_b32 v121, v125
    v_permlane16_swap_b32 v122, v126
    v_permlane16_swap_b32 v123, v127
    s_waitcnt vmcnt(7)
    v_lshlrev_b32 v242, 16, v172
    v_and_b32 v243, 0xffff0000, v172
    v_pk_add_f32 v[120:121], v[120:121], v[242:243]
    v_cvt_pk_bf16_f32 v172, v120, v121
    v_lshlrev_b32 v242, 16, v173
    v_and_b32 v243, 0xffff0000, v173
    v_pk_add_f32 v[122:123], v[122:123], v[242:243]
    v_cvt_pk_bf16_f32 v173, v122, v123
    v_lshlrev_b32 v242, 16, v174
    v_and_b32 v243, 0xffff0000, v174
    v_pk_add_f32 v[124:125], v[124:125], v[242:243]
    v_cvt_pk_bf16_f32 v174, v124, v125
    v_lshlrev_b32 v242, 16, v175
    v_and_b32 v243, 0xffff0000, v175
    v_pk_add_f32 v[126:127], v[126:127], v[242:243]
    v_cvt_pk_bf16_f32 v175, v126, v127
    buffer_store_dwordx4 v[172:175], v3, s[16:19], s57 offen offset:3072 sc1
    s_waitcnt vmcnt(0)
    v_mov_b32 v241, 0
    v_mov_b32 v242, s96
    s_mov_b64 exec, 1
    buffer_store_dword v242, v241, s[84:87], s53 offen sc1
    s_mov_b64 exec, -1
L_fin_5:
L_end:
    s_endpgm
L_common:
    v_mov_b32 v180, v3
    v_add_u32 v181, 75776, v3
    v_lshrrev_b32 v188, 2, v1
    v_and_b32 v189, 3, v1
    v_lshlrev_b32 v189, 3, v189
    v_mul_u32_u24 v190, 192, v188
    v_add_u32 v190, v190, v189
    v_and_b32 v191, 16, v1
    v_lshlrev_b32 v191, 1, v191
    v_add_u32 v182, v190, v191
    v_add_u32 v183, 75776, v182
    v_xor_b32 v191, 32, v191
    v_add_u32 v184, v190, v191
    v_add_u32 v185, 75776, v184
    v_mul_u32_u24 v190, 224, v188
    v_add_u32 v186, v190, v189
    v_add_u32 v186, 23552, v186
    v_add_u32 v187, 75776, v186
    v_accvgpr_write_b32 a0, 0
    v_accvgpr_write_b32 a1, 0
    v_accvgpr_write_b32 a2, 0
    v_accvgpr_write_b32 a3, 0
    v_accvgpr_write_b32 a4, 0
    v_accvgpr_write_b32 a5, 0
    v_accvgpr_write_b32 a6, 0
    v_accvgpr_write_b32 a7, 0
    v_accvgpr_write_b32 a8, 0
    v_accvgpr_write_b32 a9, 0
    v_accvgpr_write_b32 a10, 0
    v_accvgpr_write_b32 a11, 0
    v_accvgpr_write_b32 a12, 0
    v_accvgpr_write_b32 a13, 0
    v_accvgpr_write_b32 a14, 0
    v_accvgpr_write_b32 a15, 0
    v_accvgpr_write_b32 a16, 0
    v_accvgpr_write_b32 a17, 0
    v_accvgpr_write_b32 a18, 0
    v_accvgpr_write_b32 a19, 0
    v_accvgpr_write_b32 a20, 0
    v_accvgpr_write_b32 a21, 0
    v_accvgpr_write_b32 a22, 0
    v_accvgpr_write_b32 a23, 0
    v_accvgpr_write_b32 a24, 0
    v_accvgpr_write_b32 a25, 0
    v_accvgpr_write_b32 a26, 0
    v_accvgpr_write_b32 a27, 0
    v_accvgpr_write_b32 a28, 0
    v_accvgpr_write_b32 a29, 0
    v_accvgpr_write_b32 a30, 0
    v_accvgpr_write_b32 a31, 0
    v_accvgpr_write_b32 a32, 0
    v_accvgpr_write_b32 a33, 0
    v_accvgpr_write_b32 a34, 0
    v_accvgpr_write_b32 a35, 0
    v_accvgpr_write_b32 a36, 0
    v_accvgpr_write_b32 a37, 0
    v_accvgpr_write_b32 a38, 0
    v_accvgpr_write_b32 a39, 0
    v_accvgpr_write_b32 a40, 0
    v_accvgpr_write_b32 a41, 0
    v_accvgpr_write_b32 a42, 0
    v_accvgpr_write_b32 a43, 0
    v_accvgpr_write_b32 a44, 0
    v_accvgpr_write_b32 a45, 0
    v_accvgpr_write_b32 a46, 0
    v_accvgpr_write_b32 a47, 0
    v_accvgpr_write_b32 a48, 0
    v_accvgpr_write_b32 a49, 0
    v_accvgpr_write_b32 a50, 0
    v_accvgpr_write_b32 a51, 0
    v_accvgpr_write_b32 a52, 0
    v_accvgpr_write_b32 a53, 0
    v_accvgpr_write_b32 a54, 0
    v_accvgpr_write_b32 a55, 0
    v_accvgpr_write_b32 a56, 0
    v_accvgpr_write_b32 a57, 0
    v_accvgpr_write_b32 a58, 0
    v_accvgpr_write_b32 a59, 0
    v_accvgpr_write_b32 a60, 0
    v_accvgpr_write_b32 a61, 0
    v_accvgpr_write_b32 a62, 0
    v_accvgpr_write_b32 a63, 0
    v_accvgpr_write_b32 a64, 0
    v_accvgpr_write_b32 a65, 0
    v_accvgpr_write_b32 a66, 0
    v_accvgpr_write_b32 a67, 0
    v_accvgpr_write_b32 a68, 0
    v_accvgpr_write_b32 a69, 0
    v_accvgpr_write_b32 a70, 0
    v_accvgpr_write_b32 a71, 0
    v_accvgpr_write_b32 a72, 0
    v_accvgpr_write_b32 a73, 0
    v_accvgpr_write_b32 a74, 0
    v_accvgpr_write_b32 a75, 0
    v_accvgpr_write_b32 a76, 0
    v_accvgpr_write_b32 a77, 0
    v_accvgpr_write_b32 a78, 0
    v_accvgpr_write_b32 a79, 0
    v_accvgpr_write_b32 a80, 0
    v_accvgpr_write_b32 a81, 0
    v_accvgpr_write_b32 a82, 0
    v_accvgpr_write_b32 a83, 0
    v_accvgpr_write_b32 a84, 0
    v_accvgpr_write_b32 a85, 0
    v_accvgpr_write_b32 a86, 0
    v_accvgpr_write_b32 a87, 0
    v_accvgpr_write_b32 a88, 0
    v_accvgpr_write_b32 a89, 0
    v_accvgpr_write_b32 a90, 0
    v_accvgpr_write_b32 a91, 0
    v_accvgpr_write_b32 a92, 0
    v_accvgpr_write_b32 a93, 0
    v_accvgpr_write_b32 a94, 0
    v_accvgpr_write_b32 a95, 0
    v_accvgpr_write_b32 a96, 0
    v_accvgpr_write_b32 a97, 0
    v_accvgpr_write_b32 a98, 0
    v_accvgpr_write_b32 a99, 0
    v_accvgpr_write_b32 a100, 0
    v_accvgpr_write_b32 a101, 0
    v_accvgpr_write_b32 a102, 0
    v_accvgpr_write_b32 a103, 0
    v_accvgpr_write_b32 a104, 0
    v_accvgpr_write_b32 a105, 0
    v_accvgpr_write_b32 a106, 0
    v_accvgpr_write_b32 a107, 0
    v_accvgpr_write_b32 a108, 0
    v_accvgpr_write_b32 a109, 0
    v_accvgpr_write_b32 a110, 0
    v_accvgpr_write_b32 a111, 0
    v_accvgpr_write_b32 a112, 0
    v_accvgpr_write_b32 a113, 0
    v_accvgpr_write_b32 a114, 0
    v_accvgpr_write_b32 a115, 0
    v_accvgpr_write_b32 a116, 0
    v_accvgpr_write_b32 a117, 0
    v_accvgpr_write_b32 a118, 0
    v_accvgpr_write_b32 a119, 0
    v_accvgpr_write_b32 a120, 0
    v_accvgpr_write_b32 a121, 0
    v_accvgpr_write_b32 a122, 0
    v_accvgpr_write_b32 a123, 0
    v_accvgpr_write_b32 a124, 0
    v_accvgpr_write_b32 a125, 0
    v_accvgpr_write_b32 a126, 0
    v_accvgpr_write_b32 a127, 0
    v_accvgpr_write_b32 a128, 0
    v_accvgpr_write_b32 a129, 0
    v_accvgpr_write_b32 a130, 0
    v_accvgpr_write_b32 a131, 0
    v_accvgpr_write_b32 a132, 0
    v_accvgpr_write_b32 a133, 0
    v_accvgpr_write_b32 a134, 0
    v_accvgpr_write_b32 a135, 0
    v_accvgpr_write_b32 a136, 0
    v_accvgpr_write_b32 a137, 0
    v_accvgpr_write_b32 a138, 0
    v_accvgpr_write_b32 a139, 0
    v_accvgpr_write_b32 a140, 0
    v_accvgpr_write_b32 a141, 0
    v_accvgpr_write_b32 a142, 0
    v_accvgpr_write_b32 a143, 0
    v_accvgpr_write_b32 a144, 0
    v_accvgpr_write_b32 a145, 0
    v_accvgpr_write_b32 a146, 0
    v_accvgpr_write_b32 a147, 0
    v_accvgpr_write_b32 a148, 0
    v_accvgpr_write_b32 a149, 0
    v_accvgpr_write_b32 a150, 0
    v_accvgpr_write_b32 a151, 0
    v_accvgpr_write_b32 a152, 0
    v_accvgpr_write_b32 a153, 0
    v_accvgpr_write_b32 a154, 0
    v_accvgpr_write_b32 a155, 0
    v_accvgpr_write_b32 a156, 0
    v_accvgpr_write_b32 a157, 0
    v_accvgpr_write_b32 a158, 0
    v_accvgpr_write_b32 a159, 0
    v_accvgpr_write_b32 a160, 0
    v_accvgpr_write_b32 a161, 0
    v_accvgpr_write_b32 a162, 0
    v_accvgpr_write_b32 a163, 0
    v_accvgpr_write_b32 a164, 0
    v_accvgpr_write_b32 a165, 0
    v_accvgpr_write_b32 a166, 0
    v_accvgpr_write_b32 a167, 0
    v_accvgpr_write_b32 a168, 0
    v_accvgpr_write_b32 a169, 0
    v_accvgpr_write_b32 a170, 0
    v_accvgpr_write_b32 a171, 0
    v_accvgpr_write_b32 a172, 0
    v_accvgpr_write_b32 a173, 0
    v_accvgpr_write_b32 a174, 0
    v_accvgpr_write_b32 a175, 0
    v_accvgpr_write_b32 a176, 0
    v_accvgpr_write_b32 a177, 0
    v_accvgpr_write_b32 a178, 0
    v_accvgpr_write_b32 a179, 0
    v_accvgpr_write_b32 a180, 0
    v_accvgpr_write_b32 a181, 0
    v_accvgpr_write_b32 a182, 0
    v_accvgpr_write_b32 a183, 0
    v_accvgpr_write_b32 a184, 0
    v_accvgpr_write_b32 a185, 0
    v_accvgpr_write_b32 a186, 0
    v_accvgpr_write_b32 a187, 0
    v_accvgpr_write_b32 a188, 0
    v_accvgpr_write_b32 a189, 0
    v_accvgpr_write_b32 a190, 0
    v_accvgpr_write_b32 a191, 0
    v_accvgpr_write_b32 a192, 0
    v_accvgpr_write_b32 a193, 0
    v_accvgpr_write_b32 a194, 0
    v_accvgpr_write_b32 a195, 0
    v_accvgpr_write_b32 a196, 0
    v_accvgpr_write_b32 a197, 0
    v_accvgpr_write_b32 a198, 0
    v_accvgpr_write_b32 a199, 0
    v_accvgpr_write_b32 a200, 0
    v_accvgpr_write_b32 a201, 0
    v_accvgpr_write_b32 a202, 0
    v_accvgpr_write_b32 a203, 0
    v_accvgpr_write_b32 a204, 0
    v_accvgpr_write_b32 a205, 0
    v_accvgpr_write_b32 a206, 0
    v_accvgpr_write_b32 a207, 0
    v_accvgpr_write_b32 a208, 0
    v_accvgpr_write_b32 a209, 0
    v_accvgpr_write_b32 a210, 0
    v_accvgpr_write_b32 a211, 0
    v_accvgpr_write_b32 a212, 0
    v_accvgpr_write_b32 a213, 0
    v_accvgpr_write_b32 a214, 0
    v_accvgpr_write_b32 a215, 0
    v_accvgpr_write_b32 a216, 0
    v_accvgpr_write_b32 a217, 0
    v_accvgpr_write_b32 a218, 0
    v_accvgpr_write_b32 a219, 0
    v_accvgpr_write_b32 a220, 0
    v_accvgpr_write_b32 a221, 0
    v_accvgpr_write_b32 a222, 0
    v_accvgpr_write_b32 a223, 0
    v_accvgpr_write_b32 a224, 0
    v_accvgpr_write_b32 a225, 0
    v_accvgpr_write_b32 a226, 0
    v_accvgpr_write_b32 a227, 0
    v_accvgpr_write_b32 a228, 0
    v_accvgpr_write_b32 a229, 0
    v_accvgpr_write_b32 a230, 0
    v_accvgpr_write_b32 a231, 0
    v_mov_b64 v[4:5], 0
    v_mov_b64 v[6:7], 0
    v_mov_b64 v[8:9], 0
    v_mov_b64 v[10:11], 0
    v_mov_b64 v[12:13], 0
    v_mov_b64 v[14:15], 0
    v_mov_b64 v[16:17], 0
    v_mov_b64 v[18:19], 0
    v_mov_b64 v[20:21], 0
    v_mov_b64 v[22:23], 0
    v_mov_b64 v[24:25], 0
    v_mov_b64 v[26:27], 0
    v_mov_b64 v[28:29], 0
    v_mov_b64 v[30:31], 0
    v_mov_b64 v[32:33], 0
    v_mov_b64 v[34:35], 0
    v_mov_b64 v[36:37], 0
    v_mov_b64 v[38:39], 0
    v_mov_b64 v[40:41], 0
    v_mov_b64 v[42:43], 0
    v_mov_b64 v[44:45], 0
    v_mov_b64 v[46:47], 0
    v_mov_b64 v[48:49], 0
    v_mov_b64 v[50:51], 0
    v_mov_b64 v[52:53], 0
    v_mov_b64 v[54:55], 0
    v_mov_b64 v[56:57], 0
    v_mov_b64 v[58:59], 0
    v_mov_b64 v[60:61], 0
    v_mov_b64 v[62:63], 0
    v_mov_b64 v[64:65], 0
    v_mov_b64 v[66:67], 0
    v_mov_b64 v[68:69], 0
    v_mov_b64 v[70:71], 0
    v_mov_b64 v[72:73], 0
    v_mov_b64 v[74:75], 0
    v_mov_b64 v[76:77], 0
    v_mov_b64 v[78:79], 0
    v_mov_b64 v[80:81], 0
    v_mov_b64 v[82:83], 0
    v_mov_b64 v[84:85], 0
    v_mov_b64 v[86:87], 0
    v_mov_b64 v[88:89], 0
    v_mov_b64 v[90:91], 0
    v_mov_b64 v[92:93], 0
    v_mov_b64 v[94:95], 0
    v_mov_b64 v[96:97], 0
    v_mov_b64 v[98:99], 0
    v_mov_b64 v[100:101], 0
    v_mov_b64 v[102:103], 0
    v_mov_b64 v[104:105], 0
    v_mov_b64 v[106:107], 0
    v_mov_b64 v[108:109], 0
    v_mov_b64 v[110:111], 0
    v_mov_b64 v[112:113], 0
    v_mov_b64 v[114:115], 0
    v_mov_b64 v[116:117], 0
    v_mov_b64 v[118:119], 0
    v_mov_b64 v[120:121], 0
    v_mov_b64 v[122:123], 0
    v_mov_b64 v[124:125], 0
    v_mov_b64 v[126:127], 0
    v_mov_b64 v[128:129], 0
    v_mov_b64 v[130:131], 0
    v_mov_b64 v[132:133], 0
    v_mov_b64 v[134:135], 0
    v_mov_b64 v[136:137], 0
    v_mov_b64 v[138:139], 0
    v_mov_b64 v[140:141], 0
    v_mov_b64 v[142:143], 0
    v_mov_b64 v[144:145], 0
    v_mov_b64 v[146:147], 0
    v_mov_b64 v[148:149], 0
    v_mov_b64 v[150:151], 0
    v_mov_b64 v[152:153], 0
    v_mov_b64 v[154:155], 0
    v_mov_b64 v[156:157], 0
    v_mov_b64 v[158:159], 0
    v_mov_b64 v[160:161], 0
    v_mov_b64 v[162:163], 0
    v_mov_b64 v[164:165], 0
    v_mov_b64 v[166:167], 0
    s_setpc_b64 s[62:63]
L_end_code:
.section .rodata,"a"
.p2align 6
.amdhsa_kernel parallel_sum__sliding_local_dilated__glu_gated_bilinear__prompt_kernel
  .amdhsa_next_free_vgpr 488
  .amdhsa_next_free_sgpr 102
  .amdhsa_accum_offset 256
  .amdhsa_group_segment_fixed_size 0
  .amdhsa_kernarg_size 80
  .amdhsa_user_sgpr_count 2
  .amdhsa_user_sgpr_kernarg_segment_ptr 1
  .amdhsa_system_sgpr_workgroup_id_x 1
  .amdhsa_float_denorm_mode_32 3
.end_amdhsa_kernel
```
